```python
import torch

def _softmax(x, axis=-1):
    return torch.softmax(x, dim=axis)

def _gelu(x):
    return torch.nn.functional.gelu(x, approximate='tanh')

def _silu(x):
    return torch.nn.functional.silu(x)

def _sigmoid(x):
    return torch.sigmoid(x)

def _layernorm(x, axis=-1, eps=1e-05):
    m = x.mean(dim=axis, keepdim=True)
    v = x.var(dim=axis, keepdim=True, unbiased=False)
    return (x - m) / torch.sqrt(v + eps)

def _scatter_add(tgt, idx, src, axis=0):
    return tgt.clone().index_add_(axis, idx, src)

def _segment_sum(src, seg, n):
    out = torch.zeros((n,) + src.shape[1:], dtype=src.dtype)
    return out.index_add_(0, seg, src)

def _pad(x, pw):
    flat = tuple((v for pair in reversed(pw) for v in pair))
    return torch.nn.functional.pad(x, flat)
kernel_name = 'gated_mix__memory_aug_recurrent_mem_tr__memory_aug_recurrent_mem_tr__prompt'

def setup_inputs():

    _w = lambda a: (lambda t: t.to(torch.bfloat16) if t.is_floating_point() else t)(torch.as_tensor(a))

    def _A_setup():
        B, S, Dm = (1, 2048, 512)
        H, Dh = (32, 128)
        M, seg = (8, 32)
        seg = min(seg, S)
        S = S // seg * seg
        return {'x': _w((lambda *s: torch.randn(*s, dtype=torch.bfloat16) * 0.05)(B, S, Dm)), 'mem0': _w((lambda *s: torch.randn(*s, dtype=torch.bfloat16) * 0.4)(B, M, Dm)), 'Wq': _w((lambda *s: torch.randn(*s, dtype=torch.bfloat16) * 6.4)(Dm, H, Dh) * Dm ** (-0.5)), 'Wk': _w((lambda *s: torch.randn(*s, dtype=torch.bfloat16) * 6.4)(Dm, H, Dh) * Dm ** (-0.5)), 'Wv': _w((lambda *s: torch.randn(*s, dtype=torch.bfloat16) * 0.4)(Dm, H, Dh) * Dm ** (-0.5)), 'Wo': _w((lambda *s: torch.randn(*s, dtype=torch.bfloat16) * 0.4)(H, Dh, Dm) * (H * Dh) ** (-0.5)), 'seg_len': seg}
    _A_in = _A_setup()

    def _B_setup():
        B, S, Dm = (1, 2048, 512)
        H, Dh = (32, 128)
        M, seg = (8, 32)
        seg = min(seg, S)
        S = S // seg * seg
        return {'x': _w((lambda *s: torch.randn(*s, dtype=torch.bfloat16) * 0.05)(B, S, Dm)), 'mem0': _w((lambda *s: torch.randn(*s, dtype=torch.bfloat16) * 0.4)(B, M, Dm)), 'Wq': _w((lambda *s: torch.randn(*s, dtype=torch.bfloat16) * 6.4)(Dm, H, Dh) * Dm ** (-0.5)), 'Wk': _w((lambda *s: torch.randn(*s, dtype=torch.bfloat16) * 6.4)(Dm, H, Dh) * Dm ** (-0.5)), 'Wv': _w((lambda *s: torch.randn(*s, dtype=torch.bfloat16) * 0.4)(Dm, H, Dh) * Dm ** (-0.5)), 'Wo': _w((lambda *s: torch.randn(*s, dtype=torch.bfloat16) * 0.4)(H, Dh, Dm) * (H * Dh) ** (-0.5)), 'seg_len': seg}
    _B_in = _B_setup()
    return {'A_x': _A_in['x'], 'A_mem0': _A_in['mem0'], 'A_Wq': _A_in['Wq'], 'A_Wk': _A_in['Wk'], 'A_Wv': _A_in['Wv'], 'A_Wo': _A_in['Wo'], 'A_seg_len': _A_in['seg_len'], 'B_x': _B_in['x'], 'B_mem0': _B_in['mem0'], 'B_Wq': _B_in['Wq'], 'B_Wk': _B_in['Wk'], 'B_Wv': _B_in['Wv'], 'B_Wo': _B_in['Wo'], 'B_seg_len': _B_in['seg_len'], 'gate_w': _w((lambda *s: torch.randn(*s, dtype=torch.bfloat16) * 0.05)(512) * 16.0)}

def reference(A_x, A_mem0, A_Wq, A_Wk, A_Wv, A_Wo, A_seg_len, B_x, B_mem0, B_Wq, B_Wk, B_Wv, B_Wo, B_seg_len, gate_w):

    def _A_ref(x, mem0, Wq, Wk, Wv, Wo, seg_len):
        B, S, Dm = x.shape
        H, Dh = (Wq.shape[1], Wq.shape[2])
        M = mem0.shape[1]
        scale = Dh ** (-0.5)
        n_seg = S // seg_len
        L = M + seg_len
        idx = torch.arange(L)
        mask = (idx[:, None] < M) | (idx[:, None] >= idx[None, :])
        mem = mem0
        outs = []
        for s in range(n_seg):
            xs = x[:, s * seg_len:(s + 1) * seg_len, :].clone()
            h = torch.concatenate([mem, xs], axis=1)
            q = torch.einsum('btd,dhe->bhte', h, Wq)
            k = torch.einsum('btd,dhe->bhte', h, Wk)
            v = torch.einsum('btd,dhe->bhte', h, Wv)
            scores = torch.einsum('bhqe,bhke->bhqk', q, k) * scale
            scores = torch.where(mask[None, None], scores, -1000000000.0)
            p = _softmax(scores, axis=-1)
            o = torch.einsum('bhqk,bhke->bhqe', p, v)
            o = torch.einsum('bhte,hed->btd', o, Wo)
            mem = o[:, :M, :].clone()
            outs.append(o[:, M:, :])
        return torch.concatenate(outs, axis=1)

    def _B_ref(x, mem0, Wq, Wk, Wv, Wo, seg_len):
        B, S, Dm = x.shape
        H, Dh = (Wq.shape[1], Wq.shape[2])
        M = mem0.shape[1]
        scale = Dh ** (-0.5)
        n_seg = S // seg_len
        L = M + seg_len
        idx = torch.arange(L)
        mask = (idx[:, None] < M) | (idx[:, None] >= idx[None, :])
        mem = mem0
        outs = []
        for s in range(n_seg):
            xs = x[:, s * seg_len:(s + 1) * seg_len, :].clone()
            h = torch.concatenate([mem, xs], axis=1)
            q = torch.einsum('btd,dhe->bhte', h, Wq)
            k = torch.einsum('btd,dhe->bhte', h, Wk)
            v = torch.einsum('btd,dhe->bhte', h, Wv)
            scores = torch.einsum('bhqe,bhke->bhqk', q, k) * scale
            scores = torch.where(mask[None, None], scores, -1000000000.0)
            p = _softmax(scores, axis=-1)
            o = torch.einsum('bhqk,bhke->bhqe', p, v)
            o = torch.einsum('bhte,hed->btd', o, Wo)
            mem = o[:, :M, :].clone()
            outs.append(o[:, M:, :])
        return torch.concatenate(outs, axis=1)
    x = A_x
    g = _sigmoid((x * gate_w).sum(-1, keepdims=True))
    a = _A_ref(x, A_mem0, A_Wq, A_Wk, A_Wv, A_Wo, A_seg_len)
    b = _B_ref(x, B_mem0, B_Wq, B_Wk, B_Wv, B_Wo, B_seg_len)
    return g * a + (1 - g) * b
```

```asm
; @launch grid=(256,1,1) block=(256,1,1) lds=163840
.amdgcn_target "amdgcn-amd-amdhsa--gfx950"
.text
.globl gated_mix__memory_aug_recurrent_mem_tr__memory_aug_recurrent_mem_tr__prompt_kernel
.p2align 8
.type gated_mix__memory_aug_recurrent_mem_tr__memory_aug_recurrent_mem_tr__prompt_kernel,@function
gated_mix__memory_aug_recurrent_mem_tr__memory_aug_recurrent_mem_tr__prompt_kernel:
    s_cmp_ge_u32 s2, 256
    s_cbranch_scc1 L_exit
    s_getpc_b64 s[20:21]
L_pc0:
    s_lshr_b32 s22, s2, 3
    s_and_b32 s22, s22, 31
    s_lshl_b32 s22, s22, 12
    v_lshlrev_b32 v10, 4, v0
    v_add_u32 v10, s22, v10
    v_min_u32 v10, L_code_end-L_pc0-16, v10
    global_load_dwordx4 v[248:251], v10, s[20:21]
    s_load_dwordx2 s[4:5], s[0:1], 136
    s_load_dwordx2 s[6:7], s[0:1], 128
    s_getreg_b32 s13, hwreg(HW_REG_XCC_ID, 0, 4)
    v_lshrrev_b32 v1, 6, v0
    v_and_b32 v0, 63, v0
    s_mov_b32 s12, 0x00200000
    v_readfirstlane_b32 s8, v1
    s_and_b32 s13, s13, 7
    s_waitcnt lgkmcnt(0)
    s_cmp_lg_u32 s8, 0
    s_cbranch_scc1 L_notick_1
    s_lshl_b32 s14, s13, 2
    v_mov_b32 v2, s14
    v_mov_b32 v3, 1
    s_mov_b64 exec, 1
    global_atomic_add v4, v2, v3, s[6:7] sc0 sc1
    s_waitcnt vmcnt(0)
    v_mov_b32 v2, 0
    ds_write_b32 v2, v4
    s_waitcnt lgkmcnt(0)
    s_mov_b64 exec, -1
L_notick_1:
    s_barrier
    v_mov_b32 v2, 0
    ds_read_b32 v4, v2
    s_waitcnt lgkmcnt(0)
    v_readfirstlane_b32 s9, v4
    s_barrier
    s_cmp_ge_u32 s9, 32
    s_cbranch_scc1 L_exit
    s_mov_b32 s10, s13
    s_cmp_lt_u32 s13, 2
    s_cbranch_scc0 L_worker
L_chain:
    s_mul_i32 s54, s10, 56
    s_add_u32 s14, s0, s54
    s_addc_u32 s15, s1, 0
    s_load_dwordx2 s[68:69], s[14:15], 8
    s_load_dwordx4 s[60:63], s[14:15], 16
    s_load_dwordx4 s[64:67], s[14:15], 32
    s_waitcnt lgkmcnt(0)
    s_lshl_b32 s54, s9, 8
    s_add_u32 s60, s60, s54
    s_addc_u32 s61, s61, 0
    s_add_u32 s62, s62, s54
    s_addc_u32 s63, s63, 0
    s_add_u32 s64, s64, s54
    s_addc_u32 s65, s65, 0
    s_lshl_b32 s54, s9, 17
    s_add_u32 s66, s66, s54
    s_addc_u32 s67, s67, 0
    v_lshlrev_b32 v13, 4, v0
    v_bfe_u32 v26, v0, 1, 1
    v_mul_u32_u24 v26, 0xAAAA, v26
    v_add_u32 v1, 0x4444, v26
    s_add_u32 s54, s8, 0
    s_and_b32 s54, s54, 3
    s_lshl_b32 s54, s54, 11
    v_add_u32 v2, s54, v13
    s_add_u32 s54, s8, 1
    s_and_b32 s54, s54, 3
    s_lshl_b32 s54, s54, 11
    v_add_u32 v3, s54, v13
    s_add_u32 s54, s8, 2
    s_and_b32 s54, s54, 3
    s_lshl_b32 s54, s54, 11
    v_add_u32 v4, s54, v13
    s_add_u32 s54, s8, 3
    s_and_b32 s54, s54, 3
    s_lshl_b32 s54, s54, 11
    v_add_u32 v5, s54, v13
    v_and_b32 v26, 15, v0
    v_lshrrev_b32 v27, 4, v0
    s_lshl_b32 s54, s8, 5
    v_add_u32 v30, s54, v26
    v_lshlrev_b32 v31, 4, v30
    v_lshl_add_u32 v31, v27, 2, v31
    v_add_u32 v6, 8192, v31
    v_lshlrev_b32 v31, 5, v30
    v_lshl_add_u32 v31, v27, 3, v31
    v_add_u32 v7, 10240, v31
    v_bfe_u32 v30, v0, 5, 1
    v_lshlrev_b32 v30, 4, v30
    v_bfe_u32 v31, v0, 4, 1
    v_lshl_add_u32 v30, v31, 2, v30
    v_bfe_u32 v31, v0, 2, 2
    v_add_u32 v30, v30, v31
    v_and_b32 v31, 1, v0
    v_lshlrev_b32 v31, 3, v31
    v_lshl_add_u32 v31, v30, 4, v31
    v_add_u32 v8, 8192, v31
    v_and_b32 v31, 3, v0
    v_lshlrev_b32 v31, 3, v31
    v_lshl_add_u32 v31, v30, 5, v31
    v_add_u32 v9, 10240, v31
    v_add_u32 v10, 147456, v13
    s_lshl_b32 s54, s8, 11
    s_add_u32 s54, s54, 155648
    v_add_u32 v11, s54, v13
    v_lshlrev_b32 v30, 4, v27
    v_bfe_u32 v31, v26, 1, 2
    v_lshl_add_u32 v30, v31, 2, v30
    v_and_b32 v31, 1, v26
    v_add_u32 v30, v30, v31
    s_and_b32 s54, s8, 1
    s_lshl_b32 s54, s54, 1
    v_add_u32 v30, s54, v30
    v_lshlrev_b32 v30, 4, v30
    v_lshrrev_b32 v31, 3, v26
    v_lshl_add_u32 v30, v31, 3, v30
    s_lshr_b32 s54, s8, 1
    s_lshl_b32 s54, s54, 10
    v_add_u32 v12, s54, v30
    s_mul_i32 s54, s8, 10240
    s_add_u32 s55, s54, 16384
    v_add_u32 v14, s55, v13
    s_add_u32 s55, s54, 57344
    v_add_u32 v15, s55, v13
    v_lshrrev_b32 v30, 2, v26
    s_lshl_b32 s54, s8, 3
    v_add_u32 v30, s54, v30
    v_lshlrev_b32 v30, 13, v30
    v_and_b32 v31, 3, v26
    v_lshl_add_u32 v31, v27, 2, v31
    v_lshl_add_u32 v30, v31, 4, v30
    s_lshl_b32 s54, s9, 8
    v_add_u32 v16, s54, v30
    v_and_b32 v30, 1, v26
    v_lshl_add_u32 v30, v27, 1, v30
    v_lshlrev_b32 v30, 8, v30
    v_lshrrev_b32 v31, 1, v26
    v_lshl_add_u32 v30, v31, 4, v30
    s_lshl_b32 s54, s9, 13
    s_and_b32 s55, s8, 1
    s_lshl_b32 s55, s55, 7
    s_add_u32 s54, s54, s55
    v_add_u32 v17, s54, v30
    v_and_b32 v30, 1, v26
    v_bfe_u32 v31, v26, 2, 1
    v_lshl_add_u32 v30, v31, 1, v30
    v_lshrrev_b32 v31, 1, v27
    v_lshl_add_u32 v30, v31, 2, v30
    v_lshlrev_b32 v30, 4, v30
    v_bfe_u32 v31, v26, 1, 1
    v_lshl_add_u32 v30, v31, 3, v30
    v_and_b32 v31, 1, v27
    v_lshl_add_u32 v30, v31, 2, v30
    s_lshl_b32 s54, s9, 8
    s_and_b32 s55, s8, 1
    s_lshl_b32 s55, s55, 7
    s_add_u32 s54, s54, s55
    v_add_u32 v18, s54, v30
    v_mov_b32 v20, 0x3f803f80
    v_mov_b32 v21, 0x3f803f80
    v_mov_b32 v22, 0x3f803f80
    v_mov_b32 v23, 0x3f803f80
    s_mov_b32 s48, 0x3e0293ee
    s_mov_b32 s50, 0x00ff00ff
    s_mov_b32 s51, 0x00ff00ff
    s_mov_b32 s11, 0
    s_mov_b32 s52, 0
    s_lshl_b32 s55, s10, 20
    s_add_u32 s55, s55, 100663296
    s_add_u32 s18, s4, s55
    s_addc_u32 s19, s5, 0
    s_add_u32 s20, s18, 32768
    s_addc_u32 s21, s19, 0
    s_add_u32 s30, s18, 4096
    s_addc_u32 s31, s19, 0
    s_add_u32 s22, s18, 262144
    s_addc_u32 s23, s19, 0
    s_add_u32 s24, s22, 32768
    s_addc_u32 s25, s23, 0
    s_add_u32 s32, s22, 4096
    s_addc_u32 s33, s23, 0
    s_add_u32 s26, s18, 524288
    s_addc_u32 s27, s19, 0
    s_add_u32 s28, s26, 32768
    s_addc_u32 s29, s27, 0
    s_add_u32 s34, s26, 4096
    s_addc_u32 s35, s27, 0
    s_lshl_b32 s55, s10, 15
    s_add_u32 s55, s55, 116391936
    s_add_u32 s36, s4, s55
    s_addc_u32 s37, s5, 0
    s_add_u32 s38, s36, 8192
    s_addc_u32 s39, s37, 0
    s_add_u32 s40, s36, 16384
    s_addc_u32 s41, s37, 0
    s_lshl_b32 s54, s10, 11
    s_add_u32 s54, s54, s9
    s_lshl_b32 s55, s54, 14
    s_lshl_b32 s56, s8, 12
    s_add_u32 s55, s55, s56
    s_add_u32 s42, s4, s55
    s_addc_u32 s43, s5, 0
    s_lshl_b32 s54, s54, 13
    s_add_u32 s54, s54, 67108864
    s_lshl_b32 s55, s8, 10
    s_add_u32 s54, s54, s55
    s_add_u32 s44, s4, s54
    s_addc_u32 s45, s5, 0
    v_mov_b32 v32, -1
    v_mov_b32 v33, -1
    v_mov_b32 v34, -1
    v_mov_b32 v35, -1
    global_store_dwordx4 v16, v[32:35], s[18:19]
    global_store_dwordx4 v16, v[32:35], s[20:21]
    global_store_dwordx4 v16, v[32:35], s[22:23]
    global_store_dwordx4 v16, v[32:35], s[24:25]
    global_store_dwordx4 v16, v[32:35], s[26:27]
    global_store_dwordx4 v16, v[32:35], s[28:29]
    s_mov_b64 exec, s[50:51]
    global_store_dword v18, v32, s[36:37]
    global_store_dword v18, v32, s[38:39]
    global_store_dword v18, v32, s[40:41]
    s_mov_b64 exec, -1
    s_lshl_b32 s54, s10, 5
    s_add_u32 s54, s54, s9
    s_lshl_b32 s54, s54, 6
    s_add_u32 s54, s54, 117444608
    v_mov_b32 v30, s54
    v_mov_b32 v31, 0
    global_store_dword v30, v31, s[4:5] sc1
    s_cmp_eq_u32 s8, 1
    s_cbranch_scc1 L_w1_4
    s_cmp_eq_u32 s8, 2
    s_cbranch_scc1 L_w2_5
    s_cmp_eq_u32 s8, 3
    s_cbranch_scc1 L_w3_6
L_w0_3:
    v_lshrrev_b32 v46, 4, v0
    v_and_b32 v47, 1, v46
    v_or_b32 v47, 0, v47
    v_lshlrev_b32 v47, 1, v47
    v_and_b32 v48, 15, v0
    v_xor_b32 v48, v48, v47
    v_lshlrev_b32 v48, 4, v48
    v_add_u32 v46, 0, v46
    v_lshlrev_b32 v46, 13, v46
    v_add_u32 v40, v46, v48
    v_add_u32 v41, 32768, v40
    v_add_u32 v42, 65536, v40
    v_add_u32 v43, 98304, v40
    v_bfe_u32 v46, v0, 3, 1
    v_bfe_u32 v47, v0, 4, 1
    v_bfe_u32 v48, v0, 2, 1
    v_lshlrev_b32 v49, 2, v46
    v_lshl_or_b32 v49, v47, 1, v49
    v_or_b32 v49, v49, v48
    v_lshlrev_b32 v50, 5, v46
    v_lshl_or_b32 v50, v47, 4, v50
    v_or_b32 v50, v50, v48
    v_bfe_u32 v51, v0, 5, 1
    v_lshl_or_b32 v50, v51, 2, v50
    v_and_b32 v51, 3, v0
    v_lshlrev_b32 v51, 3, v51
    v_xor_b32 v52, 0, v49
    v_lshlrev_b32 v52, 5, v52
    v_lshl_or_b32 v52, v50, 8, v52
    v_add_u32 v52, v52, v51
    v_lshlrev_b32 v53, 5, v49
    v_lshl_or_b32 v53, v50, 10, v53
    v_add_u32 v53, v53, v51
    v_add_u32 v53, 16384, v53
    v_add_u32 v55, 0, v13
    s_add_u32 s14, s60, 0
    s_addc_u32 s15, s61, 0
    s_mov_b32 m0, 16384
    s_nop 0
    global_load_lds_dwordx4 v40, s[14:15]
    s_mov_b32 m0, 17408
    s_nop 0
    global_load_lds_dwordx4 v41, s[14:15]
    s_mov_b32 m0, 18432
    s_nop 0
    global_load_lds_dwordx4 v42, s[14:15]
    s_mov_b32 m0, 19456
    s_nop 0
    global_load_lds_dwordx4 v43, s[14:15]
    s_add_u32 s14, s60, 524288
    s_addc_u32 s15, s61, 0
    s_mov_b32 m0, 32768
    s_nop 0
    global_load_lds_dwordx4 v40, s[14:15]
    s_mov_b32 m0, 33792
    s_nop 0
    global_load_lds_dwordx4 v41, s[14:15]
    s_mov_b32 m0, 34816
    s_nop 0
    global_load_lds_dwordx4 v42, s[14:15]
    s_mov_b32 m0, 35840
    s_nop 0
    global_load_lds_dwordx4 v43, s[14:15]
    s_add_u32 s14, s60, 1048576
    s_addc_u32 s15, s61, 0
    s_mov_b32 m0, 49152
    s_nop 0
    global_load_lds_dwordx4 v40, s[14:15]
    s_mov_b32 m0, 50176
    s_nop 0
    global_load_lds_dwordx4 v41, s[14:15]
    s_mov_b32 m0, 51200
    s_nop 0
    global_load_lds_dwordx4 v42, s[14:15]
    s_mov_b32 m0, 52224
    s_nop 0
    global_load_lds_dwordx4 v43, s[14:15]
    s_add_u32 s14, s60, 1572864
    s_addc_u32 s15, s61, 0
    s_mov_b32 m0, 65536
    s_nop 0
    global_load_lds_dwordx4 v40, s[14:15]
    s_mov_b32 m0, 66560
    s_nop 0
    global_load_lds_dwordx4 v41, s[14:15]
    s_mov_b32 m0, 67584
    s_nop 0
    global_load_lds_dwordx4 v42, s[14:15]
    s_mov_b32 m0, 68608
    s_nop 0
    global_load_lds_dwordx4 v43, s[14:15]
    s_add_u32 s14, s60, 2097152
    s_addc_u32 s15, s61, 0
    s_mov_b32 m0, 81920
    s_nop 0
    global_load_lds_dwordx4 v40, s[14:15]
    s_mov_b32 m0, 82944
    s_nop 0
    global_load_lds_dwordx4 v41, s[14:15]
    s_mov_b32 m0, 83968
    s_nop 0
    global_load_lds_dwordx4 v42, s[14:15]
    s_mov_b32 m0, 84992
    s_nop 0
    global_load_lds_dwordx4 v43, s[14:15]
    s_add_u32 s14, s60, 2621440
    s_addc_u32 s15, s61, 0
    s_mov_b32 m0, 98304
    s_nop 0
    global_load_lds_dwordx4 v40, s[14:15]
    s_mov_b32 m0, 99328
    s_nop 0
    global_load_lds_dwordx4 v41, s[14:15]
    s_mov_b32 m0, 100352
    s_nop 0
    global_load_lds_dwordx4 v42, s[14:15]
    s_mov_b32 m0, 101376
    s_nop 0
    global_load_lds_dwordx4 v43, s[14:15]
    s_add_u32 s14, s60, 3145728
    s_addc_u32 s15, s61, 0
    s_mov_b32 m0, 114688
    s_nop 0
    global_load_lds_dwordx4 v40, s[14:15]
    s_mov_b32 m0, 115712
    s_nop 0
    global_load_lds_dwordx4 v41, s[14:15]
    s_mov_b32 m0, 116736
    s_nop 0
    global_load_lds_dwordx4 v42, s[14:15]
    s_mov_b32 m0, 117760
    s_nop 0
    global_load_lds_dwordx4 v43, s[14:15]
    s_add_u32 s14, s60, 3670016
    s_addc_u32 s15, s61, 0
    s_mov_b32 m0, 131072
    s_nop 0
    global_load_lds_dwordx4 v40, s[14:15]
    s_mov_b32 m0, 132096
    s_nop 0
    global_load_lds_dwordx4 v41, s[14:15]
    s_mov_b32 m0, 133120
    s_nop 0
    global_load_lds_dwordx4 v42, s[14:15]
    s_mov_b32 m0, 134144
    s_nop 0
    global_load_lds_dwordx4 v43, s[14:15]
    s_waitcnt vmcnt(28)
    s_barrier
    s_lshl_b32 s54, s10, 2
    s_add_u32 s54, s54, 32
    v_mov_b32 v30, s54
    v_mov_b32 v31, 1
    s_mov_b64 exec, 1
    global_atomic_add v30, v31, s[6:7] sc1
    s_mov_b64 exec, -1
    v_add_u32 v44, 16384, v52
    v_xor_b32 v45, 32, v44
    ds_read_b64_tr_b16 a[0:1], v44 offset:0
    ds_read_b64_tr_b16 a[2:3], v44 offset:512
    ds_read_b64_tr_b16 a[4:5], v44 offset:2048
    ds_read_b64_tr_b16 a[6:7], v44 offset:2560
    ds_read_b64_tr_b16 a[64:65], v45 offset:0
    ds_read_b64_tr_b16 a[66:67], v45 offset:512
    ds_read_b64_tr_b16 a[68:69], v45 offset:2048
    ds_read_b64_tr_b16 a[70:71], v45 offset:2560
    s_waitcnt lgkmcnt(0)
    s_barrier
    s_add_u32 s14, s62, 0
    s_addc_u32 s15, s63, 0
    s_mov_b32 m0, 16384
    s_nop 0
    global_load_lds_dwordx4 v40, s[14:15]
    s_mov_b32 m0, 17408
    s_nop 0
    global_load_lds_dwordx4 v41, s[14:15]
    s_mov_b32 m0, 18432
    s_nop 0
    global_load_lds_dwordx4 v42, s[14:15]
    s_mov_b32 m0, 19456
    s_nop 0
    global_load_lds_dwordx4 v43, s[14:15]
    s_waitcnt vmcnt(28)
    s_barrier
    v_add_u32 v44, 32768, v52
    v_xor_b32 v45, 32, v44
    ds_read_b64_tr_b16 a[8:9], v44 offset:0
    ds_read_b64_tr_b16 a[10:11], v44 offset:512
    ds_read_b64_tr_b16 a[12:13], v44 offset:2048
    ds_read_b64_tr_b16 a[14:15], v44 offset:2560
    ds_read_b64_tr_b16 a[72:73], v45 offset:0
    ds_read_b64_tr_b16 a[74:75], v45 offset:512
    ds_read_b64_tr_b16 a[76:77], v45 offset:2048
    ds_read_b64_tr_b16 a[78:79], v45 offset:2560
    s_waitcnt lgkmcnt(0)
    s_barrier
    s_add_u32 s14, s62, 524288
    s_addc_u32 s15, s63, 0
    s_mov_b32 m0, 32768
    s_nop 0
    global_load_lds_dwordx4 v40, s[14:15]
    s_mov_b32 m0, 33792
    s_nop 0
    global_load_lds_dwordx4 v41, s[14:15]
    s_mov_b32 m0, 34816
    s_nop 0
    global_load_lds_dwordx4 v42, s[14:15]
    s_mov_b32 m0, 35840
    s_nop 0
    global_load_lds_dwordx4 v43, s[14:15]
    s_waitcnt vmcnt(28)
    s_barrier
    v_add_u32 v44, 49152, v52
    v_xor_b32 v45, 32, v44
    ds_read_b64_tr_b16 a[16:17], v44 offset:0
    ds_read_b64_tr_b16 a[18:19], v44 offset:512
    ds_read_b64_tr_b16 a[20:21], v44 offset:2048
    ds_read_b64_tr_b16 a[22:23], v44 offset:2560
    ds_read_b64_tr_b16 a[80:81], v45 offset:0
    ds_read_b64_tr_b16 a[82:83], v45 offset:512
    ds_read_b64_tr_b16 a[84:85], v45 offset:2048
    ds_read_b64_tr_b16 a[86:87], v45 offset:2560
    s_waitcnt lgkmcnt(0)
    s_barrier
    s_add_u32 s14, s62, 1048576
    s_addc_u32 s15, s63, 0
    s_mov_b32 m0, 49152
    s_nop 0
    global_load_lds_dwordx4 v40, s[14:15]
    s_mov_b32 m0, 50176
    s_nop 0
    global_load_lds_dwordx4 v41, s[14:15]
    s_mov_b32 m0, 51200
    s_nop 0
    global_load_lds_dwordx4 v42, s[14:15]
    s_mov_b32 m0, 52224
    s_nop 0
    global_load_lds_dwordx4 v43, s[14:15]
    s_waitcnt vmcnt(28)
    s_barrier
    v_add_u32 v44, 65536, v52
    v_xor_b32 v45, 32, v44
    ds_read_b64_tr_b16 a[24:25], v44 offset:0
    ds_read_b64_tr_b16 a[26:27], v44 offset:512
    ds_read_b64_tr_b16 a[28:29], v44 offset:2048
    ds_read_b64_tr_b16 a[30:31], v44 offset:2560
    ds_read_b64_tr_b16 a[88:89], v45 offset:0
    ds_read_b64_tr_b16 a[90:91], v45 offset:512
    ds_read_b64_tr_b16 a[92:93], v45 offset:2048
    ds_read_b64_tr_b16 a[94:95], v45 offset:2560
    s_waitcnt lgkmcnt(0)
    s_barrier
    s_add_u32 s14, s62, 1572864
    s_addc_u32 s15, s63, 0
    s_mov_b32 m0, 65536
    s_nop 0
    global_load_lds_dwordx4 v40, s[14:15]
    s_mov_b32 m0, 66560
    s_nop 0
    global_load_lds_dwordx4 v41, s[14:15]
    s_mov_b32 m0, 67584
    s_nop 0
    global_load_lds_dwordx4 v42, s[14:15]
    s_mov_b32 m0, 68608
    s_nop 0
    global_load_lds_dwordx4 v43, s[14:15]
    s_waitcnt vmcnt(28)
    s_barrier
    v_add_u32 v44, 81920, v52
    v_xor_b32 v45, 32, v44
    ds_read_b64_tr_b16 a[32:33], v44 offset:0
    ds_read_b64_tr_b16 a[34:35], v44 offset:512
    ds_read_b64_tr_b16 a[36:37], v44 offset:2048
    ds_read_b64_tr_b16 a[38:39], v44 offset:2560
    ds_read_b64_tr_b16 a[96:97], v45 offset:0
    ds_read_b64_tr_b16 a[98:99], v45 offset:512
    ds_read_b64_tr_b16 a[100:101], v45 offset:2048
    ds_read_b64_tr_b16 a[102:103], v45 offset:2560
    s_waitcnt lgkmcnt(0)
    s_barrier
    s_add_u32 s14, s62, 2097152
    s_addc_u32 s15, s63, 0
    s_mov_b32 m0, 81920
    s_nop 0
    global_load_lds_dwordx4 v40, s[14:15]
    s_mov_b32 m0, 82944
    s_nop 0
    global_load_lds_dwordx4 v41, s[14:15]
    s_mov_b32 m0, 83968
    s_nop 0
    global_load_lds_dwordx4 v42, s[14:15]
    s_mov_b32 m0, 84992
    s_nop 0
    global_load_lds_dwordx4 v43, s[14:15]
    s_waitcnt vmcnt(28)
    s_barrier
    v_add_u32 v44, 98304, v52
    v_xor_b32 v45, 32, v44
    ds_read_b64_tr_b16 a[40:41], v44 offset:0
    ds_read_b64_tr_b16 a[42:43], v44 offset:512
    ds_read_b64_tr_b16 a[44:45], v44 offset:2048
    ds_read_b64_tr_b16 a[46:47], v44 offset:2560
    ds_read_b64_tr_b16 a[104:105], v45 offset:0
    ds_read_b64_tr_b16 a[106:107], v45 offset:512
    ds_read_b64_tr_b16 a[108:109], v45 offset:2048
    ds_read_b64_tr_b16 a[110:111], v45 offset:2560
    s_waitcnt lgkmcnt(0)
    s_barrier
    s_add_u32 s14, s62, 2621440
    s_addc_u32 s15, s63, 0
    s_mov_b32 m0, 98304
    s_nop 0
    global_load_lds_dwordx4 v40, s[14:15]
    s_mov_b32 m0, 99328
    s_nop 0
    global_load_lds_dwordx4 v41, s[14:15]
    s_mov_b32 m0, 100352
    s_nop 0
    global_load_lds_dwordx4 v42, s[14:15]
    s_mov_b32 m0, 101376
    s_nop 0
    global_load_lds_dwordx4 v43, s[14:15]
    s_waitcnt vmcnt(28)
    s_barrier
    v_add_u32 v44, 114688, v52
    v_xor_b32 v45, 32, v44
    ds_read_b64_tr_b16 a[48:49], v44 offset:0
    ds_read_b64_tr_b16 a[50:51], v44 offset:512
    ds_read_b64_tr_b16 a[52:53], v44 offset:2048
    ds_read_b64_tr_b16 a[54:55], v44 offset:2560
    ds_read_b64_tr_b16 a[112:113], v45 offset:0
    ds_read_b64_tr_b16 a[114:115], v45 offset:512
    ds_read_b64_tr_b16 a[116:117], v45 offset:2048
    ds_read_b64_tr_b16 a[118:119], v45 offset:2560
    s_waitcnt lgkmcnt(0)
    s_barrier
    s_add_u32 s14, s62, 3145728
    s_addc_u32 s15, s63, 0
    s_mov_b32 m0, 114688
    s_nop 0
    global_load_lds_dwordx4 v40, s[14:15]
    s_mov_b32 m0, 115712
    s_nop 0
    global_load_lds_dwordx4 v41, s[14:15]
    s_mov_b32 m0, 116736
    s_nop 0
    global_load_lds_dwordx4 v42, s[14:15]
    s_mov_b32 m0, 117760
    s_nop 0
    global_load_lds_dwordx4 v43, s[14:15]
    s_waitcnt vmcnt(28)
    s_barrier
    v_add_u32 v44, 131072, v52
    v_xor_b32 v45, 32, v44
    ds_read_b64_tr_b16 a[56:57], v44 offset:0
    ds_read_b64_tr_b16 a[58:59], v44 offset:512
    ds_read_b64_tr_b16 a[60:61], v44 offset:2048
    ds_read_b64_tr_b16 a[62:63], v44 offset:2560
    ds_read_b64_tr_b16 a[120:121], v45 offset:0
    ds_read_b64_tr_b16 a[122:123], v45 offset:512
    ds_read_b64_tr_b16 a[124:125], v45 offset:2048
    ds_read_b64_tr_b16 a[126:127], v45 offset:2560
    s_waitcnt lgkmcnt(0)
    s_barrier
    s_add_u32 s14, s62, 3670016
    s_addc_u32 s15, s63, 0
    s_mov_b32 m0, 131072
    s_nop 0
    global_load_lds_dwordx4 v40, s[14:15]
    s_mov_b32 m0, 132096
    s_nop 0
    global_load_lds_dwordx4 v41, s[14:15]
    s_mov_b32 m0, 133120
    s_nop 0
    global_load_lds_dwordx4 v42, s[14:15]
    s_mov_b32 m0, 134144
    s_nop 0
    global_load_lds_dwordx4 v43, s[14:15]
    s_waitcnt vmcnt(28)
    s_barrier
    v_add_u32 v44, 16384, v52
    v_xor_b32 v45, 32, v44
    ds_read_b64_tr_b16 a[128:129], v44 offset:0
    ds_read_b64_tr_b16 a[130:131], v44 offset:512
    ds_read_b64_tr_b16 a[132:133], v44 offset:2048
    ds_read_b64_tr_b16 a[134:135], v44 offset:2560
    ds_read_b64_tr_b16 a[192:193], v45 offset:0
    ds_read_b64_tr_b16 a[194:195], v45 offset:512
    ds_read_b64_tr_b16 a[196:197], v45 offset:2048
    ds_read_b64_tr_b16 a[198:199], v45 offset:2560
    s_waitcnt lgkmcnt(0)
    s_barrier
    s_add_u32 s14, s64, 0
    s_addc_u32 s15, s65, 0
    s_mov_b32 m0, 16384
    s_nop 0
    global_load_lds_dwordx4 v40, s[14:15]
    s_mov_b32 m0, 17408
    s_nop 0
    global_load_lds_dwordx4 v41, s[14:15]
    s_mov_b32 m0, 18432
    s_nop 0
    global_load_lds_dwordx4 v42, s[14:15]
    s_mov_b32 m0, 19456
    s_nop 0
    global_load_lds_dwordx4 v43, s[14:15]
    s_waitcnt vmcnt(28)
    s_barrier
    v_add_u32 v44, 32768, v52
    v_xor_b32 v45, 32, v44
    ds_read_b64_tr_b16 a[136:137], v44 offset:0
    ds_read_b64_tr_b16 a[138:139], v44 offset:512
    ds_read_b64_tr_b16 a[140:141], v44 offset:2048
    ds_read_b64_tr_b16 a[142:143], v44 offset:2560
    ds_read_b64_tr_b16 a[200:201], v45 offset:0
    ds_read_b64_tr_b16 a[202:203], v45 offset:512
    ds_read_b64_tr_b16 a[204:205], v45 offset:2048
    ds_read_b64_tr_b16 a[206:207], v45 offset:2560
    s_waitcnt lgkmcnt(0)
    s_barrier
    s_add_u32 s14, s64, 524288
    s_addc_u32 s15, s65, 0
    s_mov_b32 m0, 32768
    s_nop 0
    global_load_lds_dwordx4 v40, s[14:15]
    s_mov_b32 m0, 33792
    s_nop 0
    global_load_lds_dwordx4 v41, s[14:15]
    s_mov_b32 m0, 34816
    s_nop 0
    global_load_lds_dwordx4 v42, s[14:15]
    s_mov_b32 m0, 35840
    s_nop 0
    global_load_lds_dwordx4 v43, s[14:15]
    s_waitcnt vmcnt(28)
    s_barrier
    v_add_u32 v44, 49152, v52
    v_xor_b32 v45, 32, v44
    ds_read_b64_tr_b16 a[144:145], v44 offset:0
    ds_read_b64_tr_b16 a[146:147], v44 offset:512
    ds_read_b64_tr_b16 a[148:149], v44 offset:2048
    ds_read_b64_tr_b16 a[150:151], v44 offset:2560
    ds_read_b64_tr_b16 a[208:209], v45 offset:0
    ds_read_b64_tr_b16 a[210:211], v45 offset:512
    ds_read_b64_tr_b16 a[212:213], v45 offset:2048
    ds_read_b64_tr_b16 a[214:215], v45 offset:2560
    s_waitcnt lgkmcnt(0)
    s_barrier
    s_add_u32 s14, s64, 1048576
    s_addc_u32 s15, s65, 0
    s_mov_b32 m0, 49152
    s_nop 0
    global_load_lds_dwordx4 v40, s[14:15]
    s_mov_b32 m0, 50176
    s_nop 0
    global_load_lds_dwordx4 v41, s[14:15]
    s_mov_b32 m0, 51200
    s_nop 0
    global_load_lds_dwordx4 v42, s[14:15]
    s_mov_b32 m0, 52224
    s_nop 0
    global_load_lds_dwordx4 v43, s[14:15]
    s_waitcnt vmcnt(28)
    s_barrier
    v_add_u32 v44, 65536, v52
    v_xor_b32 v45, 32, v44
    ds_read_b64_tr_b16 a[152:153], v44 offset:0
    ds_read_b64_tr_b16 a[154:155], v44 offset:512
    ds_read_b64_tr_b16 a[156:157], v44 offset:2048
    ds_read_b64_tr_b16 a[158:159], v44 offset:2560
    ds_read_b64_tr_b16 a[216:217], v45 offset:0
    ds_read_b64_tr_b16 a[218:219], v45 offset:512
    ds_read_b64_tr_b16 a[220:221], v45 offset:2048
    ds_read_b64_tr_b16 a[222:223], v45 offset:2560
    s_waitcnt lgkmcnt(0)
    s_barrier
    s_add_u32 s14, s64, 1572864
    s_addc_u32 s15, s65, 0
    s_mov_b32 m0, 65536
    s_nop 0
    global_load_lds_dwordx4 v40, s[14:15]
    s_mov_b32 m0, 66560
    s_nop 0
    global_load_lds_dwordx4 v41, s[14:15]
    s_mov_b32 m0, 67584
    s_nop 0
    global_load_lds_dwordx4 v42, s[14:15]
    s_mov_b32 m0, 68608
    s_nop 0
    global_load_lds_dwordx4 v43, s[14:15]
    s_waitcnt vmcnt(28)
    s_barrier
    v_add_u32 v44, 81920, v52
    v_xor_b32 v45, 32, v44
    ds_read_b64_tr_b16 a[160:161], v44 offset:0
    ds_read_b64_tr_b16 a[162:163], v44 offset:512
    ds_read_b64_tr_b16 a[164:165], v44 offset:2048
    ds_read_b64_tr_b16 a[166:167], v44 offset:2560
    ds_read_b64_tr_b16 a[224:225], v45 offset:0
    ds_read_b64_tr_b16 a[226:227], v45 offset:512
    ds_read_b64_tr_b16 a[228:229], v45 offset:2048
    ds_read_b64_tr_b16 a[230:231], v45 offset:2560
    s_waitcnt lgkmcnt(0)
    s_barrier
    s_add_u32 s14, s64, 2097152
    s_addc_u32 s15, s65, 0
    s_mov_b32 m0, 81920
    s_nop 0
    global_load_lds_dwordx4 v40, s[14:15]
    s_mov_b32 m0, 82944
    s_nop 0
    global_load_lds_dwordx4 v41, s[14:15]
    s_mov_b32 m0, 83968
    s_nop 0
    global_load_lds_dwordx4 v42, s[14:15]
    s_mov_b32 m0, 84992
    s_nop 0
    global_load_lds_dwordx4 v43, s[14:15]
    s_waitcnt vmcnt(28)
    s_barrier
    v_add_u32 v44, 98304, v52
    v_xor_b32 v45, 32, v44
    ds_read_b64_tr_b16 a[168:169], v44 offset:0
    ds_read_b64_tr_b16 a[170:171], v44 offset:512
    ds_read_b64_tr_b16 a[172:173], v44 offset:2048
    ds_read_b64_tr_b16 a[174:175], v44 offset:2560
    ds_read_b64_tr_b16 a[232:233], v45 offset:0
    ds_read_b64_tr_b16 a[234:235], v45 offset:512
    ds_read_b64_tr_b16 a[236:237], v45 offset:2048
    ds_read_b64_tr_b16 a[238:239], v45 offset:2560
    s_waitcnt lgkmcnt(0)
    s_barrier
    s_add_u32 s14, s64, 2621440
    s_addc_u32 s15, s65, 0
    s_mov_b32 m0, 98304
    s_nop 0
    global_load_lds_dwordx4 v40, s[14:15]
    s_mov_b32 m0, 99328
    s_nop 0
    global_load_lds_dwordx4 v41, s[14:15]
    s_mov_b32 m0, 100352
    s_nop 0
    global_load_lds_dwordx4 v42, s[14:15]
    s_mov_b32 m0, 101376
    s_nop 0
    global_load_lds_dwordx4 v43, s[14:15]
    s_waitcnt vmcnt(28)
    s_barrier
    v_add_u32 v44, 114688, v52
    v_xor_b32 v45, 32, v44
    ds_read_b64_tr_b16 a[176:177], v44 offset:0
    ds_read_b64_tr_b16 a[178:179], v44 offset:512
    ds_read_b64_tr_b16 a[180:181], v44 offset:2048
    ds_read_b64_tr_b16 a[182:183], v44 offset:2560
    ds_read_b64_tr_b16 a[240:241], v45 offset:0
    ds_read_b64_tr_b16 a[242:243], v45 offset:512
    ds_read_b64_tr_b16 a[244:245], v45 offset:2048
    ds_read_b64_tr_b16 a[246:247], v45 offset:2560
    s_waitcnt lgkmcnt(0)
    s_barrier
    s_add_u32 s14, s64, 3145728
    s_addc_u32 s15, s65, 0
    s_mov_b32 m0, 114688
    s_nop 0
    global_load_lds_dwordx4 v40, s[14:15]
    s_mov_b32 m0, 115712
    s_nop 0
    global_load_lds_dwordx4 v41, s[14:15]
    s_mov_b32 m0, 116736
    s_nop 0
    global_load_lds_dwordx4 v42, s[14:15]
    s_mov_b32 m0, 117760
    s_nop 0
    global_load_lds_dwordx4 v43, s[14:15]
    s_waitcnt vmcnt(28)
    s_barrier
    v_add_u32 v44, 131072, v52
    v_xor_b32 v45, 32, v44
    ds_read_b64_tr_b16 a[184:185], v44 offset:0
    ds_read_b64_tr_b16 a[186:187], v44 offset:512
    ds_read_b64_tr_b16 a[188:189], v44 offset:2048
    ds_read_b64_tr_b16 a[190:191], v44 offset:2560
    ds_read_b64_tr_b16 a[248:249], v45 offset:0
    ds_read_b64_tr_b16 a[250:251], v45 offset:512
    ds_read_b64_tr_b16 a[252:253], v45 offset:2048
    ds_read_b64_tr_b16 a[254:255], v45 offset:2560
    s_waitcnt lgkmcnt(0)
    s_barrier
    s_add_u32 s14, s64, 3670016
    s_addc_u32 s15, s65, 0
    s_mov_b32 m0, 131072
    s_nop 0
    global_load_lds_dwordx4 v40, s[14:15]
    s_mov_b32 m0, 132096
    s_nop 0
    global_load_lds_dwordx4 v41, s[14:15]
    s_mov_b32 m0, 133120
    s_nop 0
    global_load_lds_dwordx4 v42, s[14:15]
    s_mov_b32 m0, 134144
    s_nop 0
    global_load_lds_dwordx4 v43, s[14:15]
    s_waitcnt vmcnt(28)
    s_barrier
    v_add_u32 v44, 16384, v52
    v_xor_b32 v45, 32, v44
    ds_read_b64_tr_b16 v[128:129], v44 offset:0
    ds_read_b64_tr_b16 v[130:131], v44 offset:512
    ds_read_b64_tr_b16 v[132:133], v44 offset:2048
    ds_read_b64_tr_b16 v[134:135], v44 offset:2560
    ds_read_b64_tr_b16 v[192:193], v45 offset:0
    ds_read_b64_tr_b16 v[194:195], v45 offset:512
    ds_read_b64_tr_b16 v[196:197], v45 offset:2048
    ds_read_b64_tr_b16 v[198:199], v45 offset:2560
    s_waitcnt lgkmcnt(0)
    s_barrier
    s_add_u32 s14, s66, 0
    s_addc_u32 s15, s67, 0
    v_xor_b32 v48, 0, v13
    s_mov_b32 m0, 16384
    s_nop 0
    global_load_lds_dwordx4 v48, s[14:15]
    s_add_u32 s14, s66, 1024
    s_addc_u32 s15, s67, 0
    v_xor_b32 v48, 32, v13
    s_mov_b32 m0, 17408
    s_nop 0
    global_load_lds_dwordx4 v48, s[14:15]
    s_add_u32 s14, s66, 2048
    s_addc_u32 s15, s67, 0
    v_xor_b32 v48, 0, v13
    s_mov_b32 m0, 18432
    s_nop 0
    global_load_lds_dwordx4 v48, s[14:15]
    s_add_u32 s14, s66, 3072
    s_addc_u32 s15, s67, 0
    v_xor_b32 v48, 32, v13
    s_mov_b32 m0, 19456
    s_nop 0
    global_load_lds_dwordx4 v48, s[14:15]
    s_waitcnt vmcnt(28)
    s_barrier
    v_add_u32 v44, 32768, v52
    v_xor_b32 v45, 32, v44
    ds_read_b64_tr_b16 v[136:137], v44 offset:0
    ds_read_b64_tr_b16 v[138:139], v44 offset:512
    ds_read_b64_tr_b16 v[140:141], v44 offset:2048
    ds_read_b64_tr_b16 v[142:143], v44 offset:2560
    ds_read_b64_tr_b16 v[200:201], v45 offset:0
    ds_read_b64_tr_b16 v[202:203], v45 offset:512
    ds_read_b64_tr_b16 v[204:205], v45 offset:2048
    ds_read_b64_tr_b16 v[206:207], v45 offset:2560
    s_waitcnt lgkmcnt(0)
    s_barrier
    s_add_u32 s14, s66, 16384
    s_addc_u32 s15, s67, 0
    v_xor_b32 v48, 64, v13
    s_mov_b32 m0, 32768
    s_nop 0
    global_load_lds_dwordx4 v48, s[14:15]
    s_add_u32 s14, s66, 17408
    s_addc_u32 s15, s67, 0
    v_xor_b32 v48, 96, v13
    s_mov_b32 m0, 33792
    s_nop 0
    global_load_lds_dwordx4 v48, s[14:15]
    s_add_u32 s14, s66, 18432
    s_addc_u32 s15, s67, 0
    v_xor_b32 v48, 64, v13
    s_mov_b32 m0, 34816
    s_nop 0
    global_load_lds_dwordx4 v48, s[14:15]
    s_add_u32 s14, s66, 19456
    s_addc_u32 s15, s67, 0
    v_xor_b32 v48, 96, v13
    s_mov_b32 m0, 35840
    s_nop 0
    global_load_lds_dwordx4 v48, s[14:15]
    s_waitcnt vmcnt(28)
    s_barrier
    v_add_u32 v44, 49152, v52
    v_xor_b32 v45, 32, v44
    ds_read_b64_tr_b16 v[56:57], v44 offset:0
    ds_read_b64_tr_b16 v[58:59], v44 offset:512
    ds_read_b64_tr_b16 v[60:61], v44 offset:2048
    ds_read_b64_tr_b16 v[62:63], v44 offset:2560
    ds_read_b64_tr_b16 v[64:65], v45 offset:0
    ds_read_b64_tr_b16 v[66:67], v45 offset:512
    ds_read_b64_tr_b16 v[68:69], v45 offset:2048
    ds_read_b64_tr_b16 v[70:71], v45 offset:2560
    s_waitcnt lgkmcnt(0)
    ds_write_b128 v55, v[56:59] offset:0
    ds_write_b128 v55, v[60:63] offset:1024
    ds_write_b128 v55, v[64:67] offset:2048
    ds_write_b128 v55, v[68:71] offset:3072
    s_waitcnt lgkmcnt(0)
    s_barrier
    s_add_u32 s14, s66, 32768
    s_addc_u32 s15, s67, 0
    v_xor_b32 v48, 128, v13
    s_mov_b32 m0, 49152
    s_nop 0
    global_load_lds_dwordx4 v48, s[14:15]
    s_add_u32 s14, s66, 33792
    s_addc_u32 s15, s67, 0
    v_xor_b32 v48, 160, v13
    s_mov_b32 m0, 50176
    s_nop 0
    global_load_lds_dwordx4 v48, s[14:15]
    s_add_u32 s14, s66, 34816
    s_addc_u32 s15, s67, 0
    v_xor_b32 v48, 128, v13
    s_mov_b32 m0, 51200
    s_nop 0
    global_load_lds_dwordx4 v48, s[14:15]
    s_add_u32 s14, s66, 35840
    s_addc_u32 s15, s67, 0
    v_xor_b32 v48, 160, v13
    s_mov_b32 m0, 52224
    s_nop 0
    global_load_lds_dwordx4 v48, s[14:15]
    s_waitcnt vmcnt(28)
    s_barrier
    v_add_u32 v44, 65536, v52
    v_xor_b32 v45, 32, v44
    ds_read_b64_tr_b16 v[56:57], v44 offset:0
    ds_read_b64_tr_b16 v[58:59], v44 offset:512
    ds_read_b64_tr_b16 v[60:61], v44 offset:2048
    ds_read_b64_tr_b16 v[62:63], v44 offset:2560
    ds_read_b64_tr_b16 v[64:65], v45 offset:0
    ds_read_b64_tr_b16 v[66:67], v45 offset:512
    ds_read_b64_tr_b16 v[68:69], v45 offset:2048
    ds_read_b64_tr_b16 v[70:71], v45 offset:2560
    s_waitcnt lgkmcnt(0)
    ds_write_b128 v55, v[56:59] offset:4096
    ds_write_b128 v55, v[60:63] offset:5120
    ds_write_b128 v55, v[64:67] offset:6144
    ds_write_b128 v55, v[68:71] offset:7168
    s_waitcnt lgkmcnt(0)
    s_barrier
    s_add_u32 s14, s66, 49152
    s_addc_u32 s15, s67, 0
    v_xor_b32 v48, 192, v13
    s_mov_b32 m0, 65536
    s_nop 0
    global_load_lds_dwordx4 v48, s[14:15]
    s_add_u32 s14, s66, 50176
    s_addc_u32 s15, s67, 0
    v_xor_b32 v48, 224, v13
    s_mov_b32 m0, 66560
    s_nop 0
    global_load_lds_dwordx4 v48, s[14:15]
    s_add_u32 s14, s66, 51200
    s_addc_u32 s15, s67, 0
    v_xor_b32 v48, 192, v13
    s_mov_b32 m0, 67584
    s_nop 0
    global_load_lds_dwordx4 v48, s[14:15]
    s_add_u32 s14, s66, 52224
    s_addc_u32 s15, s67, 0
    v_xor_b32 v48, 224, v13
    s_mov_b32 m0, 68608
    s_nop 0
    global_load_lds_dwordx4 v48, s[14:15]
    s_waitcnt vmcnt(28)
    s_barrier
    v_add_u32 v44, 81920, v52
    v_xor_b32 v45, 32, v44
    ds_read_b64_tr_b16 v[160:161], v44 offset:0
    ds_read_b64_tr_b16 v[162:163], v44 offset:512
    ds_read_b64_tr_b16 v[164:165], v44 offset:2048
    ds_read_b64_tr_b16 v[166:167], v44 offset:2560
    ds_read_b64_tr_b16 v[224:225], v45 offset:0
    ds_read_b64_tr_b16 v[226:227], v45 offset:512
    ds_read_b64_tr_b16 v[228:229], v45 offset:2048
    ds_read_b64_tr_b16 v[230:231], v45 offset:2560
    s_waitcnt lgkmcnt(0)
    s_barrier
    s_add_u32 s14, s66, 65536
    s_addc_u32 s15, s67, 0
    v_xor_b32 v48, 0, v13
    s_mov_b32 m0, 81920
    s_nop 0
    global_load_lds_dwordx4 v48, s[14:15]
    s_add_u32 s14, s66, 66560
    s_addc_u32 s15, s67, 0
    v_xor_b32 v48, 32, v13
    s_mov_b32 m0, 82944
    s_nop 0
    global_load_lds_dwordx4 v48, s[14:15]
    s_add_u32 s14, s66, 67584
    s_addc_u32 s15, s67, 0
    v_xor_b32 v48, 0, v13
    s_mov_b32 m0, 83968
    s_nop 0
    global_load_lds_dwordx4 v48, s[14:15]
    s_add_u32 s14, s66, 68608
    s_addc_u32 s15, s67, 0
    v_xor_b32 v48, 32, v13
    s_mov_b32 m0, 84992
    s_nop 0
    global_load_lds_dwordx4 v48, s[14:15]
    s_waitcnt vmcnt(28)
    s_barrier
    v_add_u32 v44, 98304, v52
    v_xor_b32 v45, 32, v44
    ds_read_b64_tr_b16 v[168:169], v44 offset:0
    ds_read_b64_tr_b16 v[170:171], v44 offset:512
    ds_read_b64_tr_b16 v[172:173], v44 offset:2048
    ds_read_b64_tr_b16 v[174:175], v44 offset:2560
    ds_read_b64_tr_b16 v[232:233], v45 offset:0
    ds_read_b64_tr_b16 v[234:235], v45 offset:512
    ds_read_b64_tr_b16 v[236:237], v45 offset:2048
    ds_read_b64_tr_b16 v[238:239], v45 offset:2560
    s_waitcnt lgkmcnt(0)
    s_barrier
    s_add_u32 s14, s66, 81920
    s_addc_u32 s15, s67, 0
    v_xor_b32 v48, 64, v13
    s_mov_b32 m0, 98304
    s_nop 0
    global_load_lds_dwordx4 v48, s[14:15]
    s_add_u32 s14, s66, 82944
    s_addc_u32 s15, s67, 0
    v_xor_b32 v48, 96, v13
    s_mov_b32 m0, 99328
    s_nop 0
    global_load_lds_dwordx4 v48, s[14:15]
    s_add_u32 s14, s66, 83968
    s_addc_u32 s15, s67, 0
    v_xor_b32 v48, 64, v13
    s_mov_b32 m0, 100352
    s_nop 0
    global_load_lds_dwordx4 v48, s[14:15]
    s_add_u32 s14, s66, 84992
    s_addc_u32 s15, s67, 0
    v_xor_b32 v48, 96, v13
    s_mov_b32 m0, 101376
    s_nop 0
    global_load_lds_dwordx4 v48, s[14:15]
    s_waitcnt vmcnt(28)
    s_barrier
    v_add_u32 v44, 114688, v52
    v_xor_b32 v45, 32, v44
    ds_read_b64_tr_b16 v[176:177], v44 offset:0
    ds_read_b64_tr_b16 v[178:179], v44 offset:512
    ds_read_b64_tr_b16 v[180:181], v44 offset:2048
    ds_read_b64_tr_b16 v[182:183], v44 offset:2560
    ds_read_b64_tr_b16 v[240:241], v45 offset:0
    ds_read_b64_tr_b16 v[242:243], v45 offset:512
    ds_read_b64_tr_b16 v[244:245], v45 offset:2048
    ds_read_b64_tr_b16 v[246:247], v45 offset:2560
    s_waitcnt lgkmcnt(0)
    s_barrier
    s_add_u32 s14, s66, 98304
    s_addc_u32 s15, s67, 0
    v_xor_b32 v48, 128, v13
    s_mov_b32 m0, 114688
    s_nop 0
    global_load_lds_dwordx4 v48, s[14:15]
    s_add_u32 s14, s66, 99328
    s_addc_u32 s15, s67, 0
    v_xor_b32 v48, 160, v13
    s_mov_b32 m0, 115712
    s_nop 0
    global_load_lds_dwordx4 v48, s[14:15]
    s_add_u32 s14, s66, 100352
    s_addc_u32 s15, s67, 0
    v_xor_b32 v48, 128, v13
    s_mov_b32 m0, 116736
    s_nop 0
    global_load_lds_dwordx4 v48, s[14:15]
    s_add_u32 s14, s66, 101376
    s_addc_u32 s15, s67, 0
    v_xor_b32 v48, 160, v13
    s_mov_b32 m0, 117760
    s_nop 0
    global_load_lds_dwordx4 v48, s[14:15]
    s_waitcnt vmcnt(28)
    s_barrier
    v_add_u32 v44, 131072, v52
    v_xor_b32 v45, 32, v44
    ds_read_b64_tr_b16 v[184:185], v44 offset:0
    ds_read_b64_tr_b16 v[186:187], v44 offset:512
    ds_read_b64_tr_b16 v[188:189], v44 offset:2048
    ds_read_b64_tr_b16 v[190:191], v44 offset:2560
    ds_read_b64_tr_b16 v[248:249], v45 offset:0
    ds_read_b64_tr_b16 v[250:251], v45 offset:512
    ds_read_b64_tr_b16 v[252:253], v45 offset:2048
    ds_read_b64_tr_b16 v[254:255], v45 offset:2560
    s_waitcnt lgkmcnt(0)
    s_barrier
    s_add_u32 s14, s66, 114688
    s_addc_u32 s15, s67, 0
    v_xor_b32 v48, 192, v13
    s_mov_b32 m0, 131072
    s_nop 0
    global_load_lds_dwordx4 v48, s[14:15]
    s_add_u32 s14, s66, 115712
    s_addc_u32 s15, s67, 0
    v_xor_b32 v48, 224, v13
    s_mov_b32 m0, 132096
    s_nop 0
    global_load_lds_dwordx4 v48, s[14:15]
    s_add_u32 s14, s66, 116736
    s_addc_u32 s15, s67, 0
    v_xor_b32 v48, 192, v13
    s_mov_b32 m0, 133120
    s_nop 0
    global_load_lds_dwordx4 v48, s[14:15]
    s_add_u32 s14, s66, 117760
    s_addc_u32 s15, s67, 0
    v_xor_b32 v48, 224, v13
    s_mov_b32 m0, 134144
    s_nop 0
    global_load_lds_dwordx4 v48, s[14:15]
    s_waitcnt vmcnt(0)
    s_barrier
    v_xor_b32 v54, 96, v53
    ds_read_b64_tr_b16 v[112:113], v54 offset:0
    ds_read_b64_tr_b16 v[114:115], v54 offset:2048
    ds_read_b64_tr_b16 v[116:117], v54 offset:8192
    ds_read_b64_tr_b16 v[118:119], v54 offset:10240
    v_xor_b32 v54, 128, v53
    ds_read_b64_tr_b16 v[144:145], v54 offset:0
    ds_read_b64_tr_b16 v[146:147], v54 offset:2048
    ds_read_b64_tr_b16 v[148:149], v54 offset:8192
    ds_read_b64_tr_b16 v[150:151], v54 offset:10240
    v_xor_b32 v54, 160, v53
    ds_read_b64_tr_b16 v[208:209], v54 offset:0
    ds_read_b64_tr_b16 v[210:211], v54 offset:2048
    ds_read_b64_tr_b16 v[212:213], v54 offset:8192
    ds_read_b64_tr_b16 v[214:215], v54 offset:10240
    v_xor_b32 v54, 0, v53
    ds_read_b64_tr_b16 v[56:57], v54 offset:0
    ds_read_b64_tr_b16 v[58:59], v54 offset:2048
    ds_read_b64_tr_b16 v[60:61], v54 offset:8192
    ds_read_b64_tr_b16 v[62:63], v54 offset:10240
    v_xor_b32 v54, 32, v53
    ds_read_b64_tr_b16 v[64:65], v54 offset:0
    ds_read_b64_tr_b16 v[66:67], v54 offset:2048
    ds_read_b64_tr_b16 v[68:69], v54 offset:8192
    ds_read_b64_tr_b16 v[70:71], v54 offset:10240
    v_xor_b32 v54, 64, v53
    ds_read_b64_tr_b16 v[72:73], v54 offset:0
    ds_read_b64_tr_b16 v[74:75], v54 offset:2048
    ds_read_b64_tr_b16 v[76:77], v54 offset:8192
    ds_read_b64_tr_b16 v[78:79], v54 offset:10240
    v_xor_b32 v54, 192, v53
    ds_read_b64_tr_b16 v[80:81], v54 offset:0
    ds_read_b64_tr_b16 v[82:83], v54 offset:2048
    ds_read_b64_tr_b16 v[84:85], v54 offset:8192
    ds_read_b64_tr_b16 v[86:87], v54 offset:10240
    v_xor_b32 v54, 224, v53
    ds_read_b64_tr_b16 v[88:89], v54 offset:0
    ds_read_b64_tr_b16 v[90:91], v54 offset:2048
    ds_read_b64_tr_b16 v[92:93], v54 offset:8192
    ds_read_b64_tr_b16 v[94:95], v54 offset:10240
    s_waitcnt lgkmcnt(0)
    s_barrier
    ds_write_b128 v14, v[56:59] offset:0
    ds_write_b128 v14, v[60:63] offset:1024
    ds_write_b128 v14, v[64:67] offset:2048
    ds_write_b128 v14, v[68:71] offset:3072
    ds_write_b128 v14, v[72:75] offset:4096
    ds_write_b128 v14, v[76:79] offset:5120
    ds_write_b128 v14, v[80:83] offset:6144
    ds_write_b128 v14, v[84:87] offset:7168
    ds_write_b128 v14, v[88:91] offset:8192
    ds_write_b128 v14, v[92:95] offset:9216
    s_waitcnt lgkmcnt(0)
    v_xor_b32 v54, 96, v53
    v_add_u32 v54, 65536, v54
    ds_read_b64_tr_b16 v[120:121], v54 offset:0
    ds_read_b64_tr_b16 v[122:123], v54 offset:2048
    ds_read_b64_tr_b16 v[124:125], v54 offset:8192
    ds_read_b64_tr_b16 v[126:127], v54 offset:10240
    v_xor_b32 v54, 128, v53
    v_add_u32 v54, 65536, v54
    ds_read_b64_tr_b16 v[152:153], v54 offset:0
    ds_read_b64_tr_b16 v[154:155], v54 offset:2048
    ds_read_b64_tr_b16 v[156:157], v54 offset:8192
    ds_read_b64_tr_b16 v[158:159], v54 offset:10240
    v_xor_b32 v54, 160, v53
    v_add_u32 v54, 65536, v54
    ds_read_b64_tr_b16 v[216:217], v54 offset:0
    ds_read_b64_tr_b16 v[218:219], v54 offset:2048
    ds_read_b64_tr_b16 v[220:221], v54 offset:8192
    ds_read_b64_tr_b16 v[222:223], v54 offset:10240
    v_xor_b32 v54, 0, v53
    v_add_u32 v54, 65536, v54
    ds_read_b64_tr_b16 v[56:57], v54 offset:0
    ds_read_b64_tr_b16 v[58:59], v54 offset:2048
    ds_read_b64_tr_b16 v[60:61], v54 offset:8192
    ds_read_b64_tr_b16 v[62:63], v54 offset:10240
    v_xor_b32 v54, 32, v53
    v_add_u32 v54, 65536, v54
    ds_read_b64_tr_b16 v[64:65], v54 offset:0
    ds_read_b64_tr_b16 v[66:67], v54 offset:2048
    ds_read_b64_tr_b16 v[68:69], v54 offset:8192
    ds_read_b64_tr_b16 v[70:71], v54 offset:10240
    v_xor_b32 v54, 64, v53
    v_add_u32 v54, 65536, v54
    ds_read_b64_tr_b16 v[72:73], v54 offset:0
    ds_read_b64_tr_b16 v[74:75], v54 offset:2048
    ds_read_b64_tr_b16 v[76:77], v54 offset:8192
    ds_read_b64_tr_b16 v[78:79], v54 offset:10240
    v_xor_b32 v54, 192, v53
    v_add_u32 v54, 65536, v54
    ds_read_b64_tr_b16 v[80:81], v54 offset:0
    ds_read_b64_tr_b16 v[82:83], v54 offset:2048
    ds_read_b64_tr_b16 v[84:85], v54 offset:8192
    ds_read_b64_tr_b16 v[86:87], v54 offset:10240
    v_xor_b32 v54, 224, v53
    v_add_u32 v54, 65536, v54
    ds_read_b64_tr_b16 v[88:89], v54 offset:0
    ds_read_b64_tr_b16 v[90:91], v54 offset:2048
    ds_read_b64_tr_b16 v[92:93], v54 offset:8192
    ds_read_b64_tr_b16 v[94:95], v54 offset:10240
    s_waitcnt lgkmcnt(0)
    s_barrier
    ds_write_b128 v15, v[56:59] offset:0
    ds_write_b128 v15, v[60:63] offset:1024
    ds_write_b128 v15, v[64:67] offset:2048
    ds_write_b128 v15, v[68:71] offset:3072
    ds_write_b128 v15, v[72:75] offset:4096
    ds_write_b128 v15, v[76:79] offset:5120
    ds_write_b128 v15, v[80:83] offset:6144
    ds_write_b128 v15, v[84:87] offset:7168
    ds_write_b128 v15, v[88:91] offset:8192
    ds_write_b128 v15, v[92:95] offset:9216
    s_waitcnt lgkmcnt(0)
    ds_read_b128 v[56:59], v55 offset:0
    ds_read_b128 v[60:63], v55 offset:1024
    ds_read_b128 v[64:67], v55 offset:2048
    ds_read_b128 v[68:71], v55 offset:3072
    ds_read_b128 v[72:75], v55 offset:4096
    ds_read_b128 v[76:79], v55 offset:5120
    ds_read_b128 v[80:83], v55 offset:6144
    ds_read_b128 v[84:87], v55 offset:7168
    v_add_u32 v54, 98304, v13
    s_waitcnt lgkmcnt(0)
    ds_write_b128 v54, v[56:59] offset:0
    ds_write_b128 v54, v[60:63] offset:1024
    ds_write_b128 v54, v[64:67] offset:2048
    ds_write_b128 v54, v[68:71] offset:3072
    ds_write_b128 v54, v[72:75] offset:4096
    ds_write_b128 v54, v[76:79] offset:5120
    ds_write_b128 v54, v[80:83] offset:6144
    ds_write_b128 v54, v[84:87] offset:7168
    s_waitcnt lgkmcnt(0)
    s_branch L_wdone_2
L_w1_4:
    v_lshrrev_b32 v46, 4, v0
    v_and_b32 v47, 1, v46
    v_or_b32 v47, 2, v47
    v_lshlrev_b32 v47, 1, v47
    v_and_b32 v48, 15, v0
    v_xor_b32 v48, v48, v47
    v_lshlrev_b32 v48, 4, v48
    v_add_u32 v46, 16, v46
    v_lshlrev_b32 v46, 13, v46
    v_add_u32 v40, v46, v48
    v_add_u32 v41, 32768, v40
    v_add_u32 v42, 65536, v40
    v_add_u32 v43, 98304, v40
    v_bfe_u32 v46, v0, 3, 1
    v_bfe_u32 v47, v0, 4, 1
    v_bfe_u32 v48, v0, 2, 1
    v_lshlrev_b32 v49, 2, v46
    v_lshl_or_b32 v49, v47, 1, v49
    v_or_b32 v49, v49, v48
    v_lshlrev_b32 v50, 5, v46
    v_lshl_or_b32 v50, v47, 4, v50
    v_or_b32 v50, v50, v48
    v_bfe_u32 v51, v0, 5, 1
    v_lshl_or_b32 v50, v51, 2, v50
    v_and_b32 v51, 3, v0
    v_lshlrev_b32 v51, 3, v51
    v_xor_b32 v52, 2, v49
    v_lshlrev_b32 v52, 5, v52
    v_lshl_or_b32 v52, v50, 8, v52
    v_add_u32 v52, v52, v51
    v_lshlrev_b32 v53, 5, v49
    v_lshl_or_b32 v53, v50, 10, v53
    v_add_u32 v53, v53, v51
    v_add_u32 v53, 16640, v53
    v_add_u32 v55, 8192, v13
    s_add_u32 s14, s60, 0
    s_addc_u32 s15, s61, 0
    s_mov_b32 m0, 20480
    s_nop 0
    global_load_lds_dwordx4 v40, s[14:15]
    s_mov_b32 m0, 21504
    s_nop 0
    global_load_lds_dwordx4 v41, s[14:15]
    s_mov_b32 m0, 22528
    s_nop 0
    global_load_lds_dwordx4 v42, s[14:15]
    s_mov_b32 m0, 23552
    s_nop 0
    global_load_lds_dwordx4 v43, s[14:15]
    s_add_u32 s14, s60, 524288
    s_addc_u32 s15, s61, 0
    s_mov_b32 m0, 36864
    s_nop 0
    global_load_lds_dwordx4 v40, s[14:15]
    s_mov_b32 m0, 37888
    s_nop 0
    global_load_lds_dwordx4 v41, s[14:15]
    s_mov_b32 m0, 38912
    s_nop 0
    global_load_lds_dwordx4 v42, s[14:15]
    s_mov_b32 m0, 39936
    s_nop 0
    global_load_lds_dwordx4 v43, s[14:15]
    s_add_u32 s14, s60, 1048576
    s_addc_u32 s15, s61, 0
    s_mov_b32 m0, 53248
    s_nop 0
    global_load_lds_dwordx4 v40, s[14:15]
    s_mov_b32 m0, 54272
    s_nop 0
    global_load_lds_dwordx4 v41, s[14:15]
    s_mov_b32 m0, 55296
    s_nop 0
    global_load_lds_dwordx4 v42, s[14:15]
    s_mov_b32 m0, 56320
    s_nop 0
    global_load_lds_dwordx4 v43, s[14:15]
    s_add_u32 s14, s60, 1572864
    s_addc_u32 s15, s61, 0
    s_mov_b32 m0, 69632
    s_nop 0
    global_load_lds_dwordx4 v40, s[14:15]
    s_mov_b32 m0, 70656
    s_nop 0
    global_load_lds_dwordx4 v41, s[14:15]
    s_mov_b32 m0, 71680
    s_nop 0
    global_load_lds_dwordx4 v42, s[14:15]
    s_mov_b32 m0, 72704
    s_nop 0
    global_load_lds_dwordx4 v43, s[14:15]
    s_add_u32 s14, s60, 2097152
    s_addc_u32 s15, s61, 0
    s_mov_b32 m0, 86016
    s_nop 0
    global_load_lds_dwordx4 v40, s[14:15]
    s_mov_b32 m0, 87040
    s_nop 0
    global_load_lds_dwordx4 v41, s[14:15]
    s_mov_b32 m0, 88064
    s_nop 0
    global_load_lds_dwordx4 v42, s[14:15]
    s_mov_b32 m0, 89088
    s_nop 0
    global_load_lds_dwordx4 v43, s[14:15]
    s_add_u32 s14, s60, 2621440
    s_addc_u32 s15, s61, 0
    s_mov_b32 m0, 102400
    s_nop 0
    global_load_lds_dwordx4 v40, s[14:15]
    s_mov_b32 m0, 103424
    s_nop 0
    global_load_lds_dwordx4 v41, s[14:15]
    s_mov_b32 m0, 104448
    s_nop 0
    global_load_lds_dwordx4 v42, s[14:15]
    s_mov_b32 m0, 105472
    s_nop 0
    global_load_lds_dwordx4 v43, s[14:15]
    s_add_u32 s14, s60, 3145728
    s_addc_u32 s15, s61, 0
    s_mov_b32 m0, 118784
    s_nop 0
    global_load_lds_dwordx4 v40, s[14:15]
    s_mov_b32 m0, 119808
    s_nop 0
    global_load_lds_dwordx4 v41, s[14:15]
    s_mov_b32 m0, 120832
    s_nop 0
    global_load_lds_dwordx4 v42, s[14:15]
    s_mov_b32 m0, 121856
    s_nop 0
    global_load_lds_dwordx4 v43, s[14:15]
    s_add_u32 s14, s60, 3670016
    s_addc_u32 s15, s61, 0
    s_mov_b32 m0, 135168
    s_nop 0
    global_load_lds_dwordx4 v40, s[14:15]
    s_mov_b32 m0, 136192
    s_nop 0
    global_load_lds_dwordx4 v41, s[14:15]
    s_mov_b32 m0, 137216
    s_nop 0
    global_load_lds_dwordx4 v42, s[14:15]
    s_mov_b32 m0, 138240
    s_nop 0
    global_load_lds_dwordx4 v43, s[14:15]
    s_waitcnt vmcnt(28)
    s_barrier
    v_add_u32 v44, 16384, v52
    v_xor_b32 v45, 32, v44
    ds_read_b64_tr_b16 a[48:49], v44 offset:0
    ds_read_b64_tr_b16 a[50:51], v44 offset:512
    ds_read_b64_tr_b16 a[52:53], v44 offset:2048
    ds_read_b64_tr_b16 a[54:55], v44 offset:2560
    ds_read_b64_tr_b16 a[112:113], v45 offset:0
    ds_read_b64_tr_b16 a[114:115], v45 offset:512
    ds_read_b64_tr_b16 a[116:117], v45 offset:2048
    ds_read_b64_tr_b16 a[118:119], v45 offset:2560
    s_waitcnt lgkmcnt(0)
    s_barrier
    s_add_u32 s14, s62, 0
    s_addc_u32 s15, s63, 0
    s_mov_b32 m0, 20480
    s_nop 0
    global_load_lds_dwordx4 v40, s[14:15]
    s_mov_b32 m0, 21504
    s_nop 0
    global_load_lds_dwordx4 v41, s[14:15]
    s_mov_b32 m0, 22528
    s_nop 0
    global_load_lds_dwordx4 v42, s[14:15]
    s_mov_b32 m0, 23552
    s_nop 0
    global_load_lds_dwordx4 v43, s[14:15]
    s_waitcnt vmcnt(28)
    s_barrier
    v_add_u32 v44, 32768, v52
    v_xor_b32 v45, 32, v44
    ds_read_b64_tr_b16 a[56:57], v44 offset:0
    ds_read_b64_tr_b16 a[58:59], v44 offset:512
    ds_read_b64_tr_b16 a[60:61], v44 offset:2048
    ds_read_b64_tr_b16 a[62:63], v44 offset:2560
    ds_read_b64_tr_b16 a[120:121], v45 offset:0
    ds_read_b64_tr_b16 a[122:123], v45 offset:512
    ds_read_b64_tr_b16 a[124:125], v45 offset:2048
    ds_read_b64_tr_b16 a[126:127], v45 offset:2560
    s_waitcnt lgkmcnt(0)
    s_barrier
    s_add_u32 s14, s62, 524288
    s_addc_u32 s15, s63, 0
    s_mov_b32 m0, 36864
    s_nop 0
    global_load_lds_dwordx4 v40, s[14:15]
    s_mov_b32 m0, 37888
    s_nop 0
    global_load_lds_dwordx4 v41, s[14:15]
    s_mov_b32 m0, 38912
    s_nop 0
    global_load_lds_dwordx4 v42, s[14:15]
    s_mov_b32 m0, 39936
    s_nop 0
    global_load_lds_dwordx4 v43, s[14:15]
    s_waitcnt vmcnt(28)
    s_barrier
    v_add_u32 v44, 49152, v52
    v_xor_b32 v45, 32, v44
    ds_read_b64_tr_b16 a[0:1], v44 offset:0
    ds_read_b64_tr_b16 a[2:3], v44 offset:512
    ds_read_b64_tr_b16 a[4:5], v44 offset:2048
    ds_read_b64_tr_b16 a[6:7], v44 offset:2560
    ds_read_b64_tr_b16 a[64:65], v45 offset:0
    ds_read_b64_tr_b16 a[66:67], v45 offset:512
    ds_read_b64_tr_b16 a[68:69], v45 offset:2048
    ds_read_b64_tr_b16 a[70:71], v45 offset:2560
    s_waitcnt lgkmcnt(0)
    s_barrier
    s_add_u32 s14, s62, 1048576
    s_addc_u32 s15, s63, 0
    s_mov_b32 m0, 53248
    s_nop 0
    global_load_lds_dwordx4 v40, s[14:15]
    s_mov_b32 m0, 54272
    s_nop 0
    global_load_lds_dwordx4 v41, s[14:15]
    s_mov_b32 m0, 55296
    s_nop 0
    global_load_lds_dwordx4 v42, s[14:15]
    s_mov_b32 m0, 56320
    s_nop 0
    global_load_lds_dwordx4 v43, s[14:15]
    s_waitcnt vmcnt(28)
    s_barrier
    v_add_u32 v44, 65536, v52
    v_xor_b32 v45, 32, v44
    ds_read_b64_tr_b16 a[8:9], v44 offset:0
    ds_read_b64_tr_b16 a[10:11], v44 offset:512
    ds_read_b64_tr_b16 a[12:13], v44 offset:2048
    ds_read_b64_tr_b16 a[14:15], v44 offset:2560
    ds_read_b64_tr_b16 a[72:73], v45 offset:0
    ds_read_b64_tr_b16 a[74:75], v45 offset:512
    ds_read_b64_tr_b16 a[76:77], v45 offset:2048
    ds_read_b64_tr_b16 a[78:79], v45 offset:2560
    s_waitcnt lgkmcnt(0)
    s_barrier
    s_add_u32 s14, s62, 1572864
    s_addc_u32 s15, s63, 0
    s_mov_b32 m0, 69632
    s_nop 0
    global_load_lds_dwordx4 v40, s[14:15]
    s_mov_b32 m0, 70656
    s_nop 0
    global_load_lds_dwordx4 v41, s[14:15]
    s_mov_b32 m0, 71680
    s_nop 0
    global_load_lds_dwordx4 v42, s[14:15]
    s_mov_b32 m0, 72704
    s_nop 0
    global_load_lds_dwordx4 v43, s[14:15]
    s_waitcnt vmcnt(28)
    s_barrier
    v_add_u32 v44, 81920, v52
    v_xor_b32 v45, 32, v44
    ds_read_b64_tr_b16 a[16:17], v44 offset:0
    ds_read_b64_tr_b16 a[18:19], v44 offset:512
    ds_read_b64_tr_b16 a[20:21], v44 offset:2048
    ds_read_b64_tr_b16 a[22:23], v44 offset:2560
    ds_read_b64_tr_b16 a[80:81], v45 offset:0
    ds_read_b64_tr_b16 a[82:83], v45 offset:512
    ds_read_b64_tr_b16 a[84:85], v45 offset:2048
    ds_read_b64_tr_b16 a[86:87], v45 offset:2560
    s_waitcnt lgkmcnt(0)
    s_barrier
    s_add_u32 s14, s62, 2097152
    s_addc_u32 s15, s63, 0
    s_mov_b32 m0, 86016
    s_nop 0
    global_load_lds_dwordx4 v40, s[14:15]
    s_mov_b32 m0, 87040
    s_nop 0
    global_load_lds_dwordx4 v41, s[14:15]
    s_mov_b32 m0, 88064
    s_nop 0
    global_load_lds_dwordx4 v42, s[14:15]
    s_mov_b32 m0, 89088
    s_nop 0
    global_load_lds_dwordx4 v43, s[14:15]
    s_waitcnt vmcnt(28)
    s_barrier
    v_add_u32 v44, 98304, v52
    v_xor_b32 v45, 32, v44
    ds_read_b64_tr_b16 a[24:25], v44 offset:0
    ds_read_b64_tr_b16 a[26:27], v44 offset:512
    ds_read_b64_tr_b16 a[28:29], v44 offset:2048
    ds_read_b64_tr_b16 a[30:31], v44 offset:2560
    ds_read_b64_tr_b16 a[88:89], v45 offset:0
    ds_read_b64_tr_b16 a[90:91], v45 offset:512
    ds_read_b64_tr_b16 a[92:93], v45 offset:2048
    ds_read_b64_tr_b16 a[94:95], v45 offset:2560
    s_waitcnt lgkmcnt(0)
    s_barrier
    s_add_u32 s14, s62, 2621440
    s_addc_u32 s15, s63, 0
    s_mov_b32 m0, 102400
    s_nop 0
    global_load_lds_dwordx4 v40, s[14:15]
    s_mov_b32 m0, 103424
    s_nop 0
    global_load_lds_dwordx4 v41, s[14:15]
    s_mov_b32 m0, 104448
    s_nop 0
    global_load_lds_dwordx4 v42, s[14:15]
    s_mov_b32 m0, 105472
    s_nop 0
    global_load_lds_dwordx4 v43, s[14:15]
    s_waitcnt vmcnt(28)
    s_barrier
    v_add_u32 v44, 114688, v52
    v_xor_b32 v45, 32, v44
    ds_read_b64_tr_b16 a[32:33], v44 offset:0
    ds_read_b64_tr_b16 a[34:35], v44 offset:512
    ds_read_b64_tr_b16 a[36:37], v44 offset:2048
    ds_read_b64_tr_b16 a[38:39], v44 offset:2560
    ds_read_b64_tr_b16 a[96:97], v45 offset:0
    ds_read_b64_tr_b16 a[98:99], v45 offset:512
    ds_read_b64_tr_b16 a[100:101], v45 offset:2048
    ds_read_b64_tr_b16 a[102:103], v45 offset:2560
    s_waitcnt lgkmcnt(0)
    s_barrier
    s_add_u32 s14, s62, 3145728
    s_addc_u32 s15, s63, 0
    s_mov_b32 m0, 118784
    s_nop 0
    global_load_lds_dwordx4 v40, s[14:15]
    s_mov_b32 m0, 119808
    s_nop 0
    global_load_lds_dwordx4 v41, s[14:15]
    s_mov_b32 m0, 120832
    s_nop 0
    global_load_lds_dwordx4 v42, s[14:15]
    s_mov_b32 m0, 121856
    s_nop 0
    global_load_lds_dwordx4 v43, s[14:15]
    s_waitcnt vmcnt(28)
    s_barrier
    v_add_u32 v44, 131072, v52
    v_xor_b32 v45, 32, v44
    ds_read_b64_tr_b16 a[40:41], v44 offset:0
    ds_read_b64_tr_b16 a[42:43], v44 offset:512
    ds_read_b64_tr_b16 a[44:45], v44 offset:2048
    ds_read_b64_tr_b16 a[46:47], v44 offset:2560
    ds_read_b64_tr_b16 a[104:105], v45 offset:0
    ds_read_b64_tr_b16 a[106:107], v45 offset:512
    ds_read_b64_tr_b16 a[108:109], v45 offset:2048
    ds_read_b64_tr_b16 a[110:111], v45 offset:2560
    s_waitcnt lgkmcnt(0)
    s_barrier
    s_add_u32 s14, s62, 3670016
    s_addc_u32 s15, s63, 0
    s_mov_b32 m0, 135168
    s_nop 0
    global_load_lds_dwordx4 v40, s[14:15]
    s_mov_b32 m0, 136192
    s_nop 0
    global_load_lds_dwordx4 v41, s[14:15]
    s_mov_b32 m0, 137216
    s_nop 0
    global_load_lds_dwordx4 v42, s[14:15]
    s_mov_b32 m0, 138240
    s_nop 0
    global_load_lds_dwordx4 v43, s[14:15]
    s_waitcnt vmcnt(28)
    s_barrier
    v_add_u32 v44, 16384, v52
    v_xor_b32 v45, 32, v44
    ds_read_b64_tr_b16 a[176:177], v44 offset:0
    ds_read_b64_tr_b16 a[178:179], v44 offset:512
    ds_read_b64_tr_b16 a[180:181], v44 offset:2048
    ds_read_b64_tr_b16 a[182:183], v44 offset:2560
    ds_read_b64_tr_b16 a[240:241], v45 offset:0
    ds_read_b64_tr_b16 a[242:243], v45 offset:512
    ds_read_b64_tr_b16 a[244:245], v45 offset:2048
    ds_read_b64_tr_b16 a[246:247], v45 offset:2560
    s_waitcnt lgkmcnt(0)
    s_barrier
    s_add_u32 s14, s64, 0
    s_addc_u32 s15, s65, 0
    s_mov_b32 m0, 20480
    s_nop 0
    global_load_lds_dwordx4 v40, s[14:15]
    s_mov_b32 m0, 21504
    s_nop 0
    global_load_lds_dwordx4 v41, s[14:15]
    s_mov_b32 m0, 22528
    s_nop 0
    global_load_lds_dwordx4 v42, s[14:15]
    s_mov_b32 m0, 23552
    s_nop 0
    global_load_lds_dwordx4 v43, s[14:15]
    s_waitcnt vmcnt(28)
    s_barrier
    v_add_u32 v44, 32768, v52
    v_xor_b32 v45, 32, v44
    ds_read_b64_tr_b16 a[184:185], v44 offset:0
    ds_read_b64_tr_b16 a[186:187], v44 offset:512
    ds_read_b64_tr_b16 a[188:189], v44 offset:2048
    ds_read_b64_tr_b16 a[190:191], v44 offset:2560
    ds_read_b64_tr_b16 a[248:249], v45 offset:0
    ds_read_b64_tr_b16 a[250:251], v45 offset:512
    ds_read_b64_tr_b16 a[252:253], v45 offset:2048
    ds_read_b64_tr_b16 a[254:255], v45 offset:2560
    s_waitcnt lgkmcnt(0)
    s_barrier
    s_add_u32 s14, s64, 524288
    s_addc_u32 s15, s65, 0
    s_mov_b32 m0, 36864
    s_nop 0
    global_load_lds_dwordx4 v40, s[14:15]
    s_mov_b32 m0, 37888
    s_nop 0
    global_load_lds_dwordx4 v41, s[14:15]
    s_mov_b32 m0, 38912
    s_nop 0
    global_load_lds_dwordx4 v42, s[14:15]
    s_mov_b32 m0, 39936
    s_nop 0
    global_load_lds_dwordx4 v43, s[14:15]
    s_waitcnt vmcnt(28)
    s_barrier
    v_add_u32 v44, 49152, v52
    v_xor_b32 v45, 32, v44
    ds_read_b64_tr_b16 a[128:129], v44 offset:0
    ds_read_b64_tr_b16 a[130:131], v44 offset:512
    ds_read_b64_tr_b16 a[132:133], v44 offset:2048
    ds_read_b64_tr_b16 a[134:135], v44 offset:2560
    ds_read_b64_tr_b16 a[192:193], v45 offset:0
    ds_read_b64_tr_b16 a[194:195], v45 offset:512
    ds_read_b64_tr_b16 a[196:197], v45 offset:2048
    ds_read_b64_tr_b16 a[198:199], v45 offset:2560
    s_waitcnt lgkmcnt(0)
    s_barrier
    s_add_u32 s14, s64, 1048576
    s_addc_u32 s15, s65, 0
    s_mov_b32 m0, 53248
    s_nop 0
    global_load_lds_dwordx4 v40, s[14:15]
    s_mov_b32 m0, 54272
    s_nop 0
    global_load_lds_dwordx4 v41, s[14:15]
    s_mov_b32 m0, 55296
    s_nop 0
    global_load_lds_dwordx4 v42, s[14:15]
    s_mov_b32 m0, 56320
    s_nop 0
    global_load_lds_dwordx4 v43, s[14:15]
    s_waitcnt vmcnt(28)
    s_barrier
    v_add_u32 v44, 65536, v52
    v_xor_b32 v45, 32, v44
    ds_read_b64_tr_b16 a[136:137], v44 offset:0
    ds_read_b64_tr_b16 a[138:139], v44 offset:512
    ds_read_b64_tr_b16 a[140:141], v44 offset:2048
    ds_read_b64_tr_b16 a[142:143], v44 offset:2560
    ds_read_b64_tr_b16 a[200:201], v45 offset:0
    ds_read_b64_tr_b16 a[202:203], v45 offset:512
    ds_read_b64_tr_b16 a[204:205], v45 offset:2048
    ds_read_b64_tr_b16 a[206:207], v45 offset:2560
    s_waitcnt lgkmcnt(0)
    s_barrier
    s_add_u32 s14, s64, 1572864
    s_addc_u32 s15, s65, 0
    s_mov_b32 m0, 69632
    s_nop 0
    global_load_lds_dwordx4 v40, s[14:15]
    s_mov_b32 m0, 70656
    s_nop 0
    global_load_lds_dwordx4 v41, s[14:15]
    s_mov_b32 m0, 71680
    s_nop 0
    global_load_lds_dwordx4 v42, s[14:15]
    s_mov_b32 m0, 72704
    s_nop 0
    global_load_lds_dwordx4 v43, s[14:15]
    s_waitcnt vmcnt(28)
    s_barrier
    v_add_u32 v44, 81920, v52
    v_xor_b32 v45, 32, v44
    ds_read_b64_tr_b16 a[144:145], v44 offset:0
    ds_read_b64_tr_b16 a[146:147], v44 offset:512
    ds_read_b64_tr_b16 a[148:149], v44 offset:2048
    ds_read_b64_tr_b16 a[150:151], v44 offset:2560
    ds_read_b64_tr_b16 a[208:209], v45 offset:0
    ds_read_b64_tr_b16 a[210:211], v45 offset:512
    ds_read_b64_tr_b16 a[212:213], v45 offset:2048
    ds_read_b64_tr_b16 a[214:215], v45 offset:2560
    s_waitcnt lgkmcnt(0)
    s_barrier
    s_add_u32 s14, s64, 2097152
    s_addc_u32 s15, s65, 0
    s_mov_b32 m0, 86016
    s_nop 0
    global_load_lds_dwordx4 v40, s[14:15]
    s_mov_b32 m0, 87040
    s_nop 0
    global_load_lds_dwordx4 v41, s[14:15]
    s_mov_b32 m0, 88064
    s_nop 0
    global_load_lds_dwordx4 v42, s[14:15]
    s_mov_b32 m0, 89088
    s_nop 0
    global_load_lds_dwordx4 v43, s[14:15]
    s_waitcnt vmcnt(28)
    s_barrier
    v_add_u32 v44, 98304, v52
    v_xor_b32 v45, 32, v44
    ds_read_b64_tr_b16 a[152:153], v44 offset:0
    ds_read_b64_tr_b16 a[154:155], v44 offset:512
    ds_read_b64_tr_b16 a[156:157], v44 offset:2048
    ds_read_b64_tr_b16 a[158:159], v44 offset:2560
    ds_read_b64_tr_b16 a[216:217], v45 offset:0
    ds_read_b64_tr_b16 a[218:219], v45 offset:512
    ds_read_b64_tr_b16 a[220:221], v45 offset:2048
    ds_read_b64_tr_b16 a[222:223], v45 offset:2560
    s_waitcnt lgkmcnt(0)
    s_barrier
    s_add_u32 s14, s64, 2621440
    s_addc_u32 s15, s65, 0
    s_mov_b32 m0, 102400
    s_nop 0
    global_load_lds_dwordx4 v40, s[14:15]
    s_mov_b32 m0, 103424
    s_nop 0
    global_load_lds_dwordx4 v41, s[14:15]
    s_mov_b32 m0, 104448
    s_nop 0
    global_load_lds_dwordx4 v42, s[14:15]
    s_mov_b32 m0, 105472
    s_nop 0
    global_load_lds_dwordx4 v43, s[14:15]
    s_waitcnt vmcnt(28)
    s_barrier
    v_add_u32 v44, 114688, v52
    v_xor_b32 v45, 32, v44
    ds_read_b64_tr_b16 a[160:161], v44 offset:0
    ds_read_b64_tr_b16 a[162:163], v44 offset:512
    ds_read_b64_tr_b16 a[164:165], v44 offset:2048
    ds_read_b64_tr_b16 a[166:167], v44 offset:2560
    ds_read_b64_tr_b16 a[224:225], v45 offset:0
    ds_read_b64_tr_b16 a[226:227], v45 offset:512
    ds_read_b64_tr_b16 a[228:229], v45 offset:2048
    ds_read_b64_tr_b16 a[230:231], v45 offset:2560
    s_waitcnt lgkmcnt(0)
    s_barrier
    s_add_u32 s14, s64, 3145728
    s_addc_u32 s15, s65, 0
    s_mov_b32 m0, 118784
    s_nop 0
    global_load_lds_dwordx4 v40, s[14:15]
    s_mov_b32 m0, 119808
    s_nop 0
    global_load_lds_dwordx4 v41, s[14:15]
    s_mov_b32 m0, 120832
    s_nop 0
    global_load_lds_dwordx4 v42, s[14:15]
    s_mov_b32 m0, 121856
    s_nop 0
    global_load_lds_dwordx4 v43, s[14:15]
    s_waitcnt vmcnt(28)
    s_barrier
    v_add_u32 v44, 131072, v52
    v_xor_b32 v45, 32, v44
    ds_read_b64_tr_b16 a[168:169], v44 offset:0
    ds_read_b64_tr_b16 a[170:171], v44 offset:512
    ds_read_b64_tr_b16 a[172:173], v44 offset:2048
    ds_read_b64_tr_b16 a[174:175], v44 offset:2560
    ds_read_b64_tr_b16 a[232:233], v45 offset:0
    ds_read_b64_tr_b16 a[234:235], v45 offset:512
    ds_read_b64_tr_b16 a[236:237], v45 offset:2048
    ds_read_b64_tr_b16 a[238:239], v45 offset:2560
    s_waitcnt lgkmcnt(0)
    s_barrier
    s_add_u32 s14, s64, 3670016
    s_addc_u32 s15, s65, 0
    s_mov_b32 m0, 135168
    s_nop 0
    global_load_lds_dwordx4 v40, s[14:15]
    s_mov_b32 m0, 136192
    s_nop 0
    global_load_lds_dwordx4 v41, s[14:15]
    s_mov_b32 m0, 137216
    s_nop 0
    global_load_lds_dwordx4 v42, s[14:15]
    s_mov_b32 m0, 138240
    s_nop 0
    global_load_lds_dwordx4 v43, s[14:15]
    s_waitcnt vmcnt(28)
    s_barrier
    v_add_u32 v44, 16384, v52
    v_xor_b32 v45, 32, v44
    ds_read_b64_tr_b16 v[176:177], v44 offset:0
    ds_read_b64_tr_b16 v[178:179], v44 offset:512
    ds_read_b64_tr_b16 v[180:181], v44 offset:2048
    ds_read_b64_tr_b16 v[182:183], v44 offset:2560
    ds_read_b64_tr_b16 v[240:241], v45 offset:0
    ds_read_b64_tr_b16 v[242:243], v45 offset:512
    ds_read_b64_tr_b16 v[244:245], v45 offset:2048
    ds_read_b64_tr_b16 v[246:247], v45 offset:2560
    s_waitcnt lgkmcnt(0)
    s_barrier
    s_add_u32 s14, s66, 4096
    s_addc_u32 s15, s67, 0
    v_xor_b32 v48, 0, v13
    s_mov_b32 m0, 20480
    s_nop 0
    global_load_lds_dwordx4 v48, s[14:15]
    s_add_u32 s14, s66, 5120
    s_addc_u32 s15, s67, 0
    v_xor_b32 v48, 32, v13
    s_mov_b32 m0, 21504
    s_nop 0
    global_load_lds_dwordx4 v48, s[14:15]
    s_add_u32 s14, s66, 6144
    s_addc_u32 s15, s67, 0
    v_xor_b32 v48, 0, v13
    s_mov_b32 m0, 22528
    s_nop 0
    global_load_lds_dwordx4 v48, s[14:15]
    s_add_u32 s14, s66, 7168
    s_addc_u32 s15, s67, 0
    v_xor_b32 v48, 32, v13
    s_mov_b32 m0, 23552
    s_nop 0
    global_load_lds_dwordx4 v48, s[14:15]
    s_waitcnt vmcnt(28)
    s_barrier
    v_add_u32 v44, 32768, v52
    v_xor_b32 v45, 32, v44
    ds_read_b64_tr_b16 v[184:185], v44 offset:0
    ds_read_b64_tr_b16 v[186:187], v44 offset:512
    ds_read_b64_tr_b16 v[188:189], v44 offset:2048
    ds_read_b64_tr_b16 v[190:191], v44 offset:2560
    ds_read_b64_tr_b16 v[248:249], v45 offset:0
    ds_read_b64_tr_b16 v[250:251], v45 offset:512
    ds_read_b64_tr_b16 v[252:253], v45 offset:2048
    ds_read_b64_tr_b16 v[254:255], v45 offset:2560
    s_waitcnt lgkmcnt(0)
    s_barrier
    s_add_u32 s14, s66, 20480
    s_addc_u32 s15, s67, 0
    v_xor_b32 v48, 64, v13
    s_mov_b32 m0, 36864
    s_nop 0
    global_load_lds_dwordx4 v48, s[14:15]
    s_add_u32 s14, s66, 21504
    s_addc_u32 s15, s67, 0
    v_xor_b32 v48, 96, v13
    s_mov_b32 m0, 37888
    s_nop 0
    global_load_lds_dwordx4 v48, s[14:15]
    s_add_u32 s14, s66, 22528
    s_addc_u32 s15, s67, 0
    v_xor_b32 v48, 64, v13
    s_mov_b32 m0, 38912
    s_nop 0
    global_load_lds_dwordx4 v48, s[14:15]
    s_add_u32 s14, s66, 23552
    s_addc_u32 s15, s67, 0
    v_xor_b32 v48, 96, v13
    s_mov_b32 m0, 39936
    s_nop 0
    global_load_lds_dwordx4 v48, s[14:15]
    s_waitcnt vmcnt(28)
    s_barrier
    v_add_u32 v44, 49152, v52
    v_xor_b32 v45, 32, v44
    ds_read_b64_tr_b16 v[128:129], v44 offset:0
    ds_read_b64_tr_b16 v[130:131], v44 offset:512
    ds_read_b64_tr_b16 v[132:133], v44 offset:2048
    ds_read_b64_tr_b16 v[134:135], v44 offset:2560
    ds_read_b64_tr_b16 v[192:193], v45 offset:0
    ds_read_b64_tr_b16 v[194:195], v45 offset:512
    ds_read_b64_tr_b16 v[196:197], v45 offset:2048
    ds_read_b64_tr_b16 v[198:199], v45 offset:2560
    s_waitcnt lgkmcnt(0)
    s_barrier
    s_add_u32 s14, s66, 36864
    s_addc_u32 s15, s67, 0
    v_xor_b32 v48, 128, v13
    s_mov_b32 m0, 53248
    s_nop 0
    global_load_lds_dwordx4 v48, s[14:15]
    s_add_u32 s14, s66, 37888
    s_addc_u32 s15, s67, 0
    v_xor_b32 v48, 160, v13
    s_mov_b32 m0, 54272
    s_nop 0
    global_load_lds_dwordx4 v48, s[14:15]
    s_add_u32 s14, s66, 38912
    s_addc_u32 s15, s67, 0
    v_xor_b32 v48, 128, v13
    s_mov_b32 m0, 55296
    s_nop 0
    global_load_lds_dwordx4 v48, s[14:15]
    s_add_u32 s14, s66, 39936
    s_addc_u32 s15, s67, 0
    v_xor_b32 v48, 160, v13
    s_mov_b32 m0, 56320
    s_nop 0
    global_load_lds_dwordx4 v48, s[14:15]
    s_waitcnt vmcnt(28)
    s_barrier
    v_add_u32 v44, 65536, v52
    v_xor_b32 v45, 32, v44
    ds_read_b64_tr_b16 v[136:137], v44 offset:0
    ds_read_b64_tr_b16 v[138:139], v44 offset:512
    ds_read_b64_tr_b16 v[140:141], v44 offset:2048
    ds_read_b64_tr_b16 v[142:143], v44 offset:2560
    ds_read_b64_tr_b16 v[200:201], v45 offset:0
    ds_read_b64_tr_b16 v[202:203], v45 offset:512
    ds_read_b64_tr_b16 v[204:205], v45 offset:2048
    ds_read_b64_tr_b16 v[206:207], v45 offset:2560
    s_waitcnt lgkmcnt(0)
    s_barrier
    s_add_u32 s14, s66, 53248
    s_addc_u32 s15, s67, 0
    v_xor_b32 v48, 192, v13
    s_mov_b32 m0, 69632
    s_nop 0
    global_load_lds_dwordx4 v48, s[14:15]
    s_add_u32 s14, s66, 54272
    s_addc_u32 s15, s67, 0
    v_xor_b32 v48, 224, v13
    s_mov_b32 m0, 70656
    s_nop 0
    global_load_lds_dwordx4 v48, s[14:15]
    s_add_u32 s14, s66, 55296
    s_addc_u32 s15, s67, 0
    v_xor_b32 v48, 192, v13
    s_mov_b32 m0, 71680
    s_nop 0
    global_load_lds_dwordx4 v48, s[14:15]
    s_add_u32 s14, s66, 56320
    s_addc_u32 s15, s67, 0
    v_xor_b32 v48, 224, v13
    s_mov_b32 m0, 72704
    s_nop 0
    global_load_lds_dwordx4 v48, s[14:15]
    s_waitcnt vmcnt(28)
    s_barrier
    v_add_u32 v44, 81920, v52
    v_xor_b32 v45, 32, v44
    ds_read_b64_tr_b16 v[56:57], v44 offset:0
    ds_read_b64_tr_b16 v[58:59], v44 offset:512
    ds_read_b64_tr_b16 v[60:61], v44 offset:2048
    ds_read_b64_tr_b16 v[62:63], v44 offset:2560
    ds_read_b64_tr_b16 v[64:65], v45 offset:0
    ds_read_b64_tr_b16 v[66:67], v45 offset:512
    ds_read_b64_tr_b16 v[68:69], v45 offset:2048
    ds_read_b64_tr_b16 v[70:71], v45 offset:2560
    s_waitcnt lgkmcnt(0)
    ds_write_b128 v55, v[56:59] offset:0
    ds_write_b128 v55, v[60:63] offset:1024
    ds_write_b128 v55, v[64:67] offset:2048
    ds_write_b128 v55, v[68:71] offset:3072
    s_waitcnt lgkmcnt(0)
    s_barrier
    s_add_u32 s14, s66, 69632
    s_addc_u32 s15, s67, 0
    v_xor_b32 v48, 0, v13
    s_mov_b32 m0, 86016
    s_nop 0
    global_load_lds_dwordx4 v48, s[14:15]
    s_add_u32 s14, s66, 70656
    s_addc_u32 s15, s67, 0
    v_xor_b32 v48, 32, v13
    s_mov_b32 m0, 87040
    s_nop 0
    global_load_lds_dwordx4 v48, s[14:15]
    s_add_u32 s14, s66, 71680
    s_addc_u32 s15, s67, 0
    v_xor_b32 v48, 0, v13
    s_mov_b32 m0, 88064
    s_nop 0
    global_load_lds_dwordx4 v48, s[14:15]
    s_add_u32 s14, s66, 72704
    s_addc_u32 s15, s67, 0
    v_xor_b32 v48, 32, v13
    s_mov_b32 m0, 89088
    s_nop 0
    global_load_lds_dwordx4 v48, s[14:15]
    s_waitcnt vmcnt(28)
    s_barrier
    v_add_u32 v44, 98304, v52
    v_xor_b32 v45, 32, v44
    ds_read_b64_tr_b16 v[56:57], v44 offset:0
    ds_read_b64_tr_b16 v[58:59], v44 offset:512
    ds_read_b64_tr_b16 v[60:61], v44 offset:2048
    ds_read_b64_tr_b16 v[62:63], v44 offset:2560
    ds_read_b64_tr_b16 v[64:65], v45 offset:0
    ds_read_b64_tr_b16 v[66:67], v45 offset:512
    ds_read_b64_tr_b16 v[68:69], v45 offset:2048
    ds_read_b64_tr_b16 v[70:71], v45 offset:2560
    s_waitcnt lgkmcnt(0)
    ds_write_b128 v55, v[56:59] offset:4096
    ds_write_b128 v55, v[60:63] offset:5120
    ds_write_b128 v55, v[64:67] offset:6144
    ds_write_b128 v55, v[68:71] offset:7168
    s_waitcnt lgkmcnt(0)
    s_barrier
    s_add_u32 s14, s66, 86016
    s_addc_u32 s15, s67, 0
    v_xor_b32 v48, 64, v13
    s_mov_b32 m0, 102400
    s_nop 0
    global_load_lds_dwordx4 v48, s[14:15]
    s_add_u32 s14, s66, 87040
    s_addc_u32 s15, s67, 0
    v_xor_b32 v48, 96, v13
    s_mov_b32 m0, 103424
    s_nop 0
    global_load_lds_dwordx4 v48, s[14:15]
    s_add_u32 s14, s66, 88064
    s_addc_u32 s15, s67, 0
    v_xor_b32 v48, 64, v13
    s_mov_b32 m0, 104448
    s_nop 0
    global_load_lds_dwordx4 v48, s[14:15]
    s_add_u32 s14, s66, 89088
    s_addc_u32 s15, s67, 0
    v_xor_b32 v48, 96, v13
    s_mov_b32 m0, 105472
    s_nop 0
    global_load_lds_dwordx4 v48, s[14:15]
    s_waitcnt vmcnt(28)
    s_barrier
    v_add_u32 v44, 114688, v52
    v_xor_b32 v45, 32, v44
    ds_read_b64_tr_b16 v[160:161], v44 offset:0
    ds_read_b64_tr_b16 v[162:163], v44 offset:512
    ds_read_b64_tr_b16 v[164:165], v44 offset:2048
    ds_read_b64_tr_b16 v[166:167], v44 offset:2560
    ds_read_b64_tr_b16 v[224:225], v45 offset:0
    ds_read_b64_tr_b16 v[226:227], v45 offset:512
    ds_read_b64_tr_b16 v[228:229], v45 offset:2048
    ds_read_b64_tr_b16 v[230:231], v45 offset:2560
    s_waitcnt lgkmcnt(0)
    s_barrier
    s_add_u32 s14, s66, 102400
    s_addc_u32 s15, s67, 0
    v_xor_b32 v48, 128, v13
    s_mov_b32 m0, 118784
    s_nop 0
    global_load_lds_dwordx4 v48, s[14:15]
    s_add_u32 s14, s66, 103424
    s_addc_u32 s15, s67, 0
    v_xor_b32 v48, 160, v13
    s_mov_b32 m0, 119808
    s_nop 0
    global_load_lds_dwordx4 v48, s[14:15]
    s_add_u32 s14, s66, 104448
    s_addc_u32 s15, s67, 0
    v_xor_b32 v48, 128, v13
    s_mov_b32 m0, 120832
    s_nop 0
    global_load_lds_dwordx4 v48, s[14:15]
    s_add_u32 s14, s66, 105472
    s_addc_u32 s15, s67, 0
    v_xor_b32 v48, 160, v13
    s_mov_b32 m0, 121856
    s_nop 0
    global_load_lds_dwordx4 v48, s[14:15]
    s_waitcnt vmcnt(28)
    s_barrier
    v_add_u32 v44, 131072, v52
    v_xor_b32 v45, 32, v44
    ds_read_b64_tr_b16 v[168:169], v44 offset:0
    ds_read_b64_tr_b16 v[170:171], v44 offset:512
    ds_read_b64_tr_b16 v[172:173], v44 offset:2048
    ds_read_b64_tr_b16 v[174:175], v44 offset:2560
    ds_read_b64_tr_b16 v[232:233], v45 offset:0
    ds_read_b64_tr_b16 v[234:235], v45 offset:512
    ds_read_b64_tr_b16 v[236:237], v45 offset:2048
    ds_read_b64_tr_b16 v[238:239], v45 offset:2560
    s_waitcnt lgkmcnt(0)
    s_barrier
    s_add_u32 s14, s66, 118784
    s_addc_u32 s15, s67, 0
    v_xor_b32 v48, 192, v13
    s_mov_b32 m0, 135168
    s_nop 0
    global_load_lds_dwordx4 v48, s[14:15]
    s_add_u32 s14, s66, 119808
    s_addc_u32 s15, s67, 0
    v_xor_b32 v48, 224, v13
    s_mov_b32 m0, 136192
    s_nop 0
    global_load_lds_dwordx4 v48, s[14:15]
    s_add_u32 s14, s66, 120832
    s_addc_u32 s15, s67, 0
    v_xor_b32 v48, 192, v13
    s_mov_b32 m0, 137216
    s_nop 0
    global_load_lds_dwordx4 v48, s[14:15]
    s_add_u32 s14, s66, 121856
    s_addc_u32 s15, s67, 0
    v_xor_b32 v48, 224, v13
    s_mov_b32 m0, 138240
    s_nop 0
    global_load_lds_dwordx4 v48, s[14:15]
    s_waitcnt vmcnt(0)
    s_barrier
    v_xor_b32 v54, 96, v53
    ds_read_b64_tr_b16 v[112:113], v54 offset:0
    ds_read_b64_tr_b16 v[114:115], v54 offset:2048
    ds_read_b64_tr_b16 v[116:117], v54 offset:8192
    ds_read_b64_tr_b16 v[118:119], v54 offset:10240
    v_xor_b32 v54, 128, v53
    ds_read_b64_tr_b16 v[144:145], v54 offset:0
    ds_read_b64_tr_b16 v[146:147], v54 offset:2048
    ds_read_b64_tr_b16 v[148:149], v54 offset:8192
    ds_read_b64_tr_b16 v[150:151], v54 offset:10240
    v_xor_b32 v54, 160, v53
    ds_read_b64_tr_b16 v[208:209], v54 offset:0
    ds_read_b64_tr_b16 v[210:211], v54 offset:2048
    ds_read_b64_tr_b16 v[212:213], v54 offset:8192
    ds_read_b64_tr_b16 v[214:215], v54 offset:10240
    v_xor_b32 v54, 0, v53
    ds_read_b64_tr_b16 v[56:57], v54 offset:0
    ds_read_b64_tr_b16 v[58:59], v54 offset:2048
    ds_read_b64_tr_b16 v[60:61], v54 offset:8192
    ds_read_b64_tr_b16 v[62:63], v54 offset:10240
    v_xor_b32 v54, 32, v53
    ds_read_b64_tr_b16 v[64:65], v54 offset:0
    ds_read_b64_tr_b16 v[66:67], v54 offset:2048
    ds_read_b64_tr_b16 v[68:69], v54 offset:8192
    ds_read_b64_tr_b16 v[70:71], v54 offset:10240
    v_xor_b32 v54, 64, v53
    ds_read_b64_tr_b16 v[72:73], v54 offset:0
    ds_read_b64_tr_b16 v[74:75], v54 offset:2048
    ds_read_b64_tr_b16 v[76:77], v54 offset:8192
    ds_read_b64_tr_b16 v[78:79], v54 offset:10240
    v_xor_b32 v54, 192, v53
    ds_read_b64_tr_b16 v[80:81], v54 offset:0
    ds_read_b64_tr_b16 v[82:83], v54 offset:2048
    ds_read_b64_tr_b16 v[84:85], v54 offset:8192
    ds_read_b64_tr_b16 v[86:87], v54 offset:10240
    v_xor_b32 v54, 224, v53
    ds_read_b64_tr_b16 v[88:89], v54 offset:0
    ds_read_b64_tr_b16 v[90:91], v54 offset:2048
    ds_read_b64_tr_b16 v[92:93], v54 offset:8192
    ds_read_b64_tr_b16 v[94:95], v54 offset:10240
    s_waitcnt lgkmcnt(0)
    s_barrier
    ds_write_b128 v14, v[56:59] offset:0
    ds_write_b128 v14, v[60:63] offset:1024
    ds_write_b128 v14, v[64:67] offset:2048
    ds_write_b128 v14, v[68:71] offset:3072
    ds_write_b128 v14, v[72:75] offset:4096
    ds_write_b128 v14, v[76:79] offset:5120
    ds_write_b128 v14, v[80:83] offset:6144
    ds_write_b128 v14, v[84:87] offset:7168
    ds_write_b128 v14, v[88:91] offset:8192
    ds_write_b128 v14, v[92:95] offset:9216
    s_waitcnt lgkmcnt(0)
    v_xor_b32 v54, 96, v53
    v_add_u32 v54, 65536, v54
    ds_read_b64_tr_b16 v[120:121], v54 offset:0
    ds_read_b64_tr_b16 v[122:123], v54 offset:2048
    ds_read_b64_tr_b16 v[124:125], v54 offset:8192
    ds_read_b64_tr_b16 v[126:127], v54 offset:10240
    v_xor_b32 v54, 128, v53
    v_add_u32 v54, 65536, v54
    ds_read_b64_tr_b16 v[152:153], v54 offset:0
    ds_read_b64_tr_b16 v[154:155], v54 offset:2048
    ds_read_b64_tr_b16 v[156:157], v54 offset:8192
    ds_read_b64_tr_b16 v[158:159], v54 offset:10240
    v_xor_b32 v54, 160, v53
    v_add_u32 v54, 65536, v54
    ds_read_b64_tr_b16 v[216:217], v54 offset:0
    ds_read_b64_tr_b16 v[218:219], v54 offset:2048
    ds_read_b64_tr_b16 v[220:221], v54 offset:8192
    ds_read_b64_tr_b16 v[222:223], v54 offset:10240
    v_xor_b32 v54, 0, v53
    v_add_u32 v54, 65536, v54
    ds_read_b64_tr_b16 v[56:57], v54 offset:0
    ds_read_b64_tr_b16 v[58:59], v54 offset:2048
    ds_read_b64_tr_b16 v[60:61], v54 offset:8192
    ds_read_b64_tr_b16 v[62:63], v54 offset:10240
    v_xor_b32 v54, 32, v53
    v_add_u32 v54, 65536, v54
    ds_read_b64_tr_b16 v[64:65], v54 offset:0
    ds_read_b64_tr_b16 v[66:67], v54 offset:2048
    ds_read_b64_tr_b16 v[68:69], v54 offset:8192
    ds_read_b64_tr_b16 v[70:71], v54 offset:10240
    v_xor_b32 v54, 64, v53
    v_add_u32 v54, 65536, v54
    ds_read_b64_tr_b16 v[72:73], v54 offset:0
    ds_read_b64_tr_b16 v[74:75], v54 offset:2048
    ds_read_b64_tr_b16 v[76:77], v54 offset:8192
    ds_read_b64_tr_b16 v[78:79], v54 offset:10240
    v_xor_b32 v54, 192, v53
    v_add_u32 v54, 65536, v54
    ds_read_b64_tr_b16 v[80:81], v54 offset:0
    ds_read_b64_tr_b16 v[82:83], v54 offset:2048
    ds_read_b64_tr_b16 v[84:85], v54 offset:8192
    ds_read_b64_tr_b16 v[86:87], v54 offset:10240
    v_xor_b32 v54, 224, v53
    v_add_u32 v54, 65536, v54
    ds_read_b64_tr_b16 v[88:89], v54 offset:0
    ds_read_b64_tr_b16 v[90:91], v54 offset:2048
    ds_read_b64_tr_b16 v[92:93], v54 offset:8192
    ds_read_b64_tr_b16 v[94:95], v54 offset:10240
    s_waitcnt lgkmcnt(0)
    s_barrier
    ds_write_b128 v15, v[56:59] offset:0
    ds_write_b128 v15, v[60:63] offset:1024
    ds_write_b128 v15, v[64:67] offset:2048
    ds_write_b128 v15, v[68:71] offset:3072
    ds_write_b128 v15, v[72:75] offset:4096
    ds_write_b128 v15, v[76:79] offset:5120
    ds_write_b128 v15, v[80:83] offset:6144
    ds_write_b128 v15, v[84:87] offset:7168
    ds_write_b128 v15, v[88:91] offset:8192
    ds_write_b128 v15, v[92:95] offset:9216
    s_waitcnt lgkmcnt(0)
    ds_read_b128 v[56:59], v55 offset:0
    ds_read_b128 v[60:63], v55 offset:1024
    ds_read_b128 v[64:67], v55 offset:2048
    ds_read_b128 v[68:71], v55 offset:3072
    ds_read_b128 v[72:75], v55 offset:4096
    ds_read_b128 v[76:79], v55 offset:5120
    ds_read_b128 v[80:83], v55 offset:6144
    ds_read_b128 v[84:87], v55 offset:7168
    v_add_u32 v54, 106496, v13
    s_waitcnt lgkmcnt(0)
    ds_write_b128 v54, v[56:59] offset:0
    ds_write_b128 v54, v[60:63] offset:1024
    ds_write_b128 v54, v[64:67] offset:2048
    ds_write_b128 v54, v[68:71] offset:3072
    ds_write_b128 v54, v[72:75] offset:4096
    ds_write_b128 v54, v[76:79] offset:5120
    ds_write_b128 v54, v[80:83] offset:6144
    ds_write_b128 v54, v[84:87] offset:7168
    s_waitcnt lgkmcnt(0)
    s_branch L_wdone_2
L_w2_5:
    v_lshrrev_b32 v46, 4, v0
    v_and_b32 v47, 1, v46
    v_or_b32 v47, 4, v47
    v_lshlrev_b32 v47, 1, v47
    v_and_b32 v48, 15, v0
    v_xor_b32 v48, v48, v47
    v_lshlrev_b32 v48, 4, v48
    v_add_u32 v46, 32, v46
    v_lshlrev_b32 v46, 13, v46
    v_add_u32 v40, v46, v48
    v_add_u32 v41, 32768, v40
    v_add_u32 v42, 65536, v40
    v_add_u32 v43, 98304, v40
    v_bfe_u32 v46, v0, 3, 1
    v_bfe_u32 v47, v0, 4, 1
    v_bfe_u32 v48, v0, 2, 1
    v_lshlrev_b32 v49, 2, v46
    v_lshl_or_b32 v49, v47, 1, v49
    v_or_b32 v49, v49, v48
    v_lshlrev_b32 v50, 5, v46
    v_lshl_or_b32 v50, v47, 4, v50
    v_or_b32 v50, v50, v48
    v_bfe_u32 v51, v0, 5, 1
    v_lshl_or_b32 v50, v51, 2, v50
    v_and_b32 v51, 3, v0
    v_lshlrev_b32 v51, 3, v51
    v_xor_b32 v52, 4, v49
    v_lshlrev_b32 v52, 5, v52
    v_lshl_or_b32 v52, v50, 8, v52
    v_add_u32 v52, v52, v51
    v_lshlrev_b32 v53, 5, v49
    v_lshl_or_b32 v53, v50, 10, v53
    v_add_u32 v53, v53, v51
    v_add_u32 v53, 16896, v53
    v_add_u32 v55, 147456, v13
    s_add_u32 s14, s60, 0
    s_addc_u32 s15, s61, 0
    s_mov_b32 m0, 24576
    s_nop 0
    global_load_lds_dwordx4 v40, s[14:15]
    s_mov_b32 m0, 25600
    s_nop 0
    global_load_lds_dwordx4 v41, s[14:15]
    s_mov_b32 m0, 26624
    s_nop 0
    global_load_lds_dwordx4 v42, s[14:15]
    s_mov_b32 m0, 27648
    s_nop 0
    global_load_lds_dwordx4 v43, s[14:15]
    s_add_u32 s14, s60, 524288
    s_addc_u32 s15, s61, 0
    s_mov_b32 m0, 40960
    s_nop 0
    global_load_lds_dwordx4 v40, s[14:15]
    s_mov_b32 m0, 41984
    s_nop 0
    global_load_lds_dwordx4 v41, s[14:15]
    s_mov_b32 m0, 43008
    s_nop 0
    global_load_lds_dwordx4 v42, s[14:15]
    s_mov_b32 m0, 44032
    s_nop 0
    global_load_lds_dwordx4 v43, s[14:15]
    s_add_u32 s14, s60, 1048576
    s_addc_u32 s15, s61, 0
    s_mov_b32 m0, 57344
    s_nop 0
    global_load_lds_dwordx4 v40, s[14:15]
    s_mov_b32 m0, 58368
    s_nop 0
    global_load_lds_dwordx4 v41, s[14:15]
    s_mov_b32 m0, 59392
    s_nop 0
    global_load_lds_dwordx4 v42, s[14:15]
    s_mov_b32 m0, 60416
    s_nop 0
    global_load_lds_dwordx4 v43, s[14:15]
    s_add_u32 s14, s60, 1572864
    s_addc_u32 s15, s61, 0
    s_mov_b32 m0, 73728
    s_nop 0
    global_load_lds_dwordx4 v40, s[14:15]
    s_mov_b32 m0, 74752
    s_nop 0
    global_load_lds_dwordx4 v41, s[14:15]
    s_mov_b32 m0, 75776
    s_nop 0
    global_load_lds_dwordx4 v42, s[14:15]
    s_mov_b32 m0, 76800
    s_nop 0
    global_load_lds_dwordx4 v43, s[14:15]
    s_add_u32 s14, s60, 2097152
    s_addc_u32 s15, s61, 0
    s_mov_b32 m0, 90112
    s_nop 0
    global_load_lds_dwordx4 v40, s[14:15]
    s_mov_b32 m0, 91136
    s_nop 0
    global_load_lds_dwordx4 v41, s[14:15]
    s_mov_b32 m0, 92160
    s_nop 0
    global_load_lds_dwordx4 v42, s[14:15]
    s_mov_b32 m0, 93184
    s_nop 0
    global_load_lds_dwordx4 v43, s[14:15]
    s_add_u32 s14, s60, 2621440
    s_addc_u32 s15, s61, 0
    s_mov_b32 m0, 106496
    s_nop 0
    global_load_lds_dwordx4 v40, s[14:15]
    s_mov_b32 m0, 107520
    s_nop 0
    global_load_lds_dwordx4 v41, s[14:15]
    s_mov_b32 m0, 108544
    s_nop 0
    global_load_lds_dwordx4 v42, s[14:15]
    s_mov_b32 m0, 109568
    s_nop 0
    global_load_lds_dwordx4 v43, s[14:15]
    s_add_u32 s14, s60, 3145728
    s_addc_u32 s15, s61, 0
    s_mov_b32 m0, 122880
    s_nop 0
    global_load_lds_dwordx4 v40, s[14:15]
    s_mov_b32 m0, 123904
    s_nop 0
    global_load_lds_dwordx4 v41, s[14:15]
    s_mov_b32 m0, 124928
    s_nop 0
    global_load_lds_dwordx4 v42, s[14:15]
    s_mov_b32 m0, 125952
    s_nop 0
    global_load_lds_dwordx4 v43, s[14:15]
    s_add_u32 s14, s60, 3670016
    s_addc_u32 s15, s61, 0
    s_mov_b32 m0, 139264
    s_nop 0
    global_load_lds_dwordx4 v40, s[14:15]
    s_mov_b32 m0, 140288
    s_nop 0
    global_load_lds_dwordx4 v41, s[14:15]
    s_mov_b32 m0, 141312
    s_nop 0
    global_load_lds_dwordx4 v42, s[14:15]
    s_mov_b32 m0, 142336
    s_nop 0
    global_load_lds_dwordx4 v43, s[14:15]
    s_waitcnt vmcnt(28)
    s_barrier
    v_add_u32 v44, 16384, v52
    v_xor_b32 v45, 32, v44
    ds_read_b64_tr_b16 a[32:33], v44 offset:0
    ds_read_b64_tr_b16 a[34:35], v44 offset:512
    ds_read_b64_tr_b16 a[36:37], v44 offset:2048
    ds_read_b64_tr_b16 a[38:39], v44 offset:2560
    ds_read_b64_tr_b16 a[96:97], v45 offset:0
    ds_read_b64_tr_b16 a[98:99], v45 offset:512
    ds_read_b64_tr_b16 a[100:101], v45 offset:2048
    ds_read_b64_tr_b16 a[102:103], v45 offset:2560
    s_waitcnt lgkmcnt(0)
    s_barrier
    s_add_u32 s14, s62, 0
    s_addc_u32 s15, s63, 0
    s_mov_b32 m0, 24576
    s_nop 0
    global_load_lds_dwordx4 v40, s[14:15]
    s_mov_b32 m0, 25600
    s_nop 0
    global_load_lds_dwordx4 v41, s[14:15]
    s_mov_b32 m0, 26624
    s_nop 0
    global_load_lds_dwordx4 v42, s[14:15]
    s_mov_b32 m0, 27648
    s_nop 0
    global_load_lds_dwordx4 v43, s[14:15]
    s_waitcnt vmcnt(28)
    s_barrier
    v_add_u32 v44, 32768, v52
    v_xor_b32 v45, 32, v44
    ds_read_b64_tr_b16 a[40:41], v44 offset:0
    ds_read_b64_tr_b16 a[42:43], v44 offset:512
    ds_read_b64_tr_b16 a[44:45], v44 offset:2048
    ds_read_b64_tr_b16 a[46:47], v44 offset:2560
    ds_read_b64_tr_b16 a[104:105], v45 offset:0
    ds_read_b64_tr_b16 a[106:107], v45 offset:512
    ds_read_b64_tr_b16 a[108:109], v45 offset:2048
    ds_read_b64_tr_b16 a[110:111], v45 offset:2560
    s_waitcnt lgkmcnt(0)
    s_barrier
    s_add_u32 s14, s62, 524288
    s_addc_u32 s15, s63, 0
    s_mov_b32 m0, 40960
    s_nop 0
    global_load_lds_dwordx4 v40, s[14:15]
    s_mov_b32 m0, 41984
    s_nop 0
    global_load_lds_dwordx4 v41, s[14:15]
    s_mov_b32 m0, 43008
    s_nop 0
    global_load_lds_dwordx4 v42, s[14:15]
    s_mov_b32 m0, 44032
    s_nop 0
    global_load_lds_dwordx4 v43, s[14:15]
    s_waitcnt vmcnt(28)
    s_barrier
    v_add_u32 v44, 49152, v52
    v_xor_b32 v45, 32, v44
    ds_read_b64_tr_b16 a[48:49], v44 offset:0
    ds_read_b64_tr_b16 a[50:51], v44 offset:512
    ds_read_b64_tr_b16 a[52:53], v44 offset:2048
    ds_read_b64_tr_b16 a[54:55], v44 offset:2560
    ds_read_b64_tr_b16 a[112:113], v45 offset:0
    ds_read_b64_tr_b16 a[114:115], v45 offset:512
    ds_read_b64_tr_b16 a[116:117], v45 offset:2048
    ds_read_b64_tr_b16 a[118:119], v45 offset:2560
    s_waitcnt lgkmcnt(0)
    s_barrier
    s_add_u32 s14, s62, 1048576
    s_addc_u32 s15, s63, 0
    s_mov_b32 m0, 57344
    s_nop 0
    global_load_lds_dwordx4 v40, s[14:15]
    s_mov_b32 m0, 58368
    s_nop 0
    global_load_lds_dwordx4 v41, s[14:15]
    s_mov_b32 m0, 59392
    s_nop 0
    global_load_lds_dwordx4 v42, s[14:15]
    s_mov_b32 m0, 60416
    s_nop 0
    global_load_lds_dwordx4 v43, s[14:15]
    s_waitcnt vmcnt(28)
    s_barrier
    v_add_u32 v44, 65536, v52
    v_xor_b32 v45, 32, v44
    ds_read_b64_tr_b16 a[56:57], v44 offset:0
    ds_read_b64_tr_b16 a[58:59], v44 offset:512
    ds_read_b64_tr_b16 a[60:61], v44 offset:2048
    ds_read_b64_tr_b16 a[62:63], v44 offset:2560
    ds_read_b64_tr_b16 a[120:121], v45 offset:0
    ds_read_b64_tr_b16 a[122:123], v45 offset:512
    ds_read_b64_tr_b16 a[124:125], v45 offset:2048
    ds_read_b64_tr_b16 a[126:127], v45 offset:2560
    s_waitcnt lgkmcnt(0)
    s_barrier
    s_add_u32 s14, s62, 1572864
    s_addc_u32 s15, s63, 0
    s_mov_b32 m0, 73728
    s_nop 0
    global_load_lds_dwordx4 v40, s[14:15]
    s_mov_b32 m0, 74752
    s_nop 0
    global_load_lds_dwordx4 v41, s[14:15]
    s_mov_b32 m0, 75776
    s_nop 0
    global_load_lds_dwordx4 v42, s[14:15]
    s_mov_b32 m0, 76800
    s_nop 0
    global_load_lds_dwordx4 v43, s[14:15]
    s_waitcnt vmcnt(28)
    s_barrier
    v_add_u32 v44, 81920, v52
    v_xor_b32 v45, 32, v44
    ds_read_b64_tr_b16 a[0:1], v44 offset:0
    ds_read_b64_tr_b16 a[2:3], v44 offset:512
    ds_read_b64_tr_b16 a[4:5], v44 offset:2048
    ds_read_b64_tr_b16 a[6:7], v44 offset:2560
    ds_read_b64_tr_b16 a[64:65], v45 offset:0
    ds_read_b64_tr_b16 a[66:67], v45 offset:512
    ds_read_b64_tr_b16 a[68:69], v45 offset:2048
    ds_read_b64_tr_b16 a[70:71], v45 offset:2560
    s_waitcnt lgkmcnt(0)
    s_barrier
    s_add_u32 s14, s62, 2097152
    s_addc_u32 s15, s63, 0
    s_mov_b32 m0, 90112
    s_nop 0
    global_load_lds_dwordx4 v40, s[14:15]
    s_mov_b32 m0, 91136
    s_nop 0
    global_load_lds_dwordx4 v41, s[14:15]
    s_mov_b32 m0, 92160
    s_nop 0
    global_load_lds_dwordx4 v42, s[14:15]
    s_mov_b32 m0, 93184
    s_nop 0
    global_load_lds_dwordx4 v43, s[14:15]
    s_waitcnt vmcnt(28)
    s_barrier
    v_add_u32 v44, 98304, v52
    v_xor_b32 v45, 32, v44
    ds_read_b64_tr_b16 a[8:9], v44 offset:0
    ds_read_b64_tr_b16 a[10:11], v44 offset:512
    ds_read_b64_tr_b16 a[12:13], v44 offset:2048
    ds_read_b64_tr_b16 a[14:15], v44 offset:2560
    ds_read_b64_tr_b16 a[72:73], v45 offset:0
    ds_read_b64_tr_b16 a[74:75], v45 offset:512
    ds_read_b64_tr_b16 a[76:77], v45 offset:2048
    ds_read_b64_tr_b16 a[78:79], v45 offset:2560
    s_waitcnt lgkmcnt(0)
    s_barrier
    s_add_u32 s14, s62, 2621440
    s_addc_u32 s15, s63, 0
    s_mov_b32 m0, 106496
    s_nop 0
    global_load_lds_dwordx4 v40, s[14:15]
    s_mov_b32 m0, 107520
    s_nop 0
    global_load_lds_dwordx4 v41, s[14:15]
    s_mov_b32 m0, 108544
    s_nop 0
    global_load_lds_dwordx4 v42, s[14:15]
    s_mov_b32 m0, 109568
    s_nop 0
    global_load_lds_dwordx4 v43, s[14:15]
    s_waitcnt vmcnt(28)
    s_barrier
    v_add_u32 v44, 114688, v52
    v_xor_b32 v45, 32, v44
    ds_read_b64_tr_b16 a[16:17], v44 offset:0
    ds_read_b64_tr_b16 a[18:19], v44 offset:512
    ds_read_b64_tr_b16 a[20:21], v44 offset:2048
    ds_read_b64_tr_b16 a[22:23], v44 offset:2560
    ds_read_b64_tr_b16 a[80:81], v45 offset:0
    ds_read_b64_tr_b16 a[82:83], v45 offset:512
    ds_read_b64_tr_b16 a[84:85], v45 offset:2048
    ds_read_b64_tr_b16 a[86:87], v45 offset:2560
    s_waitcnt lgkmcnt(0)
    s_barrier
    s_add_u32 s14, s62, 3145728
    s_addc_u32 s15, s63, 0
    s_mov_b32 m0, 122880
    s_nop 0
    global_load_lds_dwordx4 v40, s[14:15]
    s_mov_b32 m0, 123904
    s_nop 0
    global_load_lds_dwordx4 v41, s[14:15]
    s_mov_b32 m0, 124928
    s_nop 0
    global_load_lds_dwordx4 v42, s[14:15]
    s_mov_b32 m0, 125952
    s_nop 0
    global_load_lds_dwordx4 v43, s[14:15]
    s_waitcnt vmcnt(28)
    s_barrier
    v_add_u32 v44, 131072, v52
    v_xor_b32 v45, 32, v44
    ds_read_b64_tr_b16 a[24:25], v44 offset:0
    ds_read_b64_tr_b16 a[26:27], v44 offset:512
    ds_read_b64_tr_b16 a[28:29], v44 offset:2048
    ds_read_b64_tr_b16 a[30:31], v44 offset:2560
    ds_read_b64_tr_b16 a[88:89], v45 offset:0
    ds_read_b64_tr_b16 a[90:91], v45 offset:512
    ds_read_b64_tr_b16 a[92:93], v45 offset:2048
    ds_read_b64_tr_b16 a[94:95], v45 offset:2560
    s_waitcnt lgkmcnt(0)
    s_barrier
    s_add_u32 s14, s62, 3670016
    s_addc_u32 s15, s63, 0
    s_mov_b32 m0, 139264
    s_nop 0
    global_load_lds_dwordx4 v40, s[14:15]
    s_mov_b32 m0, 140288
    s_nop 0
    global_load_lds_dwordx4 v41, s[14:15]
    s_mov_b32 m0, 141312
    s_nop 0
    global_load_lds_dwordx4 v42, s[14:15]
    s_mov_b32 m0, 142336
    s_nop 0
    global_load_lds_dwordx4 v43, s[14:15]
    s_waitcnt vmcnt(28)
    s_barrier
    v_add_u32 v44, 16384, v52
    v_xor_b32 v45, 32, v44
    ds_read_b64_tr_b16 a[160:161], v44 offset:0
    ds_read_b64_tr_b16 a[162:163], v44 offset:512
    ds_read_b64_tr_b16 a[164:165], v44 offset:2048
    ds_read_b64_tr_b16 a[166:167], v44 offset:2560
    ds_read_b64_tr_b16 a[224:225], v45 offset:0
    ds_read_b64_tr_b16 a[226:227], v45 offset:512
    ds_read_b64_tr_b16 a[228:229], v45 offset:2048
    ds_read_b64_tr_b16 a[230:231], v45 offset:2560
    s_waitcnt lgkmcnt(0)
    s_barrier
    s_add_u32 s14, s64, 0
    s_addc_u32 s15, s65, 0
    s_mov_b32 m0, 24576
    s_nop 0
    global_load_lds_dwordx4 v40, s[14:15]
    s_mov_b32 m0, 25600
    s_nop 0
    global_load_lds_dwordx4 v41, s[14:15]
    s_mov_b32 m0, 26624
    s_nop 0
    global_load_lds_dwordx4 v42, s[14:15]
    s_mov_b32 m0, 27648
    s_nop 0
    global_load_lds_dwordx4 v43, s[14:15]
    s_waitcnt vmcnt(28)
    s_barrier
    v_add_u32 v44, 32768, v52
    v_xor_b32 v45, 32, v44
    ds_read_b64_tr_b16 a[168:169], v44 offset:0
    ds_read_b64_tr_b16 a[170:171], v44 offset:512
    ds_read_b64_tr_b16 a[172:173], v44 offset:2048
    ds_read_b64_tr_b16 a[174:175], v44 offset:2560
    ds_read_b64_tr_b16 a[232:233], v45 offset:0
    ds_read_b64_tr_b16 a[234:235], v45 offset:512
    ds_read_b64_tr_b16 a[236:237], v45 offset:2048
    ds_read_b64_tr_b16 a[238:239], v45 offset:2560
    s_waitcnt lgkmcnt(0)
    s_barrier
    s_add_u32 s14, s64, 524288
    s_addc_u32 s15, s65, 0
    s_mov_b32 m0, 40960
    s_nop 0
    global_load_lds_dwordx4 v40, s[14:15]
    s_mov_b32 m0, 41984
    s_nop 0
    global_load_lds_dwordx4 v41, s[14:15]
    s_mov_b32 m0, 43008
    s_nop 0
    global_load_lds_dwordx4 v42, s[14:15]
    s_mov_b32 m0, 44032
    s_nop 0
    global_load_lds_dwordx4 v43, s[14:15]
    s_waitcnt vmcnt(28)
    s_barrier
    v_add_u32 v44, 49152, v52
    v_xor_b32 v45, 32, v44
    ds_read_b64_tr_b16 a[176:177], v44 offset:0
    ds_read_b64_tr_b16 a[178:179], v44 offset:512
    ds_read_b64_tr_b16 a[180:181], v44 offset:2048
    ds_read_b64_tr_b16 a[182:183], v44 offset:2560
    ds_read_b64_tr_b16 a[240:241], v45 offset:0
    ds_read_b64_tr_b16 a[242:243], v45 offset:512
    ds_read_b64_tr_b16 a[244:245], v45 offset:2048
    ds_read_b64_tr_b16 a[246:247], v45 offset:2560
    s_waitcnt lgkmcnt(0)
    s_barrier
    s_add_u32 s14, s64, 1048576
    s_addc_u32 s15, s65, 0
    s_mov_b32 m0, 57344
    s_nop 0
    global_load_lds_dwordx4 v40, s[14:15]
    s_mov_b32 m0, 58368
    s_nop 0
    global_load_lds_dwordx4 v41, s[14:15]
    s_mov_b32 m0, 59392
    s_nop 0
    global_load_lds_dwordx4 v42, s[14:15]
    s_mov_b32 m0, 60416
    s_nop 0
    global_load_lds_dwordx4 v43, s[14:15]
    s_waitcnt vmcnt(28)
    s_barrier
    v_add_u32 v44, 65536, v52
    v_xor_b32 v45, 32, v44
    ds_read_b64_tr_b16 a[184:185], v44 offset:0
    ds_read_b64_tr_b16 a[186:187], v44 offset:512
    ds_read_b64_tr_b16 a[188:189], v44 offset:2048
    ds_read_b64_tr_b16 a[190:191], v44 offset:2560
    ds_read_b64_tr_b16 a[248:249], v45 offset:0
    ds_read_b64_tr_b16 a[250:251], v45 offset:512
    ds_read_b64_tr_b16 a[252:253], v45 offset:2048
    ds_read_b64_tr_b16 a[254:255], v45 offset:2560
    s_waitcnt lgkmcnt(0)
    s_barrier
    s_add_u32 s14, s64, 1572864
    s_addc_u32 s15, s65, 0
    s_mov_b32 m0, 73728
    s_nop 0
    global_load_lds_dwordx4 v40, s[14:15]
    s_mov_b32 m0, 74752
    s_nop 0
    global_load_lds_dwordx4 v41, s[14:15]
    s_mov_b32 m0, 75776
    s_nop 0
    global_load_lds_dwordx4 v42, s[14:15]
    s_mov_b32 m0, 76800
    s_nop 0
    global_load_lds_dwordx4 v43, s[14:15]
    s_waitcnt vmcnt(28)
    s_barrier
    v_add_u32 v44, 81920, v52
    v_xor_b32 v45, 32, v44
    ds_read_b64_tr_b16 a[128:129], v44 offset:0
    ds_read_b64_tr_b16 a[130:131], v44 offset:512
    ds_read_b64_tr_b16 a[132:133], v44 offset:2048
    ds_read_b64_tr_b16 a[134:135], v44 offset:2560
    ds_read_b64_tr_b16 a[192:193], v45 offset:0
    ds_read_b64_tr_b16 a[194:195], v45 offset:512
    ds_read_b64_tr_b16 a[196:197], v45 offset:2048
    ds_read_b64_tr_b16 a[198:199], v45 offset:2560
    s_waitcnt lgkmcnt(0)
    s_barrier
    s_add_u32 s14, s64, 2097152
    s_addc_u32 s15, s65, 0
    s_mov_b32 m0, 90112
    s_nop 0
    global_load_lds_dwordx4 v40, s[14:15]
    s_mov_b32 m0, 91136
    s_nop 0
    global_load_lds_dwordx4 v41, s[14:15]
    s_mov_b32 m0, 92160
    s_nop 0
    global_load_lds_dwordx4 v42, s[14:15]
    s_mov_b32 m0, 93184
    s_nop 0
    global_load_lds_dwordx4 v43, s[14:15]
    s_waitcnt vmcnt(28)
    s_barrier
    v_add_u32 v44, 98304, v52
    v_xor_b32 v45, 32, v44
    ds_read_b64_tr_b16 a[136:137], v44 offset:0
    ds_read_b64_tr_b16 a[138:139], v44 offset:512
    ds_read_b64_tr_b16 a[140:141], v44 offset:2048
    ds_read_b64_tr_b16 a[142:143], v44 offset:2560
    ds_read_b64_tr_b16 a[200:201], v45 offset:0
    ds_read_b64_tr_b16 a[202:203], v45 offset:512
    ds_read_b64_tr_b16 a[204:205], v45 offset:2048
    ds_read_b64_tr_b16 a[206:207], v45 offset:2560
    s_waitcnt lgkmcnt(0)
    s_barrier
    s_add_u32 s14, s64, 2621440
    s_addc_u32 s15, s65, 0
    s_mov_b32 m0, 106496
    s_nop 0
    global_load_lds_dwordx4 v40, s[14:15]
    s_mov_b32 m0, 107520
    s_nop 0
    global_load_lds_dwordx4 v41, s[14:15]
    s_mov_b32 m0, 108544
    s_nop 0
    global_load_lds_dwordx4 v42, s[14:15]
    s_mov_b32 m0, 109568
    s_nop 0
    global_load_lds_dwordx4 v43, s[14:15]
    s_waitcnt vmcnt(28)
    s_barrier
    v_add_u32 v44, 114688, v52
    v_xor_b32 v45, 32, v44
    ds_read_b64_tr_b16 a[144:145], v44 offset:0
    ds_read_b64_tr_b16 a[146:147], v44 offset:512
    ds_read_b64_tr_b16 a[148:149], v44 offset:2048
    ds_read_b64_tr_b16 a[150:151], v44 offset:2560
    ds_read_b64_tr_b16 a[208:209], v45 offset:0
    ds_read_b64_tr_b16 a[210:211], v45 offset:512
    ds_read_b64_tr_b16 a[212:213], v45 offset:2048
    ds_read_b64_tr_b16 a[214:215], v45 offset:2560
    s_waitcnt lgkmcnt(0)
    s_barrier
    s_add_u32 s14, s64, 3145728
    s_addc_u32 s15, s65, 0
    s_mov_b32 m0, 122880
    s_nop 0
    global_load_lds_dwordx4 v40, s[14:15]
    s_mov_b32 m0, 123904
    s_nop 0
    global_load_lds_dwordx4 v41, s[14:15]
    s_mov_b32 m0, 124928
    s_nop 0
    global_load_lds_dwordx4 v42, s[14:15]
    s_mov_b32 m0, 125952
    s_nop 0
    global_load_lds_dwordx4 v43, s[14:15]
    s_waitcnt vmcnt(28)
    s_barrier
    v_add_u32 v44, 131072, v52
    v_xor_b32 v45, 32, v44
    ds_read_b64_tr_b16 a[152:153], v44 offset:0
    ds_read_b64_tr_b16 a[154:155], v44 offset:512
    ds_read_b64_tr_b16 a[156:157], v44 offset:2048
    ds_read_b64_tr_b16 a[158:159], v44 offset:2560
    ds_read_b64_tr_b16 a[216:217], v45 offset:0
    ds_read_b64_tr_b16 a[218:219], v45 offset:512
    ds_read_b64_tr_b16 a[220:221], v45 offset:2048
    ds_read_b64_tr_b16 a[222:223], v45 offset:2560
    s_waitcnt lgkmcnt(0)
    s_barrier
    s_add_u32 s14, s64, 3670016
    s_addc_u32 s15, s65, 0
    s_mov_b32 m0, 139264
    s_nop 0
    global_load_lds_dwordx4 v40, s[14:15]
    s_mov_b32 m0, 140288
    s_nop 0
    global_load_lds_dwordx4 v41, s[14:15]
    s_mov_b32 m0, 141312
    s_nop 0
    global_load_lds_dwordx4 v42, s[14:15]
    s_mov_b32 m0, 142336
    s_nop 0
    global_load_lds_dwordx4 v43, s[14:15]
    s_waitcnt vmcnt(28)
    s_barrier
    v_add_u32 v44, 16384, v52
    v_xor_b32 v45, 32, v44
    ds_read_b64_tr_b16 v[160:161], v44 offset:0
    ds_read_b64_tr_b16 v[162:163], v44 offset:512
    ds_read_b64_tr_b16 v[164:165], v44 offset:2048
    ds_read_b64_tr_b16 v[166:167], v44 offset:2560
    ds_read_b64_tr_b16 v[224:225], v45 offset:0
    ds_read_b64_tr_b16 v[226:227], v45 offset:512
    ds_read_b64_tr_b16 v[228:229], v45 offset:2048
    ds_read_b64_tr_b16 v[230:231], v45 offset:2560
    s_waitcnt lgkmcnt(0)
    s_barrier
    s_add_u32 s14, s66, 8192
    s_addc_u32 s15, s67, 0
    v_xor_b32 v48, 0, v13
    s_mov_b32 m0, 24576
    s_nop 0
    global_load_lds_dwordx4 v48, s[14:15]
    s_add_u32 s14, s66, 9216
    s_addc_u32 s15, s67, 0
    v_xor_b32 v48, 32, v13
    s_mov_b32 m0, 25600
    s_nop 0
    global_load_lds_dwordx4 v48, s[14:15]
    s_add_u32 s14, s66, 10240
    s_addc_u32 s15, s67, 0
    v_xor_b32 v48, 0, v13
    s_mov_b32 m0, 26624
    s_nop 0
    global_load_lds_dwordx4 v48, s[14:15]
    s_add_u32 s14, s66, 11264
    s_addc_u32 s15, s67, 0
    v_xor_b32 v48, 32, v13
    s_mov_b32 m0, 27648
    s_nop 0
    global_load_lds_dwordx4 v48, s[14:15]
    s_waitcnt vmcnt(28)
    s_barrier
    v_add_u32 v44, 32768, v52
    v_xor_b32 v45, 32, v44
    ds_read_b64_tr_b16 v[168:169], v44 offset:0
    ds_read_b64_tr_b16 v[170:171], v44 offset:512
    ds_read_b64_tr_b16 v[172:173], v44 offset:2048
    ds_read_b64_tr_b16 v[174:175], v44 offset:2560
    ds_read_b64_tr_b16 v[232:233], v45 offset:0
    ds_read_b64_tr_b16 v[234:235], v45 offset:512
    ds_read_b64_tr_b16 v[236:237], v45 offset:2048
    ds_read_b64_tr_b16 v[238:239], v45 offset:2560
    s_waitcnt lgkmcnt(0)
    s_barrier
    s_add_u32 s14, s66, 24576
    s_addc_u32 s15, s67, 0
    v_xor_b32 v48, 64, v13
    s_mov_b32 m0, 40960
    s_nop 0
    global_load_lds_dwordx4 v48, s[14:15]
    s_add_u32 s14, s66, 25600
    s_addc_u32 s15, s67, 0
    v_xor_b32 v48, 96, v13
    s_mov_b32 m0, 41984
    s_nop 0
    global_load_lds_dwordx4 v48, s[14:15]
    s_add_u32 s14, s66, 26624
    s_addc_u32 s15, s67, 0
    v_xor_b32 v48, 64, v13
    s_mov_b32 m0, 43008
    s_nop 0
    global_load_lds_dwordx4 v48, s[14:15]
    s_add_u32 s14, s66, 27648
    s_addc_u32 s15, s67, 0
    v_xor_b32 v48, 96, v13
    s_mov_b32 m0, 44032
    s_nop 0
    global_load_lds_dwordx4 v48, s[14:15]
    s_waitcnt vmcnt(28)
    s_barrier
    v_add_u32 v44, 49152, v52
    v_xor_b32 v45, 32, v44
    ds_read_b64_tr_b16 v[176:177], v44 offset:0
    ds_read_b64_tr_b16 v[178:179], v44 offset:512
    ds_read_b64_tr_b16 v[180:181], v44 offset:2048
    ds_read_b64_tr_b16 v[182:183], v44 offset:2560
    ds_read_b64_tr_b16 v[240:241], v45 offset:0
    ds_read_b64_tr_b16 v[242:243], v45 offset:512
    ds_read_b64_tr_b16 v[244:245], v45 offset:2048
    ds_read_b64_tr_b16 v[246:247], v45 offset:2560
    s_waitcnt lgkmcnt(0)
    s_barrier
    s_add_u32 s14, s66, 40960
    s_addc_u32 s15, s67, 0
    v_xor_b32 v48, 128, v13
    s_mov_b32 m0, 57344
    s_nop 0
    global_load_lds_dwordx4 v48, s[14:15]
    s_add_u32 s14, s66, 41984
    s_addc_u32 s15, s67, 0
    v_xor_b32 v48, 160, v13
    s_mov_b32 m0, 58368
    s_nop 0
    global_load_lds_dwordx4 v48, s[14:15]
    s_add_u32 s14, s66, 43008
    s_addc_u32 s15, s67, 0
    v_xor_b32 v48, 128, v13
    s_mov_b32 m0, 59392
    s_nop 0
    global_load_lds_dwordx4 v48, s[14:15]
    s_add_u32 s14, s66, 44032
    s_addc_u32 s15, s67, 0
    v_xor_b32 v48, 160, v13
    s_mov_b32 m0, 60416
    s_nop 0
    global_load_lds_dwordx4 v48, s[14:15]
    s_waitcnt vmcnt(28)
    s_barrier
    v_add_u32 v44, 65536, v52
    v_xor_b32 v45, 32, v44
    ds_read_b64_tr_b16 v[184:185], v44 offset:0
    ds_read_b64_tr_b16 v[186:187], v44 offset:512
    ds_read_b64_tr_b16 v[188:189], v44 offset:2048
    ds_read_b64_tr_b16 v[190:191], v44 offset:2560
    ds_read_b64_tr_b16 v[248:249], v45 offset:0
    ds_read_b64_tr_b16 v[250:251], v45 offset:512
    ds_read_b64_tr_b16 v[252:253], v45 offset:2048
    ds_read_b64_tr_b16 v[254:255], v45 offset:2560
    s_waitcnt lgkmcnt(0)
    s_barrier
    s_add_u32 s14, s66, 57344
    s_addc_u32 s15, s67, 0
    v_xor_b32 v48, 192, v13
    s_mov_b32 m0, 73728
    s_nop 0
    global_load_lds_dwordx4 v48, s[14:15]
    s_add_u32 s14, s66, 58368
    s_addc_u32 s15, s67, 0
    v_xor_b32 v48, 224, v13
    s_mov_b32 m0, 74752
    s_nop 0
    global_load_lds_dwordx4 v48, s[14:15]
    s_add_u32 s14, s66, 59392
    s_addc_u32 s15, s67, 0
    v_xor_b32 v48, 192, v13
    s_mov_b32 m0, 75776
    s_nop 0
    global_load_lds_dwordx4 v48, s[14:15]
    s_add_u32 s14, s66, 60416
    s_addc_u32 s15, s67, 0
    v_xor_b32 v48, 224, v13
    s_mov_b32 m0, 76800
    s_nop 0
    global_load_lds_dwordx4 v48, s[14:15]
    s_waitcnt vmcnt(28)
    s_barrier
    v_add_u32 v44, 81920, v52
    v_xor_b32 v45, 32, v44
    ds_read_b64_tr_b16 v[128:129], v44 offset:0
    ds_read_b64_tr_b16 v[130:131], v44 offset:512
    ds_read_b64_tr_b16 v[132:133], v44 offset:2048
    ds_read_b64_tr_b16 v[134:135], v44 offset:2560
    ds_read_b64_tr_b16 v[192:193], v45 offset:0
    ds_read_b64_tr_b16 v[194:195], v45 offset:512
    ds_read_b64_tr_b16 v[196:197], v45 offset:2048
    ds_read_b64_tr_b16 v[198:199], v45 offset:2560
    s_waitcnt lgkmcnt(0)
    s_barrier
    s_add_u32 s14, s66, 73728
    s_addc_u32 s15, s67, 0
    v_xor_b32 v48, 0, v13
    s_mov_b32 m0, 90112
    s_nop 0
    global_load_lds_dwordx4 v48, s[14:15]
    s_add_u32 s14, s66, 74752
    s_addc_u32 s15, s67, 0
    v_xor_b32 v48, 32, v13
    s_mov_b32 m0, 91136
    s_nop 0
    global_load_lds_dwordx4 v48, s[14:15]
    s_add_u32 s14, s66, 75776
    s_addc_u32 s15, s67, 0
    v_xor_b32 v48, 0, v13
    s_mov_b32 m0, 92160
    s_nop 0
    global_load_lds_dwordx4 v48, s[14:15]
    s_add_u32 s14, s66, 76800
    s_addc_u32 s15, s67, 0
    v_xor_b32 v48, 32, v13
    s_mov_b32 m0, 93184
    s_nop 0
    global_load_lds_dwordx4 v48, s[14:15]
    s_waitcnt vmcnt(28)
    s_barrier
    v_add_u32 v44, 98304, v52
    v_xor_b32 v45, 32, v44
    ds_read_b64_tr_b16 v[136:137], v44 offset:0
    ds_read_b64_tr_b16 v[138:139], v44 offset:512
    ds_read_b64_tr_b16 v[140:141], v44 offset:2048
    ds_read_b64_tr_b16 v[142:143], v44 offset:2560
    ds_read_b64_tr_b16 v[200:201], v45 offset:0
    ds_read_b64_tr_b16 v[202:203], v45 offset:512
    ds_read_b64_tr_b16 v[204:205], v45 offset:2048
    ds_read_b64_tr_b16 v[206:207], v45 offset:2560
    s_waitcnt lgkmcnt(0)
    s_barrier
    s_add_u32 s14, s66, 90112
    s_addc_u32 s15, s67, 0
    v_xor_b32 v48, 64, v13
    s_mov_b32 m0, 106496
    s_nop 0
    global_load_lds_dwordx4 v48, s[14:15]
    s_add_u32 s14, s66, 91136
    s_addc_u32 s15, s67, 0
    v_xor_b32 v48, 96, v13
    s_mov_b32 m0, 107520
    s_nop 0
    global_load_lds_dwordx4 v48, s[14:15]
    s_add_u32 s14, s66, 92160
    s_addc_u32 s15, s67, 0
    v_xor_b32 v48, 64, v13
    s_mov_b32 m0, 108544
    s_nop 0
    global_load_lds_dwordx4 v48, s[14:15]
    s_add_u32 s14, s66, 93184
    s_addc_u32 s15, s67, 0
    v_xor_b32 v48, 96, v13
    s_mov_b32 m0, 109568
    s_nop 0
    global_load_lds_dwordx4 v48, s[14:15]
    s_waitcnt vmcnt(28)
    s_barrier
    v_add_u32 v44, 114688, v52
    v_xor_b32 v45, 32, v44
    ds_read_b64_tr_b16 v[56:57], v44 offset:0
    ds_read_b64_tr_b16 v[58:59], v44 offset:512
    ds_read_b64_tr_b16 v[60:61], v44 offset:2048
    ds_read_b64_tr_b16 v[62:63], v44 offset:2560
    ds_read_b64_tr_b16 v[64:65], v45 offset:0
    ds_read_b64_tr_b16 v[66:67], v45 offset:512
    ds_read_b64_tr_b16 v[68:69], v45 offset:2048
    ds_read_b64_tr_b16 v[70:71], v45 offset:2560
    s_waitcnt lgkmcnt(0)
    ds_write_b128 v55, v[56:59] offset:0
    ds_write_b128 v55, v[60:63] offset:1024
    ds_write_b128 v55, v[64:67] offset:2048
    ds_write_b128 v55, v[68:71] offset:3072
    s_waitcnt lgkmcnt(0)
    s_barrier
    s_add_u32 s14, s66, 106496
    s_addc_u32 s15, s67, 0
    v_xor_b32 v48, 128, v13
    s_mov_b32 m0, 122880
    s_nop 0
    global_load_lds_dwordx4 v48, s[14:15]
    s_add_u32 s14, s66, 107520
    s_addc_u32 s15, s67, 0
    v_xor_b32 v48, 160, v13
    s_mov_b32 m0, 123904
    s_nop 0
    global_load_lds_dwordx4 v48, s[14:15]
    s_add_u32 s14, s66, 108544
    s_addc_u32 s15, s67, 0
    v_xor_b32 v48, 128, v13
    s_mov_b32 m0, 124928
    s_nop 0
    global_load_lds_dwordx4 v48, s[14:15]
    s_add_u32 s14, s66, 109568
    s_addc_u32 s15, s67, 0
    v_xor_b32 v48, 160, v13
    s_mov_b32 m0, 125952
    s_nop 0
    global_load_lds_dwordx4 v48, s[14:15]
    s_waitcnt vmcnt(28)
    s_barrier
    v_add_u32 v44, 131072, v52
    v_xor_b32 v45, 32, v44
    ds_read_b64_tr_b16 v[56:57], v44 offset:0
    ds_read_b64_tr_b16 v[58:59], v44 offset:512
    ds_read_b64_tr_b16 v[60:61], v44 offset:2048
    ds_read_b64_tr_b16 v[62:63], v44 offset:2560
    ds_read_b64_tr_b16 v[64:65], v45 offset:0
    ds_read_b64_tr_b16 v[66:67], v45 offset:512
    ds_read_b64_tr_b16 v[68:69], v45 offset:2048
    ds_read_b64_tr_b16 v[70:71], v45 offset:2560
    s_waitcnt lgkmcnt(0)
    ds_write_b128 v55, v[56:59] offset:4096
    ds_write_b128 v55, v[60:63] offset:5120
    ds_write_b128 v55, v[64:67] offset:6144
    ds_write_b128 v55, v[68:71] offset:7168
    s_waitcnt lgkmcnt(0)
    s_barrier
    s_add_u32 s14, s66, 122880
    s_addc_u32 s15, s67, 0
    v_xor_b32 v48, 192, v13
    s_mov_b32 m0, 139264
    s_nop 0
    global_load_lds_dwordx4 v48, s[14:15]
    s_add_u32 s14, s66, 123904
    s_addc_u32 s15, s67, 0
    v_xor_b32 v48, 224, v13
    s_mov_b32 m0, 140288
    s_nop 0
    global_load_lds_dwordx4 v48, s[14:15]
    s_add_u32 s14, s66, 124928
    s_addc_u32 s15, s67, 0
    v_xor_b32 v48, 192, v13
    s_mov_b32 m0, 141312
    s_nop 0
    global_load_lds_dwordx4 v48, s[14:15]
    s_add_u32 s14, s66, 125952
    s_addc_u32 s15, s67, 0
    v_xor_b32 v48, 224, v13
    s_mov_b32 m0, 142336
    s_nop 0
    global_load_lds_dwordx4 v48, s[14:15]
    s_waitcnt vmcnt(0)
    s_barrier
    v_xor_b32 v54, 96, v53
    ds_read_b64_tr_b16 v[112:113], v54 offset:0
    ds_read_b64_tr_b16 v[114:115], v54 offset:2048
    ds_read_b64_tr_b16 v[116:117], v54 offset:8192
    ds_read_b64_tr_b16 v[118:119], v54 offset:10240
    v_xor_b32 v54, 128, v53
    ds_read_b64_tr_b16 v[144:145], v54 offset:0
    ds_read_b64_tr_b16 v[146:147], v54 offset:2048
    ds_read_b64_tr_b16 v[148:149], v54 offset:8192
    ds_read_b64_tr_b16 v[150:151], v54 offset:10240
    v_xor_b32 v54, 160, v53
    ds_read_b64_tr_b16 v[208:209], v54 offset:0
    ds_read_b64_tr_b16 v[210:211], v54 offset:2048
    ds_read_b64_tr_b16 v[212:213], v54 offset:8192
    ds_read_b64_tr_b16 v[214:215], v54 offset:10240
    v_xor_b32 v54, 0, v53
    ds_read_b64_tr_b16 v[56:57], v54 offset:0
    ds_read_b64_tr_b16 v[58:59], v54 offset:2048
    ds_read_b64_tr_b16 v[60:61], v54 offset:8192
    ds_read_b64_tr_b16 v[62:63], v54 offset:10240
    v_xor_b32 v54, 32, v53
    ds_read_b64_tr_b16 v[64:65], v54 offset:0
    ds_read_b64_tr_b16 v[66:67], v54 offset:2048
    ds_read_b64_tr_b16 v[68:69], v54 offset:8192
    ds_read_b64_tr_b16 v[70:71], v54 offset:10240
    v_xor_b32 v54, 64, v53
    ds_read_b64_tr_b16 v[72:73], v54 offset:0
    ds_read_b64_tr_b16 v[74:75], v54 offset:2048
    ds_read_b64_tr_b16 v[76:77], v54 offset:8192
    ds_read_b64_tr_b16 v[78:79], v54 offset:10240
    v_xor_b32 v54, 192, v53
    ds_read_b64_tr_b16 v[80:81], v54 offset:0
    ds_read_b64_tr_b16 v[82:83], v54 offset:2048
    ds_read_b64_tr_b16 v[84:85], v54 offset:8192
    ds_read_b64_tr_b16 v[86:87], v54 offset:10240
    v_xor_b32 v54, 224, v53
    ds_read_b64_tr_b16 v[88:89], v54 offset:0
    ds_read_b64_tr_b16 v[90:91], v54 offset:2048
    ds_read_b64_tr_b16 v[92:93], v54 offset:8192
    ds_read_b64_tr_b16 v[94:95], v54 offset:10240
    s_waitcnt lgkmcnt(0)
    s_barrier
    ds_write_b128 v14, v[56:59] offset:0
    ds_write_b128 v14, v[60:63] offset:1024
    ds_write_b128 v14, v[64:67] offset:2048
    ds_write_b128 v14, v[68:71] offset:3072
    ds_write_b128 v14, v[72:75] offset:4096
    ds_write_b128 v14, v[76:79] offset:5120
    ds_write_b128 v14, v[80:83] offset:6144
    ds_write_b128 v14, v[84:87] offset:7168
    ds_write_b128 v14, v[88:91] offset:8192
    ds_write_b128 v14, v[92:95] offset:9216
    s_waitcnt lgkmcnt(0)
    v_xor_b32 v54, 96, v53
    v_add_u32 v54, 65536, v54
    ds_read_b64_tr_b16 v[120:121], v54 offset:0
    ds_read_b64_tr_b16 v[122:123], v54 offset:2048
    ds_read_b64_tr_b16 v[124:125], v54 offset:8192
    ds_read_b64_tr_b16 v[126:127], v54 offset:10240
    v_xor_b32 v54, 128, v53
    v_add_u32 v54, 65536, v54
    ds_read_b64_tr_b16 v[152:153], v54 offset:0
    ds_read_b64_tr_b16 v[154:155], v54 offset:2048
    ds_read_b64_tr_b16 v[156:157], v54 offset:8192
    ds_read_b64_tr_b16 v[158:159], v54 offset:10240
    v_xor_b32 v54, 160, v53
    v_add_u32 v54, 65536, v54
    ds_read_b64_tr_b16 v[216:217], v54 offset:0
    ds_read_b64_tr_b16 v[218:219], v54 offset:2048
    ds_read_b64_tr_b16 v[220:221], v54 offset:8192
    ds_read_b64_tr_b16 v[222:223], v54 offset:10240
    v_xor_b32 v54, 0, v53
    v_add_u32 v54, 65536, v54
    ds_read_b64_tr_b16 v[56:57], v54 offset:0
    ds_read_b64_tr_b16 v[58:59], v54 offset:2048
    ds_read_b64_tr_b16 v[60:61], v54 offset:8192
    ds_read_b64_tr_b16 v[62:63], v54 offset:10240
    v_xor_b32 v54, 32, v53
    v_add_u32 v54, 65536, v54
    ds_read_b64_tr_b16 v[64:65], v54 offset:0
    ds_read_b64_tr_b16 v[66:67], v54 offset:2048
    ds_read_b64_tr_b16 v[68:69], v54 offset:8192
    ds_read_b64_tr_b16 v[70:71], v54 offset:10240
    v_xor_b32 v54, 64, v53
    v_add_u32 v54, 65536, v54
    ds_read_b64_tr_b16 v[72:73], v54 offset:0
    ds_read_b64_tr_b16 v[74:75], v54 offset:2048
    ds_read_b64_tr_b16 v[76:77], v54 offset:8192
    ds_read_b64_tr_b16 v[78:79], v54 offset:10240
    v_xor_b32 v54, 192, v53
    v_add_u32 v54, 65536, v54
    ds_read_b64_tr_b16 v[80:81], v54 offset:0
    ds_read_b64_tr_b16 v[82:83], v54 offset:2048
    ds_read_b64_tr_b16 v[84:85], v54 offset:8192
    ds_read_b64_tr_b16 v[86:87], v54 offset:10240
    v_xor_b32 v54, 224, v53
    v_add_u32 v54, 65536, v54
    ds_read_b64_tr_b16 v[88:89], v54 offset:0
    ds_read_b64_tr_b16 v[90:91], v54 offset:2048
    ds_read_b64_tr_b16 v[92:93], v54 offset:8192
    ds_read_b64_tr_b16 v[94:95], v54 offset:10240
    s_waitcnt lgkmcnt(0)
    s_barrier
    ds_write_b128 v15, v[56:59] offset:0
    ds_write_b128 v15, v[60:63] offset:1024
    ds_write_b128 v15, v[64:67] offset:2048
    ds_write_b128 v15, v[68:71] offset:3072
    ds_write_b128 v15, v[72:75] offset:4096
    ds_write_b128 v15, v[76:79] offset:5120
    ds_write_b128 v15, v[80:83] offset:6144
    ds_write_b128 v15, v[84:87] offset:7168
    ds_write_b128 v15, v[88:91] offset:8192
    ds_write_b128 v15, v[92:95] offset:9216
    s_waitcnt lgkmcnt(0)
    ds_read_b128 v[56:59], v55 offset:0
    ds_read_b128 v[60:63], v55 offset:1024
    ds_read_b128 v[64:67], v55 offset:2048
    ds_read_b128 v[68:71], v55 offset:3072
    ds_read_b128 v[72:75], v55 offset:4096
    ds_read_b128 v[76:79], v55 offset:5120
    ds_read_b128 v[80:83], v55 offset:6144
    ds_read_b128 v[84:87], v55 offset:7168
    v_add_u32 v54, 114688, v13
    s_waitcnt lgkmcnt(0)
    ds_write_b128 v54, v[56:59] offset:0
    ds_write_b128 v54, v[60:63] offset:1024
    ds_write_b128 v54, v[64:67] offset:2048
    ds_write_b128 v54, v[68:71] offset:3072
    ds_write_b128 v54, v[72:75] offset:4096
    ds_write_b128 v54, v[76:79] offset:5120
    ds_write_b128 v54, v[80:83] offset:6144
    ds_write_b128 v54, v[84:87] offset:7168
    s_waitcnt lgkmcnt(0)
    s_branch L_wdone_2
L_w3_6:
    v_lshrrev_b32 v46, 4, v0
    v_and_b32 v47, 1, v46
    v_or_b32 v47, 6, v47
    v_lshlrev_b32 v47, 1, v47
    v_and_b32 v48, 15, v0
    v_xor_b32 v48, v48, v47
    v_lshlrev_b32 v48, 4, v48
    v_add_u32 v46, 48, v46
    v_lshlrev_b32 v46, 13, v46
    v_add_u32 v40, v46, v48
    v_add_u32 v41, 32768, v40
    v_add_u32 v42, 65536, v40
    v_add_u32 v43, 98304, v40
    v_bfe_u32 v46, v0, 3, 1
    v_bfe_u32 v47, v0, 4, 1
    v_bfe_u32 v48, v0, 2, 1
    v_lshlrev_b32 v49, 2, v46
    v_lshl_or_b32 v49, v47, 1, v49
    v_or_b32 v49, v49, v48
    v_lshlrev_b32 v50, 5, v46
    v_lshl_or_b32 v50, v47, 4, v50
    v_or_b32 v50, v50, v48
    v_bfe_u32 v51, v0, 5, 1
    v_lshl_or_b32 v50, v51, 2, v50
    v_and_b32 v51, 3, v0
    v_lshlrev_b32 v51, 3, v51
    v_xor_b32 v52, 6, v49
    v_lshlrev_b32 v52, 5, v52
    v_lshl_or_b32 v52, v50, 8, v52
    v_add_u32 v52, v52, v51
    v_lshlrev_b32 v53, 5, v49
    v_lshl_or_b32 v53, v50, 10, v53
    v_add_u32 v53, v53, v51
    v_add_u32 v53, 17152, v53
    v_add_u32 v55, 155648, v13
    s_add_u32 s14, s60, 0
    s_addc_u32 s15, s61, 0
    s_mov_b32 m0, 28672
    s_nop 0
    global_load_lds_dwordx4 v40, s[14:15]
    s_mov_b32 m0, 29696
    s_nop 0
    global_load_lds_dwordx4 v41, s[14:15]
    s_mov_b32 m0, 30720
    s_nop 0
    global_load_lds_dwordx4 v42, s[14:15]
    s_mov_b32 m0, 31744
    s_nop 0
    global_load_lds_dwordx4 v43, s[14:15]
    s_add_u32 s14, s60, 524288
    s_addc_u32 s15, s61, 0
    s_mov_b32 m0, 45056
    s_nop 0
    global_load_lds_dwordx4 v40, s[14:15]
    s_mov_b32 m0, 46080
    s_nop 0
    global_load_lds_dwordx4 v41, s[14:15]
    s_mov_b32 m0, 47104
    s_nop 0
    global_load_lds_dwordx4 v42, s[14:15]
    s_mov_b32 m0, 48128
    s_nop 0
    global_load_lds_dwordx4 v43, s[14:15]
    s_add_u32 s14, s60, 1048576
    s_addc_u32 s15, s61, 0
    s_mov_b32 m0, 61440
    s_nop 0
    global_load_lds_dwordx4 v40, s[14:15]
    s_mov_b32 m0, 62464
    s_nop 0
    global_load_lds_dwordx4 v41, s[14:15]
    s_mov_b32 m0, 63488
    s_nop 0
    global_load_lds_dwordx4 v42, s[14:15]
    s_mov_b32 m0, 64512
    s_nop 0
    global_load_lds_dwordx4 v43, s[14:15]
    s_add_u32 s14, s60, 1572864
    s_addc_u32 s15, s61, 0
    s_mov_b32 m0, 77824
    s_nop 0
    global_load_lds_dwordx4 v40, s[14:15]
    s_mov_b32 m0, 78848
    s_nop 0
    global_load_lds_dwordx4 v41, s[14:15]
    s_mov_b32 m0, 79872
    s_nop 0
    global_load_lds_dwordx4 v42, s[14:15]
    s_mov_b32 m0, 80896
    s_nop 0
    global_load_lds_dwordx4 v43, s[14:15]
    s_add_u32 s14, s60, 2097152
    s_addc_u32 s15, s61, 0
    s_mov_b32 m0, 94208
    s_nop 0
    global_load_lds_dwordx4 v40, s[14:15]
    s_mov_b32 m0, 95232
    s_nop 0
    global_load_lds_dwordx4 v41, s[14:15]
    s_mov_b32 m0, 96256
    s_nop 0
    global_load_lds_dwordx4 v42, s[14:15]
    s_mov_b32 m0, 97280
    s_nop 0
    global_load_lds_dwordx4 v43, s[14:15]
    s_add_u32 s14, s60, 2621440
    s_addc_u32 s15, s61, 0
    s_mov_b32 m0, 110592
    s_nop 0
    global_load_lds_dwordx4 v40, s[14:15]
    s_mov_b32 m0, 111616
    s_nop 0
    global_load_lds_dwordx4 v41, s[14:15]
    s_mov_b32 m0, 112640
    s_nop 0
    global_load_lds_dwordx4 v42, s[14:15]
    s_mov_b32 m0, 113664
    s_nop 0
    global_load_lds_dwordx4 v43, s[14:15]
    s_add_u32 s14, s60, 3145728
    s_addc_u32 s15, s61, 0
    s_mov_b32 m0, 126976
    s_nop 0
    global_load_lds_dwordx4 v40, s[14:15]
    s_mov_b32 m0, 128000
    s_nop 0
    global_load_lds_dwordx4 v41, s[14:15]
    s_mov_b32 m0, 129024
    s_nop 0
    global_load_lds_dwordx4 v42, s[14:15]
    s_mov_b32 m0, 130048
    s_nop 0
    global_load_lds_dwordx4 v43, s[14:15]
    s_add_u32 s14, s60, 3670016
    s_addc_u32 s15, s61, 0
    s_mov_b32 m0, 143360
    s_nop 0
    global_load_lds_dwordx4 v40, s[14:15]
    s_mov_b32 m0, 144384
    s_nop 0
    global_load_lds_dwordx4 v41, s[14:15]
    s_mov_b32 m0, 145408
    s_nop 0
    global_load_lds_dwordx4 v42, s[14:15]
    s_mov_b32 m0, 146432
    s_nop 0
    global_load_lds_dwordx4 v43, s[14:15]
    s_waitcnt vmcnt(28)
    s_barrier
    v_add_u32 v44, 16384, v52
    v_xor_b32 v45, 32, v44
    ds_read_b64_tr_b16 a[16:17], v44 offset:0
    ds_read_b64_tr_b16 a[18:19], v44 offset:512
    ds_read_b64_tr_b16 a[20:21], v44 offset:2048
    ds_read_b64_tr_b16 a[22:23], v44 offset:2560
    ds_read_b64_tr_b16 a[80:81], v45 offset:0
    ds_read_b64_tr_b16 a[82:83], v45 offset:512
    ds_read_b64_tr_b16 a[84:85], v45 offset:2048
    ds_read_b64_tr_b16 a[86:87], v45 offset:2560
    s_waitcnt lgkmcnt(0)
    s_barrier
    s_add_u32 s14, s62, 0
    s_addc_u32 s15, s63, 0
    s_mov_b32 m0, 28672
    s_nop 0
    global_load_lds_dwordx4 v40, s[14:15]
    s_mov_b32 m0, 29696
    s_nop 0
    global_load_lds_dwordx4 v41, s[14:15]
    s_mov_b32 m0, 30720
    s_nop 0
    global_load_lds_dwordx4 v42, s[14:15]
    s_mov_b32 m0, 31744
    s_nop 0
    global_load_lds_dwordx4 v43, s[14:15]
    s_waitcnt vmcnt(28)
    s_barrier
    v_add_u32 v44, 32768, v52
    v_xor_b32 v45, 32, v44
    ds_read_b64_tr_b16 a[24:25], v44 offset:0
    ds_read_b64_tr_b16 a[26:27], v44 offset:512
    ds_read_b64_tr_b16 a[28:29], v44 offset:2048
    ds_read_b64_tr_b16 a[30:31], v44 offset:2560
    ds_read_b64_tr_b16 a[88:89], v45 offset:0
    ds_read_b64_tr_b16 a[90:91], v45 offset:512
    ds_read_b64_tr_b16 a[92:93], v45 offset:2048
    ds_read_b64_tr_b16 a[94:95], v45 offset:2560
    s_waitcnt lgkmcnt(0)
    s_barrier
    s_add_u32 s14, s62, 524288
    s_addc_u32 s15, s63, 0
    s_mov_b32 m0, 45056
    s_nop 0
    global_load_lds_dwordx4 v40, s[14:15]
    s_mov_b32 m0, 46080
    s_nop 0
    global_load_lds_dwordx4 v41, s[14:15]
    s_mov_b32 m0, 47104
    s_nop 0
    global_load_lds_dwordx4 v42, s[14:15]
    s_mov_b32 m0, 48128
    s_nop 0
    global_load_lds_dwordx4 v43, s[14:15]
    s_waitcnt vmcnt(28)
    s_barrier
    v_add_u32 v44, 49152, v52
    v_xor_b32 v45, 32, v44
    ds_read_b64_tr_b16 a[32:33], v44 offset:0
    ds_read_b64_tr_b16 a[34:35], v44 offset:512
    ds_read_b64_tr_b16 a[36:37], v44 offset:2048
    ds_read_b64_tr_b16 a[38:39], v44 offset:2560
    ds_read_b64_tr_b16 a[96:97], v45 offset:0
    ds_read_b64_tr_b16 a[98:99], v45 offset:512
    ds_read_b64_tr_b16 a[100:101], v45 offset:2048
    ds_read_b64_tr_b16 a[102:103], v45 offset:2560
    s_waitcnt lgkmcnt(0)
    s_barrier
    s_add_u32 s14, s62, 1048576
    s_addc_u32 s15, s63, 0
    s_mov_b32 m0, 61440
    s_nop 0
    global_load_lds_dwordx4 v40, s[14:15]
    s_mov_b32 m0, 62464
    s_nop 0
    global_load_lds_dwordx4 v41, s[14:15]
    s_mov_b32 m0, 63488
    s_nop 0
    global_load_lds_dwordx4 v42, s[14:15]
    s_mov_b32 m0, 64512
    s_nop 0
    global_load_lds_dwordx4 v43, s[14:15]
    s_waitcnt vmcnt(28)
    s_barrier
    v_add_u32 v44, 65536, v52
    v_xor_b32 v45, 32, v44
    ds_read_b64_tr_b16 a[40:41], v44 offset:0
    ds_read_b64_tr_b16 a[42:43], v44 offset:512
    ds_read_b64_tr_b16 a[44:45], v44 offset:2048
    ds_read_b64_tr_b16 a[46:47], v44 offset:2560
    ds_read_b64_tr_b16 a[104:105], v45 offset:0
    ds_read_b64_tr_b16 a[106:107], v45 offset:512
    ds_read_b64_tr_b16 a[108:109], v45 offset:2048
    ds_read_b64_tr_b16 a[110:111], v45 offset:2560
    s_waitcnt lgkmcnt(0)
    s_barrier
    s_add_u32 s14, s62, 1572864
    s_addc_u32 s15, s63, 0
    s_mov_b32 m0, 77824
    s_nop 0
    global_load_lds_dwordx4 v40, s[14:15]
    s_mov_b32 m0, 78848
    s_nop 0
    global_load_lds_dwordx4 v41, s[14:15]
    s_mov_b32 m0, 79872
    s_nop 0
    global_load_lds_dwordx4 v42, s[14:15]
    s_mov_b32 m0, 80896
    s_nop 0
    global_load_lds_dwordx4 v43, s[14:15]
    s_waitcnt vmcnt(28)
    s_barrier
    v_add_u32 v44, 81920, v52
    v_xor_b32 v45, 32, v44
    ds_read_b64_tr_b16 a[48:49], v44 offset:0
    ds_read_b64_tr_b16 a[50:51], v44 offset:512
    ds_read_b64_tr_b16 a[52:53], v44 offset:2048
    ds_read_b64_tr_b16 a[54:55], v44 offset:2560
    ds_read_b64_tr_b16 a[112:113], v45 offset:0
    ds_read_b64_tr_b16 a[114:115], v45 offset:512
    ds_read_b64_tr_b16 a[116:117], v45 offset:2048
    ds_read_b64_tr_b16 a[118:119], v45 offset:2560
    s_waitcnt lgkmcnt(0)
    s_barrier
    s_add_u32 s14, s62, 2097152
    s_addc_u32 s15, s63, 0
    s_mov_b32 m0, 94208
    s_nop 0
    global_load_lds_dwordx4 v40, s[14:15]
    s_mov_b32 m0, 95232
    s_nop 0
    global_load_lds_dwordx4 v41, s[14:15]
    s_mov_b32 m0, 96256
    s_nop 0
    global_load_lds_dwordx4 v42, s[14:15]
    s_mov_b32 m0, 97280
    s_nop 0
    global_load_lds_dwordx4 v43, s[14:15]
    s_waitcnt vmcnt(28)
    s_barrier
    v_add_u32 v44, 98304, v52
    v_xor_b32 v45, 32, v44
    ds_read_b64_tr_b16 a[56:57], v44 offset:0
    ds_read_b64_tr_b16 a[58:59], v44 offset:512
    ds_read_b64_tr_b16 a[60:61], v44 offset:2048
    ds_read_b64_tr_b16 a[62:63], v44 offset:2560
    ds_read_b64_tr_b16 a[120:121], v45 offset:0
    ds_read_b64_tr_b16 a[122:123], v45 offset:512
    ds_read_b64_tr_b16 a[124:125], v45 offset:2048
    ds_read_b64_tr_b16 a[126:127], v45 offset:2560
    s_waitcnt lgkmcnt(0)
    s_barrier
    s_add_u32 s14, s62, 2621440
    s_addc_u32 s15, s63, 0
    s_mov_b32 m0, 110592
    s_nop 0
    global_load_lds_dwordx4 v40, s[14:15]
    s_mov_b32 m0, 111616
    s_nop 0
    global_load_lds_dwordx4 v41, s[14:15]
    s_mov_b32 m0, 112640
    s_nop 0
    global_load_lds_dwordx4 v42, s[14:15]
    s_mov_b32 m0, 113664
    s_nop 0
    global_load_lds_dwordx4 v43, s[14:15]
    s_waitcnt vmcnt(28)
    s_barrier
    v_add_u32 v44, 114688, v52
    v_xor_b32 v45, 32, v44
    ds_read_b64_tr_b16 a[0:1], v44 offset:0
    ds_read_b64_tr_b16 a[2:3], v44 offset:512
    ds_read_b64_tr_b16 a[4:5], v44 offset:2048
    ds_read_b64_tr_b16 a[6:7], v44 offset:2560
    ds_read_b64_tr_b16 a[64:65], v45 offset:0
    ds_read_b64_tr_b16 a[66:67], v45 offset:512
    ds_read_b64_tr_b16 a[68:69], v45 offset:2048
    ds_read_b64_tr_b16 a[70:71], v45 offset:2560
    s_waitcnt lgkmcnt(0)
    s_barrier
    s_add_u32 s14, s62, 3145728
    s_addc_u32 s15, s63, 0
    s_mov_b32 m0, 126976
    s_nop 0
    global_load_lds_dwordx4 v40, s[14:15]
    s_mov_b32 m0, 128000
    s_nop 0
    global_load_lds_dwordx4 v41, s[14:15]
    s_mov_b32 m0, 129024
    s_nop 0
    global_load_lds_dwordx4 v42, s[14:15]
    s_mov_b32 m0, 130048
    s_nop 0
    global_load_lds_dwordx4 v43, s[14:15]
    s_waitcnt vmcnt(28)
    s_barrier
    v_add_u32 v44, 131072, v52
    v_xor_b32 v45, 32, v44
    ds_read_b64_tr_b16 a[8:9], v44 offset:0
    ds_read_b64_tr_b16 a[10:11], v44 offset:512
    ds_read_b64_tr_b16 a[12:13], v44 offset:2048
    ds_read_b64_tr_b16 a[14:15], v44 offset:2560
    ds_read_b64_tr_b16 a[72:73], v45 offset:0
    ds_read_b64_tr_b16 a[74:75], v45 offset:512
    ds_read_b64_tr_b16 a[76:77], v45 offset:2048
    ds_read_b64_tr_b16 a[78:79], v45 offset:2560
    s_waitcnt lgkmcnt(0)
    s_barrier
    s_add_u32 s14, s62, 3670016
    s_addc_u32 s15, s63, 0
    s_mov_b32 m0, 143360
    s_nop 0
    global_load_lds_dwordx4 v40, s[14:15]
    s_mov_b32 m0, 144384
    s_nop 0
    global_load_lds_dwordx4 v41, s[14:15]
    s_mov_b32 m0, 145408
    s_nop 0
    global_load_lds_dwordx4 v42, s[14:15]
    s_mov_b32 m0, 146432
    s_nop 0
    global_load_lds_dwordx4 v43, s[14:15]
    s_waitcnt vmcnt(28)
    s_barrier
    v_add_u32 v44, 16384, v52
    v_xor_b32 v45, 32, v44
    ds_read_b64_tr_b16 a[144:145], v44 offset:0
    ds_read_b64_tr_b16 a[146:147], v44 offset:512
    ds_read_b64_tr_b16 a[148:149], v44 offset:2048
    ds_read_b64_tr_b16 a[150:151], v44 offset:2560
    ds_read_b64_tr_b16 a[208:209], v45 offset:0
    ds_read_b64_tr_b16 a[210:211], v45 offset:512
    ds_read_b64_tr_b16 a[212:213], v45 offset:2048
    ds_read_b64_tr_b16 a[214:215], v45 offset:2560
    s_waitcnt lgkmcnt(0)
    s_barrier
    s_add_u32 s14, s64, 0
    s_addc_u32 s15, s65, 0
    s_mov_b32 m0, 28672
    s_nop 0
    global_load_lds_dwordx4 v40, s[14:15]
    s_mov_b32 m0, 29696
    s_nop 0
    global_load_lds_dwordx4 v41, s[14:15]
    s_mov_b32 m0, 30720
    s_nop 0
    global_load_lds_dwordx4 v42, s[14:15]
    s_mov_b32 m0, 31744
    s_nop 0
    global_load_lds_dwordx4 v43, s[14:15]
    s_waitcnt vmcnt(28)
    s_barrier
    v_add_u32 v44, 32768, v52
    v_xor_b32 v45, 32, v44
    ds_read_b64_tr_b16 a[152:153], v44 offset:0
    ds_read_b64_tr_b16 a[154:155], v44 offset:512
    ds_read_b64_tr_b16 a[156:157], v44 offset:2048
    ds_read_b64_tr_b16 a[158:159], v44 offset:2560
    ds_read_b64_tr_b16 a[216:217], v45 offset:0
    ds_read_b64_tr_b16 a[218:219], v45 offset:512
    ds_read_b64_tr_b16 a[220:221], v45 offset:2048
    ds_read_b64_tr_b16 a[222:223], v45 offset:2560
    s_waitcnt lgkmcnt(0)
    s_barrier
    s_add_u32 s14, s64, 524288
    s_addc_u32 s15, s65, 0
    s_mov_b32 m0, 45056
    s_nop 0
    global_load_lds_dwordx4 v40, s[14:15]
    s_mov_b32 m0, 46080
    s_nop 0
    global_load_lds_dwordx4 v41, s[14:15]
    s_mov_b32 m0, 47104
    s_nop 0
    global_load_lds_dwordx4 v42, s[14:15]
    s_mov_b32 m0, 48128
    s_nop 0
    global_load_lds_dwordx4 v43, s[14:15]
    s_waitcnt vmcnt(28)
    s_barrier
    v_add_u32 v44, 49152, v52
    v_xor_b32 v45, 32, v44
    ds_read_b64_tr_b16 a[160:161], v44 offset:0
    ds_read_b64_tr_b16 a[162:163], v44 offset:512
    ds_read_b64_tr_b16 a[164:165], v44 offset:2048
    ds_read_b64_tr_b16 a[166:167], v44 offset:2560
    ds_read_b64_tr_b16 a[224:225], v45 offset:0
    ds_read_b64_tr_b16 a[226:227], v45 offset:512
    ds_read_b64_tr_b16 a[228:229], v45 offset:2048
    ds_read_b64_tr_b16 a[230:231], v45 offset:2560
    s_waitcnt lgkmcnt(0)
    s_barrier
    s_add_u32 s14, s64, 1048576
    s_addc_u32 s15, s65, 0
    s_mov_b32 m0, 61440
    s_nop 0
    global_load_lds_dwordx4 v40, s[14:15]
    s_mov_b32 m0, 62464
    s_nop 0
    global_load_lds_dwordx4 v41, s[14:15]
    s_mov_b32 m0, 63488
    s_nop 0
    global_load_lds_dwordx4 v42, s[14:15]
    s_mov_b32 m0, 64512
    s_nop 0
    global_load_lds_dwordx4 v43, s[14:15]
    s_waitcnt vmcnt(28)
    s_barrier
    v_add_u32 v44, 65536, v52
    v_xor_b32 v45, 32, v44
    ds_read_b64_tr_b16 a[168:169], v44 offset:0
    ds_read_b64_tr_b16 a[170:171], v44 offset:512
    ds_read_b64_tr_b16 a[172:173], v44 offset:2048
    ds_read_b64_tr_b16 a[174:175], v44 offset:2560
    ds_read_b64_tr_b16 a[232:233], v45 offset:0
    ds_read_b64_tr_b16 a[234:235], v45 offset:512
    ds_read_b64_tr_b16 a[236:237], v45 offset:2048
    ds_read_b64_tr_b16 a[238:239], v45 offset:2560
    s_waitcnt lgkmcnt(0)
    s_barrier
    s_add_u32 s14, s64, 1572864
    s_addc_u32 s15, s65, 0
    s_mov_b32 m0, 77824
    s_nop 0
    global_load_lds_dwordx4 v40, s[14:15]
    s_mov_b32 m0, 78848
    s_nop 0
    global_load_lds_dwordx4 v41, s[14:15]
    s_mov_b32 m0, 79872
    s_nop 0
    global_load_lds_dwordx4 v42, s[14:15]
    s_mov_b32 m0, 80896
    s_nop 0
    global_load_lds_dwordx4 v43, s[14:15]
    s_waitcnt vmcnt(28)
    s_barrier
    v_add_u32 v44, 81920, v52
    v_xor_b32 v45, 32, v44
    ds_read_b64_tr_b16 a[176:177], v44 offset:0
    ds_read_b64_tr_b16 a[178:179], v44 offset:512
    ds_read_b64_tr_b16 a[180:181], v44 offset:2048
    ds_read_b64_tr_b16 a[182:183], v44 offset:2560
    ds_read_b64_tr_b16 a[240:241], v45 offset:0
    ds_read_b64_tr_b16 a[242:243], v45 offset:512
    ds_read_b64_tr_b16 a[244:245], v45 offset:2048
    ds_read_b64_tr_b16 a[246:247], v45 offset:2560
    s_waitcnt lgkmcnt(0)
    s_barrier
    s_add_u32 s14, s64, 2097152
    s_addc_u32 s15, s65, 0
    s_mov_b32 m0, 94208
    s_nop 0
    global_load_lds_dwordx4 v40, s[14:15]
    s_mov_b32 m0, 95232
    s_nop 0
    global_load_lds_dwordx4 v41, s[14:15]
    s_mov_b32 m0, 96256
    s_nop 0
    global_load_lds_dwordx4 v42, s[14:15]
    s_mov_b32 m0, 97280
    s_nop 0
    global_load_lds_dwordx4 v43, s[14:15]
    s_waitcnt vmcnt(28)
    s_barrier
    v_add_u32 v44, 98304, v52
    v_xor_b32 v45, 32, v44
    ds_read_b64_tr_b16 a[184:185], v44 offset:0
    ds_read_b64_tr_b16 a[186:187], v44 offset:512
    ds_read_b64_tr_b16 a[188:189], v44 offset:2048
    ds_read_b64_tr_b16 a[190:191], v44 offset:2560
    ds_read_b64_tr_b16 a[248:249], v45 offset:0
    ds_read_b64_tr_b16 a[250:251], v45 offset:512
    ds_read_b64_tr_b16 a[252:253], v45 offset:2048
    ds_read_b64_tr_b16 a[254:255], v45 offset:2560
    s_waitcnt lgkmcnt(0)
    s_barrier
    s_add_u32 s14, s64, 2621440
    s_addc_u32 s15, s65, 0
    s_mov_b32 m0, 110592
    s_nop 0
    global_load_lds_dwordx4 v40, s[14:15]
    s_mov_b32 m0, 111616
    s_nop 0
    global_load_lds_dwordx4 v41, s[14:15]
    s_mov_b32 m0, 112640
    s_nop 0
    global_load_lds_dwordx4 v42, s[14:15]
    s_mov_b32 m0, 113664
    s_nop 0
    global_load_lds_dwordx4 v43, s[14:15]
    s_waitcnt vmcnt(28)
    s_barrier
    v_add_u32 v44, 114688, v52
    v_xor_b32 v45, 32, v44
    ds_read_b64_tr_b16 a[128:129], v44 offset:0
    ds_read_b64_tr_b16 a[130:131], v44 offset:512
    ds_read_b64_tr_b16 a[132:133], v44 offset:2048
    ds_read_b64_tr_b16 a[134:135], v44 offset:2560
    ds_read_b64_tr_b16 a[192:193], v45 offset:0
    ds_read_b64_tr_b16 a[194:195], v45 offset:512
    ds_read_b64_tr_b16 a[196:197], v45 offset:2048
    ds_read_b64_tr_b16 a[198:199], v45 offset:2560
    s_waitcnt lgkmcnt(0)
    s_barrier
    s_add_u32 s14, s64, 3145728
    s_addc_u32 s15, s65, 0
    s_mov_b32 m0, 126976
    s_nop 0
    global_load_lds_dwordx4 v40, s[14:15]
    s_mov_b32 m0, 128000
    s_nop 0
    global_load_lds_dwordx4 v41, s[14:15]
    s_mov_b32 m0, 129024
    s_nop 0
    global_load_lds_dwordx4 v42, s[14:15]
    s_mov_b32 m0, 130048
    s_nop 0
    global_load_lds_dwordx4 v43, s[14:15]
    s_waitcnt vmcnt(28)
    s_barrier
    v_add_u32 v44, 131072, v52
    v_xor_b32 v45, 32, v44
    ds_read_b64_tr_b16 a[136:137], v44 offset:0
    ds_read_b64_tr_b16 a[138:139], v44 offset:512
    ds_read_b64_tr_b16 a[140:141], v44 offset:2048
    ds_read_b64_tr_b16 a[142:143], v44 offset:2560
    ds_read_b64_tr_b16 a[200:201], v45 offset:0
    ds_read_b64_tr_b16 a[202:203], v45 offset:512
    ds_read_b64_tr_b16 a[204:205], v45 offset:2048
    ds_read_b64_tr_b16 a[206:207], v45 offset:2560
    s_waitcnt lgkmcnt(0)
    s_barrier
    s_add_u32 s14, s64, 3670016
    s_addc_u32 s15, s65, 0
    s_mov_b32 m0, 143360
    s_nop 0
    global_load_lds_dwordx4 v40, s[14:15]
    s_mov_b32 m0, 144384
    s_nop 0
    global_load_lds_dwordx4 v41, s[14:15]
    s_mov_b32 m0, 145408
    s_nop 0
    global_load_lds_dwordx4 v42, s[14:15]
    s_mov_b32 m0, 146432
    s_nop 0
    global_load_lds_dwordx4 v43, s[14:15]
    s_waitcnt vmcnt(28)
    s_barrier
    v_add_u32 v44, 16384, v52
    v_xor_b32 v45, 32, v44
    ds_read_b64_tr_b16 v[56:57], v44 offset:0
    ds_read_b64_tr_b16 v[58:59], v44 offset:512
    ds_read_b64_tr_b16 v[60:61], v44 offset:2048
    ds_read_b64_tr_b16 v[62:63], v44 offset:2560
    ds_read_b64_tr_b16 v[64:65], v45 offset:0
    ds_read_b64_tr_b16 v[66:67], v45 offset:512
    ds_read_b64_tr_b16 v[68:69], v45 offset:2048
    ds_read_b64_tr_b16 v[70:71], v45 offset:2560
    s_waitcnt lgkmcnt(0)
    ds_write_b128 v55, v[56:59] offset:0
    ds_write_b128 v55, v[60:63] offset:1024
    ds_write_b128 v55, v[64:67] offset:2048
    ds_write_b128 v55, v[68:71] offset:3072
    s_waitcnt lgkmcnt(0)
    s_barrier
    s_add_u32 s14, s66, 12288
    s_addc_u32 s15, s67, 0
    v_xor_b32 v48, 0, v13
    s_mov_b32 m0, 28672
    s_nop 0
    global_load_lds_dwordx4 v48, s[14:15]
    s_add_u32 s14, s66, 13312
    s_addc_u32 s15, s67, 0
    v_xor_b32 v48, 32, v13
    s_mov_b32 m0, 29696
    s_nop 0
    global_load_lds_dwordx4 v48, s[14:15]
    s_add_u32 s14, s66, 14336
    s_addc_u32 s15, s67, 0
    v_xor_b32 v48, 0, v13
    s_mov_b32 m0, 30720
    s_nop 0
    global_load_lds_dwordx4 v48, s[14:15]
    s_add_u32 s14, s66, 15360
    s_addc_u32 s15, s67, 0
    v_xor_b32 v48, 32, v13
    s_mov_b32 m0, 31744
    s_nop 0
    global_load_lds_dwordx4 v48, s[14:15]
    s_waitcnt vmcnt(28)
    s_barrier
    v_add_u32 v44, 32768, v52
    v_xor_b32 v45, 32, v44
    ds_read_b64_tr_b16 v[56:57], v44 offset:0
    ds_read_b64_tr_b16 v[58:59], v44 offset:512
    ds_read_b64_tr_b16 v[60:61], v44 offset:2048
    ds_read_b64_tr_b16 v[62:63], v44 offset:2560
    ds_read_b64_tr_b16 v[64:65], v45 offset:0
    ds_read_b64_tr_b16 v[66:67], v45 offset:512
    ds_read_b64_tr_b16 v[68:69], v45 offset:2048
    ds_read_b64_tr_b16 v[70:71], v45 offset:2560
    s_waitcnt lgkmcnt(0)
    ds_write_b128 v55, v[56:59] offset:4096
    ds_write_b128 v55, v[60:63] offset:5120
    ds_write_b128 v55, v[64:67] offset:6144
    ds_write_b128 v55, v[68:71] offset:7168
    s_waitcnt lgkmcnt(0)
    s_barrier
    s_add_u32 s14, s66, 28672
    s_addc_u32 s15, s67, 0
    v_xor_b32 v48, 64, v13
    s_mov_b32 m0, 45056
    s_nop 0
    global_load_lds_dwordx4 v48, s[14:15]
    s_add_u32 s14, s66, 29696
    s_addc_u32 s15, s67, 0
    v_xor_b32 v48, 96, v13
    s_mov_b32 m0, 46080
    s_nop 0
    global_load_lds_dwordx4 v48, s[14:15]
    s_add_u32 s14, s66, 30720
    s_addc_u32 s15, s67, 0
    v_xor_b32 v48, 64, v13
    s_mov_b32 m0, 47104
    s_nop 0
    global_load_lds_dwordx4 v48, s[14:15]
    s_add_u32 s14, s66, 31744
    s_addc_u32 s15, s67, 0
    v_xor_b32 v48, 96, v13
    s_mov_b32 m0, 48128
    s_nop 0
    global_load_lds_dwordx4 v48, s[14:15]
    s_waitcnt vmcnt(28)
    s_barrier
    v_add_u32 v44, 49152, v52
    v_xor_b32 v45, 32, v44
    ds_read_b64_tr_b16 v[160:161], v44 offset:0
    ds_read_b64_tr_b16 v[162:163], v44 offset:512
    ds_read_b64_tr_b16 v[164:165], v44 offset:2048
    ds_read_b64_tr_b16 v[166:167], v44 offset:2560
    ds_read_b64_tr_b16 v[224:225], v45 offset:0
    ds_read_b64_tr_b16 v[226:227], v45 offset:512
    ds_read_b64_tr_b16 v[228:229], v45 offset:2048
    ds_read_b64_tr_b16 v[230:231], v45 offset:2560
    s_waitcnt lgkmcnt(0)
    s_barrier
    s_add_u32 s14, s66, 45056
    s_addc_u32 s15, s67, 0
    v_xor_b32 v48, 128, v13
    s_mov_b32 m0, 61440
    s_nop 0
    global_load_lds_dwordx4 v48, s[14:15]
    s_add_u32 s14, s66, 46080
    s_addc_u32 s15, s67, 0
    v_xor_b32 v48, 160, v13
    s_mov_b32 m0, 62464
    s_nop 0
    global_load_lds_dwordx4 v48, s[14:15]
    s_add_u32 s14, s66, 47104
    s_addc_u32 s15, s67, 0
    v_xor_b32 v48, 128, v13
    s_mov_b32 m0, 63488
    s_nop 0
    global_load_lds_dwordx4 v48, s[14:15]
    s_add_u32 s14, s66, 48128
    s_addc_u32 s15, s67, 0
    v_xor_b32 v48, 160, v13
    s_mov_b32 m0, 64512
    s_nop 0
    global_load_lds_dwordx4 v48, s[14:15]
    s_waitcnt vmcnt(28)
    s_barrier
    v_add_u32 v44, 65536, v52
    v_xor_b32 v45, 32, v44
    ds_read_b64_tr_b16 v[168:169], v44 offset:0
    ds_read_b64_tr_b16 v[170:171], v44 offset:512
    ds_read_b64_tr_b16 v[172:173], v44 offset:2048
    ds_read_b64_tr_b16 v[174:175], v44 offset:2560
    ds_read_b64_tr_b16 v[232:233], v45 offset:0
    ds_read_b64_tr_b16 v[234:235], v45 offset:512
    ds_read_b64_tr_b16 v[236:237], v45 offset:2048
    ds_read_b64_tr_b16 v[238:239], v45 offset:2560
    s_waitcnt lgkmcnt(0)
    s_barrier
    s_add_u32 s14, s66, 61440
    s_addc_u32 s15, s67, 0
    v_xor_b32 v48, 192, v13
    s_mov_b32 m0, 77824
    s_nop 0
    global_load_lds_dwordx4 v48, s[14:15]
    s_add_u32 s14, s66, 62464
    s_addc_u32 s15, s67, 0
    v_xor_b32 v48, 224, v13
    s_mov_b32 m0, 78848
    s_nop 0
    global_load_lds_dwordx4 v48, s[14:15]
    s_add_u32 s14, s66, 63488
    s_addc_u32 s15, s67, 0
    v_xor_b32 v48, 192, v13
    s_mov_b32 m0, 79872
    s_nop 0
    global_load_lds_dwordx4 v48, s[14:15]
    s_add_u32 s14, s66, 64512
    s_addc_u32 s15, s67, 0
    v_xor_b32 v48, 224, v13
    s_mov_b32 m0, 80896
    s_nop 0
    global_load_lds_dwordx4 v48, s[14:15]
    s_waitcnt vmcnt(28)
    s_barrier
    v_add_u32 v44, 81920, v52
    v_xor_b32 v45, 32, v44
    ds_read_b64_tr_b16 v[176:177], v44 offset:0
    ds_read_b64_tr_b16 v[178:179], v44 offset:512
    ds_read_b64_tr_b16 v[180:181], v44 offset:2048
    ds_read_b64_tr_b16 v[182:183], v44 offset:2560
    ds_read_b64_tr_b16 v[240:241], v45 offset:0
    ds_read_b64_tr_b16 v[242:243], v45 offset:512
    ds_read_b64_tr_b16 v[244:245], v45 offset:2048
    ds_read_b64_tr_b16 v[246:247], v45 offset:2560
    s_waitcnt lgkmcnt(0)
    s_barrier
    s_add_u32 s14, s66, 77824
    s_addc_u32 s15, s67, 0
    v_xor_b32 v48, 0, v13
    s_mov_b32 m0, 94208
    s_nop 0
    global_load_lds_dwordx4 v48, s[14:15]
    s_add_u32 s14, s66, 78848
    s_addc_u32 s15, s67, 0
    v_xor_b32 v48, 32, v13
    s_mov_b32 m0, 95232
    s_nop 0
    global_load_lds_dwordx4 v48, s[14:15]
    s_add_u32 s14, s66, 79872
    s_addc_u32 s15, s67, 0
    v_xor_b32 v48, 0, v13
    s_mov_b32 m0, 96256
    s_nop 0
    global_load_lds_dwordx4 v48, s[14:15]
    s_add_u32 s14, s66, 80896
    s_addc_u32 s15, s67, 0
    v_xor_b32 v48, 32, v13
    s_mov_b32 m0, 97280
    s_nop 0
    global_load_lds_dwordx4 v48, s[14:15]
    s_waitcnt vmcnt(28)
    s_barrier
    v_add_u32 v44, 98304, v52
    v_xor_b32 v45, 32, v44
    ds_read_b64_tr_b16 v[184:185], v44 offset:0
    ds_read_b64_tr_b16 v[186:187], v44 offset:512
    ds_read_b64_tr_b16 v[188:189], v44 offset:2048
    ds_read_b64_tr_b16 v[190:191], v44 offset:2560
    ds_read_b64_tr_b16 v[248:249], v45 offset:0
    ds_read_b64_tr_b16 v[250:251], v45 offset:512
    ds_read_b64_tr_b16 v[252:253], v45 offset:2048
    ds_read_b64_tr_b16 v[254:255], v45 offset:2560
    s_waitcnt lgkmcnt(0)
    s_barrier
    s_add_u32 s14, s66, 94208
    s_addc_u32 s15, s67, 0
    v_xor_b32 v48, 64, v13
    s_mov_b32 m0, 110592
    s_nop 0
    global_load_lds_dwordx4 v48, s[14:15]
    s_add_u32 s14, s66, 95232
    s_addc_u32 s15, s67, 0
    v_xor_b32 v48, 96, v13
    s_mov_b32 m0, 111616
    s_nop 0
    global_load_lds_dwordx4 v48, s[14:15]
    s_add_u32 s14, s66, 96256
    s_addc_u32 s15, s67, 0
    v_xor_b32 v48, 64, v13
    s_mov_b32 m0, 112640
    s_nop 0
    global_load_lds_dwordx4 v48, s[14:15]
    s_add_u32 s14, s66, 97280
    s_addc_u32 s15, s67, 0
    v_xor_b32 v48, 96, v13
    s_mov_b32 m0, 113664
    s_nop 0
    global_load_lds_dwordx4 v48, s[14:15]
    s_waitcnt vmcnt(28)
    s_barrier
    v_add_u32 v44, 114688, v52
    v_xor_b32 v45, 32, v44
    ds_read_b64_tr_b16 v[128:129], v44 offset:0
    ds_read_b64_tr_b16 v[130:131], v44 offset:512
    ds_read_b64_tr_b16 v[132:133], v44 offset:2048
    ds_read_b64_tr_b16 v[134:135], v44 offset:2560
    ds_read_b64_tr_b16 v[192:193], v45 offset:0
    ds_read_b64_tr_b16 v[194:195], v45 offset:512
    ds_read_b64_tr_b16 v[196:197], v45 offset:2048
    ds_read_b64_tr_b16 v[198:199], v45 offset:2560
    s_waitcnt lgkmcnt(0)
    s_barrier
    s_add_u32 s14, s66, 110592
    s_addc_u32 s15, s67, 0
    v_xor_b32 v48, 128, v13
    s_mov_b32 m0, 126976
    s_nop 0
    global_load_lds_dwordx4 v48, s[14:15]
    s_add_u32 s14, s66, 111616
    s_addc_u32 s15, s67, 0
    v_xor_b32 v48, 160, v13
    s_mov_b32 m0, 128000
    s_nop 0
    global_load_lds_dwordx4 v48, s[14:15]
    s_add_u32 s14, s66, 112640
    s_addc_u32 s15, s67, 0
    v_xor_b32 v48, 128, v13
    s_mov_b32 m0, 129024
    s_nop 0
    global_load_lds_dwordx4 v48, s[14:15]
    s_add_u32 s14, s66, 113664
    s_addc_u32 s15, s67, 0
    v_xor_b32 v48, 160, v13
    s_mov_b32 m0, 130048
    s_nop 0
    global_load_lds_dwordx4 v48, s[14:15]
    s_waitcnt vmcnt(28)
    s_barrier
    v_add_u32 v44, 131072, v52
    v_xor_b32 v45, 32, v44
    ds_read_b64_tr_b16 v[136:137], v44 offset:0
    ds_read_b64_tr_b16 v[138:139], v44 offset:512
    ds_read_b64_tr_b16 v[140:141], v44 offset:2048
    ds_read_b64_tr_b16 v[142:143], v44 offset:2560
    ds_read_b64_tr_b16 v[200:201], v45 offset:0
    ds_read_b64_tr_b16 v[202:203], v45 offset:512
    ds_read_b64_tr_b16 v[204:205], v45 offset:2048
    ds_read_b64_tr_b16 v[206:207], v45 offset:2560
    s_waitcnt lgkmcnt(0)
    s_barrier
    s_add_u32 s14, s66, 126976
    s_addc_u32 s15, s67, 0
    v_xor_b32 v48, 192, v13
    s_mov_b32 m0, 143360
    s_nop 0
    global_load_lds_dwordx4 v48, s[14:15]
    s_add_u32 s14, s66, 128000
    s_addc_u32 s15, s67, 0
    v_xor_b32 v48, 224, v13
    s_mov_b32 m0, 144384
    s_nop 0
    global_load_lds_dwordx4 v48, s[14:15]
    s_add_u32 s14, s66, 129024
    s_addc_u32 s15, s67, 0
    v_xor_b32 v48, 192, v13
    s_mov_b32 m0, 145408
    s_nop 0
    global_load_lds_dwordx4 v48, s[14:15]
    s_add_u32 s14, s66, 130048
    s_addc_u32 s15, s67, 0
    v_xor_b32 v48, 224, v13
    s_mov_b32 m0, 146432
    s_nop 0
    global_load_lds_dwordx4 v48, s[14:15]
    s_waitcnt vmcnt(0)
    s_barrier
    v_xor_b32 v54, 96, v53
    ds_read_b64_tr_b16 v[112:113], v54 offset:0
    ds_read_b64_tr_b16 v[114:115], v54 offset:2048
    ds_read_b64_tr_b16 v[116:117], v54 offset:8192
    ds_read_b64_tr_b16 v[118:119], v54 offset:10240
    v_xor_b32 v54, 128, v53
    ds_read_b64_tr_b16 v[144:145], v54 offset:0
    ds_read_b64_tr_b16 v[146:147], v54 offset:2048
    ds_read_b64_tr_b16 v[148:149], v54 offset:8192
    ds_read_b64_tr_b16 v[150:151], v54 offset:10240
    v_xor_b32 v54, 160, v53
    ds_read_b64_tr_b16 v[208:209], v54 offset:0
    ds_read_b64_tr_b16 v[210:211], v54 offset:2048
    ds_read_b64_tr_b16 v[212:213], v54 offset:8192
    ds_read_b64_tr_b16 v[214:215], v54 offset:10240
    v_xor_b32 v54, 0, v53
    ds_read_b64_tr_b16 v[56:57], v54 offset:0
    ds_read_b64_tr_b16 v[58:59], v54 offset:2048
    ds_read_b64_tr_b16 v[60:61], v54 offset:8192
    ds_read_b64_tr_b16 v[62:63], v54 offset:10240
    v_xor_b32 v54, 32, v53
    ds_read_b64_tr_b16 v[64:65], v54 offset:0
    ds_read_b64_tr_b16 v[66:67], v54 offset:2048
    ds_read_b64_tr_b16 v[68:69], v54 offset:8192
    ds_read_b64_tr_b16 v[70:71], v54 offset:10240
    v_xor_b32 v54, 64, v53
    ds_read_b64_tr_b16 v[72:73], v54 offset:0
    ds_read_b64_tr_b16 v[74:75], v54 offset:2048
    ds_read_b64_tr_b16 v[76:77], v54 offset:8192
    ds_read_b64_tr_b16 v[78:79], v54 offset:10240
    v_xor_b32 v54, 192, v53
    ds_read_b64_tr_b16 v[80:81], v54 offset:0
    ds_read_b64_tr_b16 v[82:83], v54 offset:2048
    ds_read_b64_tr_b16 v[84:85], v54 offset:8192
    ds_read_b64_tr_b16 v[86:87], v54 offset:10240
    v_xor_b32 v54, 224, v53
    ds_read_b64_tr_b16 v[88:89], v54 offset:0
    ds_read_b64_tr_b16 v[90:91], v54 offset:2048
    ds_read_b64_tr_b16 v[92:93], v54 offset:8192
    ds_read_b64_tr_b16 v[94:95], v54 offset:10240
    s_waitcnt lgkmcnt(0)
    s_barrier
    ds_write_b128 v14, v[56:59] offset:0
    ds_write_b128 v14, v[60:63] offset:1024
    ds_write_b128 v14, v[64:67] offset:2048
    ds_write_b128 v14, v[68:71] offset:3072
    ds_write_b128 v14, v[72:75] offset:4096
    ds_write_b128 v14, v[76:79] offset:5120
    ds_write_b128 v14, v[80:83] offset:6144
    ds_write_b128 v14, v[84:87] offset:7168
    ds_write_b128 v14, v[88:91] offset:8192
    ds_write_b128 v14, v[92:95] offset:9216
    s_waitcnt lgkmcnt(0)
    v_xor_b32 v54, 96, v53
    v_add_u32 v54, 65536, v54
    ds_read_b64_tr_b16 v[120:121], v54 offset:0
    ds_read_b64_tr_b16 v[122:123], v54 offset:2048
    ds_read_b64_tr_b16 v[124:125], v54 offset:8192
    ds_read_b64_tr_b16 v[126:127], v54 offset:10240
    v_xor_b32 v54, 128, v53
    v_add_u32 v54, 65536, v54
    ds_read_b64_tr_b16 v[152:153], v54 offset:0
    ds_read_b64_tr_b16 v[154:155], v54 offset:2048
    ds_read_b64_tr_b16 v[156:157], v54 offset:8192
    ds_read_b64_tr_b16 v[158:159], v54 offset:10240
    v_xor_b32 v54, 160, v53
    v_add_u32 v54, 65536, v54
    ds_read_b64_tr_b16 v[216:217], v54 offset:0
    ds_read_b64_tr_b16 v[218:219], v54 offset:2048
    ds_read_b64_tr_b16 v[220:221], v54 offset:8192
    ds_read_b64_tr_b16 v[222:223], v54 offset:10240
    v_xor_b32 v54, 0, v53
    v_add_u32 v54, 65536, v54
    ds_read_b64_tr_b16 v[56:57], v54 offset:0
    ds_read_b64_tr_b16 v[58:59], v54 offset:2048
    ds_read_b64_tr_b16 v[60:61], v54 offset:8192
    ds_read_b64_tr_b16 v[62:63], v54 offset:10240
    v_xor_b32 v54, 32, v53
    v_add_u32 v54, 65536, v54
    ds_read_b64_tr_b16 v[64:65], v54 offset:0
    ds_read_b64_tr_b16 v[66:67], v54 offset:2048
    ds_read_b64_tr_b16 v[68:69], v54 offset:8192
    ds_read_b64_tr_b16 v[70:71], v54 offset:10240
    v_xor_b32 v54, 64, v53
    v_add_u32 v54, 65536, v54
    ds_read_b64_tr_b16 v[72:73], v54 offset:0
    ds_read_b64_tr_b16 v[74:75], v54 offset:2048
    ds_read_b64_tr_b16 v[76:77], v54 offset:8192
    ds_read_b64_tr_b16 v[78:79], v54 offset:10240
    v_xor_b32 v54, 192, v53
    v_add_u32 v54, 65536, v54
    ds_read_b64_tr_b16 v[80:81], v54 offset:0
    ds_read_b64_tr_b16 v[82:83], v54 offset:2048
    ds_read_b64_tr_b16 v[84:85], v54 offset:8192
    ds_read_b64_tr_b16 v[86:87], v54 offset:10240
    v_xor_b32 v54, 224, v53
    v_add_u32 v54, 65536, v54
    ds_read_b64_tr_b16 v[88:89], v54 offset:0
    ds_read_b64_tr_b16 v[90:91], v54 offset:2048
    ds_read_b64_tr_b16 v[92:93], v54 offset:8192
    ds_read_b64_tr_b16 v[94:95], v54 offset:10240
    s_waitcnt lgkmcnt(0)
    s_barrier
    ds_write_b128 v15, v[56:59] offset:0
    ds_write_b128 v15, v[60:63] offset:1024
    ds_write_b128 v15, v[64:67] offset:2048
    ds_write_b128 v15, v[68:71] offset:3072
    ds_write_b128 v15, v[72:75] offset:4096
    ds_write_b128 v15, v[76:79] offset:5120
    ds_write_b128 v15, v[80:83] offset:6144
    ds_write_b128 v15, v[84:87] offset:7168
    ds_write_b128 v15, v[88:91] offset:8192
    ds_write_b128 v15, v[92:95] offset:9216
    s_waitcnt lgkmcnt(0)
    ds_read_b128 v[56:59], v55 offset:0
    ds_read_b128 v[60:63], v55 offset:1024
    ds_read_b128 v[64:67], v55 offset:2048
    ds_read_b128 v[68:71], v55 offset:3072
    ds_read_b128 v[72:75], v55 offset:4096
    ds_read_b128 v[76:79], v55 offset:5120
    ds_read_b128 v[80:83], v55 offset:6144
    ds_read_b128 v[84:87], v55 offset:7168
    v_add_u32 v54, 122880, v13
    s_waitcnt lgkmcnt(0)
    ds_write_b128 v54, v[56:59] offset:0
    ds_write_b128 v54, v[60:63] offset:1024
    ds_write_b128 v54, v[64:67] offset:2048
    ds_write_b128 v54, v[68:71] offset:3072
    ds_write_b128 v54, v[72:75] offset:4096
    ds_write_b128 v54, v[76:79] offset:5120
    ds_write_b128 v54, v[80:83] offset:6144
    ds_write_b128 v54, v[84:87] offset:7168
    s_waitcnt lgkmcnt(0)
L_wdone_2:
    s_barrier
    v_mov_b64 v[32:33], 0
    v_mov_b64 v[34:35], 0
    ds_write_b128 v13, v[32:35] offset:14336
    v_and_b32 v30, 7, v0
    v_lshlrev_b32 v30, 2, v30
    v_add_u32 v30, 32, v30
L_clr_7:
    global_load_dword v31, v30, s[6:7] sc1
    s_waitcnt vmcnt(0)
    v_cmp_gt_u32 vcc, 32, v31
    s_sub_u32 s12, s12, 1
    s_cbranch_scc1 L_fail
    s_cbranch_vccnz L_clr_7
    s_lshl_b32 s54, s10, 5
    s_add_u32 s54, s54, s9
    s_lshl_b32 s55, s54, 4
    s_add_u32 s55, s55, 117440512
    s_add_u32 s60, s4, s55
    s_addc_u32 s61, s5, 0
    s_lshl_b32 s55, s54, 6
    s_add_u32 s55, s55, 117444608
    s_add_u32 s62, s4, s55
    s_addc_u32 s63, s5, 0
    s_cmp_eq_u32 s8, 3
    s_cselect_b32 s64, 1, 0
    s_mov_b32 s65, 0
    s_mov_b32 s66, 1
L_p1first_8:
    s_mov_b64 exec, 1
    global_load_dword v31, v13, s[60:61] sc1
    s_waitcnt vmcnt(0)
    v_cmp_gt_u32 vcc, 1, v31
    s_mov_b64 exec, -1
    s_sub_u32 s12, s12, 1
    s_cbranch_scc1 L_fail
    s_cbranch_vccnz L_p1first_8
    s_mov_b64 exec, 1
    global_load_dword v19, v13, s[60:61] offset:4 sc1
    s_mov_b64 exec, -1
    s_mov_b32 s53, 147456
    s_lshl_b32 s54, s8, 12
    s_add_u32 m0, s54, s53
    s_nop 0
    global_load_lds_dwordx4 v13, s[42:43] offset:0 sc1
    global_load_lds_dwordx4 v13, s[42:43] offset:1024 sc1
    global_load_lds_dwordx4 v13, s[42:43] offset:2048 sc1
    global_load_lds_dwordx4 v13, s[42:43] offset:3072 sc1
    s_add_u32 s42, s42, 524288
    s_addc_u32 s43, s43, 0
    s_mov_b32 s53, 131072
    v_bfe_u32 v30, v0, 2, 2
    v_and_b32 v31, 1, v0
    v_lshl_add_u32 v30, v30, 1, v31
    v_lshlrev_b32 v30, 10, v30
    v_bfe_u32 v31, v0, 1, 1
    v_lshl_add_u32 v30, v31, 6, v30
    v_lshrrev_b32 v31, 4, v0
    v_lshl_add_u32 v30, v31, 3, v30
    s_lshl_b32 s54, s8, 8
    v_add_u32 v30, s54, v30
    global_load_dwordx2 v[32:33], v30, s[68:69]
    global_load_dwordx2 v[34:35], v30, s[68:69] offset:32
    global_load_dwordx2 v[36:37], v30, s[68:69] offset:128
    global_load_dwordx2 v[38:39], v30, s[68:69] offset:160
    s_lshl_b32 s54, s8, 13
    s_add_u32 s54, s54, 98304
    v_add_u32 v0, s54, v13
    v_mov_b64 v[64:65], 0
    v_mov_b64 v[66:67], 0
    v_mov_b64 v[68:69], 0
    v_mov_b64 v[70:71], 0
    v_mov_b64 v[72:73], 0
    v_mov_b64 v[74:75], 0
    v_mov_b64 v[76:77], 0
    v_mov_b64 v[78:79], 0
    v_mov_b64 v[80:81], 0
    v_mov_b64 v[82:83], 0
    v_mov_b64 v[84:85], 0
    v_mov_b64 v[86:87], 0
    s_waitcnt vmcnt(0)
.p2align 6
L_step:
    ds_write_b128 v2, v[32:35]
    ds_write_b128 v2, v[36:39] offset:1024
    v_smfmac_f32_16x16x64_bf16 v[64:67], v[32:35], a[0:7], v1
    v_smfmac_f32_16x16x64_bf16 v[68:71], v[32:35], a[64:71], v1
    v_smfmac_f32_16x16x64_bf16 v[64:67], v[36:39], a[8:15], v1
    v_smfmac_f32_16x16x64_bf16 v[68:71], v[36:39], a[72:79], v1
    v_smfmac_f32_16x16x64_bf16 v[72:75], v[32:35], a[128:135], v1
    s_waitcnt lgkmcnt(0)
    s_barrier
    ds_read_b128 v[40:43], v3
    ds_read_b128 v[44:47], v3 offset:1024
    v_smfmac_f32_16x16x64_bf16 v[76:79], v[32:35], a[192:199], v1
    ds_read_b128 v[48:51], v4
    v_smfmac_f32_16x16x64_bf16 v[72:75], v[36:39], a[136:143], v1
    ds_read_b128 v[52:55], v4 offset:1024
    v_smfmac_f32_16x16x64_bf16 v[76:79], v[36:39], a[200:207], v1
    ds_read_b128 v[56:59], v5
    v_smfmac_f32_16x16x64_bf16 v[80:83], v[32:35], v[128:135], v1
    ds_read_b128 v[60:63], v5 offset:1024
    v_smfmac_f32_16x16x64_bf16 v[84:87], v[32:35], v[192:199], v1
    v_smfmac_f32_16x16x64_bf16 v[80:83], v[36:39], v[136:143], v1
    v_smfmac_f32_16x16x64_bf16 v[84:87], v[36:39], v[200:207], v1
    s_waitcnt lgkmcnt(5)
    v_smfmac_f32_16x16x64_bf16 v[64:67], v[40:43], a[16:23], v1
    s_lshl_b32 s54, s8, 12
    s_add_u32 m0, s54, s53
    v_smfmac_f32_16x16x64_bf16 v[68:71], v[40:43], a[80:87], v1
    s_waitcnt lgkmcnt(4)
    v_readfirstlane_b32 s55, v19
    s_mov_b32 s56, s66
    s_cmp_lt_u32 s55, s56
    s_cbranch_scc1 L_p1slow_9
L_p1ok_10:
    v_smfmac_f32_16x16x64_bf16 v[64:67], v[44:47], a[24:31], v1
    global_load_lds_dwordx4 v13, s[42:43] offset:0 sc1
    v_smfmac_f32_16x16x64_bf16 v[68:71], v[44:47], a[88:95], v1
    s_waitcnt lgkmcnt(3)
    v_mov_b32 v26, s11
    v_smfmac_f32_16x16x64_bf16 v[64:67], v[48:51], a[32:39], v1
    global_load_lds_dwordx4 v13, s[42:43] offset:1024 sc1
    v_smfmac_f32_16x16x64_bf16 v[68:71], v[48:51], a[96:103], v1
    s_waitcnt lgkmcnt(2)
    s_mov_b64 exec, s[64:65]
    global_store_dword v13, v26, s[62:63] sc1
    s_mov_b64 exec, -1
    v_smfmac_f32_16x16x64_bf16 v[64:67], v[52:55], a[40:47], v1
    global_load_lds_dwordx4 v13, s[42:43] offset:2048 sc1
    v_smfmac_f32_16x16x64_bf16 v[68:71], v[52:55], a[104:111], v1
    s_waitcnt lgkmcnt(1)
    v_smfmac_f32_16x16x64_bf16 v[64:67], v[56:59], a[48:55], v1
    global_load_lds_dwordx4 v13, s[42:43] offset:3072 sc1
    v_smfmac_f32_16x16x64_bf16 v[68:71], v[56:59], a[112:119], v1
    s_waitcnt lgkmcnt(0)
    s_mov_b64 exec, 1
    global_load_dword v19, v13, s[60:61] offset:8 sc1
    s_mov_b64 exec, -1
    v_smfmac_f32_16x16x64_bf16 v[64:67], v[60:63], a[56:63], v1
    s_add_u32 s42, s42, 524288
    s_addc_u32 s43, s43, 0
    v_smfmac_f32_16x16x64_bf16 v[68:71], v[60:63], a[120:127], v1
    s_xor_b32 s53, s53, 16384
    v_smfmac_f32_16x16x64_bf16 v[72:75], v[40:43], a[144:151], v1
    v_add_f32 v64, v64, v66
    v_add_f32 v65, v65, v67
    v_smfmac_f32_16x16x64_bf16 v[76:79], v[40:43], a[208:215], v1
    v_cvt_pk_bf16_f32 v26, v64, v65
    ds_write_b32 v6, v26
    v_add_f32 v68, v68, v70
    v_smfmac_f32_16x16x64_bf16 v[72:75], v[44:47], a[152:159], v1
    v_add_f32 v69, v69, v71
    v_cvt_pk_bf16_f32 v27, v68, v69
    ds_write_b32 v6, v27 offset:256
    v_smfmac_f32_16x16x64_bf16 v[76:79], v[44:47], a[216:223], v1
    ds_read_b128 v[88:91], v0 offset:0
    v_smfmac_f32_16x16x64_bf16 v[72:75], v[48:51], a[160:167], v1
    ds_read_b128 v[92:95], v0 offset:1024
    v_smfmac_f32_16x16x64_bf16 v[76:79], v[48:51], a[224:231], v1
    ds_read_b128 v[96:99], v0 offset:2048
    v_smfmac_f32_16x16x64_bf16 v[72:75], v[52:55], a[168:175], v1
    ds_read_b128 v[100:103], v0 offset:3072
    v_smfmac_f32_16x16x64_bf16 v[76:79], v[52:55], a[232:239], v1
    s_waitcnt lgkmcnt(4)
    s_barrier
    v_smfmac_f32_16x16x64_bf16 v[72:75], v[56:59], a[176:183], v1
    ds_read_b64_tr_b16 v[64:65], v8 offset:0
    ds_read_b128 v[104:107], v0 offset:4096
    v_smfmac_f32_16x16x64_bf16 v[76:79], v[56:59], a[240:247], v1
    ds_read_b64_tr_b16 v[66:67], v8 offset:128
    ds_read_b128 v[108:111], v0 offset:5120
    v_smfmac_f32_16x16x64_bf16 v[72:75], v[60:63], a[184:191], v1
    ds_read_b64_tr_b16 v[68:69], v8 offset:512
    ds_read_b128 v[32:35], v0 offset:6144
    v_smfmac_f32_16x16x64_bf16 v[76:79], v[60:63], a[248:255], v1
    ds_read_b64_tr_b16 v[70:71], v8 offset:640
    ds_read_b128 v[36:39], v0 offset:7168
    s_waitcnt lgkmcnt(8)
    v_smfmac_f32_16x16x64_bf16 v[80:83], v[40:43], v[88:95], v1
    ds_read_b64_tr_b16 v[88:89], v8 offset:1024
    v_add_f32 v72, v72, v74
    v_smfmac_f32_16x16x64_bf16 v[84:87], v[40:43], v[96:103], v1
    ds_read_b64_tr_b16 v[90:91], v8 offset:1152
    v_add_f32 v73, v73, v75
    s_waitcnt lgkmcnt(6)
    v_smfmac_f32_16x16x64_bf16 v[80:83], v[44:47], v[104:111], v1
    v_cvt_pk_bf16_f32 v24, v72, v73
    ds_write_b32 v7, v24
    s_waitcnt lgkmcnt(3)
    v_smfmac_f32_16x16x64_bf16 v[84:87], v[44:47], v[32:39], v1
    ds_read_b64_tr_b16 v[92:93], v8 offset:1536
    v_add_f32 v76, v76, v78
    v_smfmac_f32_16x16x64_bf16 v[80:83], v[48:51], v[160:167], v1
    ds_read_b64_tr_b16 v[94:95], v8 offset:1664
    v_add_f32 v77, v77, v79
    ds_read_b128 v[40:43], v10 offset:2048
    v_smfmac_f32_16x16x64_bf16 v[84:87], v[48:51], v[224:231], v1
    v_cvt_pk_bf16_f32 v25, v76, v77
    ds_write_b32 v7, v25 offset:512
    ds_read_b128 v[44:47], v10 offset:3072
    v_smfmac_f32_16x16x64_bf16 v[80:83], v[52:55], v[168:175], v1
    ds_read_b128 v[32:35], v10 offset:0
    ds_read_b128 v[36:39], v10 offset:1024
    v_smfmac_f32_16x16x64_bf16 v[84:87], v[52:55], v[232:239], v1
    ds_read_b128 v[48:51], v10 offset:4096
    v_smfmac_f32_16x16x64_bf16 v[80:83], v[56:59], v[176:183], v1
    ds_read_b128 v[52:55], v10 offset:5120
    v_smfmac_f32_16x16x64_bf16 v[84:87], v[56:59], v[240:247], v1
    v_smfmac_f32_16x16x64_bf16 v[80:83], v[60:63], v[184:191], v1
    ds_read_b128 v[56:59], v10 offset:6144
    v_smfmac_f32_16x16x64_bf16 v[84:87], v[60:63], v[248:255], v1
    ds_read_b128 v[60:63], v10 offset:7168
    s_waitcnt lgkmcnt(7)
    s_barrier
    ds_read_b64_tr_b16 v[72:73], v9 offset:0
    ds_read_b64_tr_b16 v[74:75], v9 offset:256
    s_waitcnt lgkmcnt(8)
    v_mfma_f32_16x16x32_bf16 v[104:107], v[40:43], v[88:91], 0
    ds_read_b64_tr_b16 v[76:77], v9 offset:1024
    v_mfma_f32_16x16x32_bf16 v[104:107], v[44:47], v[92:95], v[104:107]
    ds_read_b64_tr_b16 v[78:79], v9 offset:1280
    s_waitcnt lgkmcnt(9)
    v_mfma_f32_16x16x32_bf16 v[104:107], v[32:35], v[64:67], v[104:107]
    ds_read_b64_tr_b16 v[96:97], v9 offset:2048
    s_waitcnt lgkmcnt(9)
    v_mfma_f32_16x16x32_bf16 v[104:107], v[36:39], v[68:71], v[104:107]
    ds_read_b64_tr_b16 v[98:99], v9 offset:2304
    s_waitcnt lgkmcnt(9)
    v_mfma_f32_16x16x32_bf16 v[108:111], v[48:51], v[64:67], 0
    ds_read_b64_tr_b16 v[100:101], v9 offset:3072
    s_waitcnt lgkmcnt(9)
    v_mfma_f32_16x16x32_bf16 v[108:111], v[52:55], v[68:71], v[108:111]
    ds_read_b64_tr_b16 v[102:103], v9 offset:3328
    s_waitcnt lgkmcnt(9)
    v_mfma_f32_16x16x32_bf16 v[108:111], v[56:59], v[88:91], v[108:111]
    s_waitcnt lgkmcnt(8)
    ds_read_b128 v[40:43], v11
    v_mfma_f32_16x16x32_bf16 v[108:111], v[60:63], v[92:95], v[108:111]
    ds_read_b128 v[44:47], v11 offset:1024
    s_waitcnt lgkmcnt(8)
    v_mfma_f32_16x16x32_bf16 v[28:31], v[72:75], v[64:67], 0
    v_add_f32 v80, v80, v82
    v_add_f32 v81, v81, v83
    s_waitcnt lgkmcnt(6)
    v_mfma_f32_16x16x32_bf16 v[28:31], v[76:79], v[68:71], v[28:31]
    v_cvt_pk_bf16_f32 v26, v80, v81
    v_add_f32 v84, v84, v86
    s_waitcnt lgkmcnt(4)
    v_mfma_f32_16x16x32_bf16 v[28:31], v[96:99], v[88:91], v[28:31]
    v_add_f32 v85, v85, v87
    v_cvt_pk_bf16_f32 v27, v84, v85
    s_waitcnt lgkmcnt(2)
    v_mfma_f32_16x16x32_bf16 v[28:31], v[100:103], v[92:95], v[28:31]
    global_store_dwordx4 v13, v[24:27], s[44:45] sc1
    v_mov_b32 v76, v26
    v_mov_b32 v77, 0
    v_mov_b32 v78, v27
    v_mov_b32 v79, 0
    ds_read_b128 v[48:51], v14 offset:0
    ds_read_b128 v[52:55], v14 offset:1024
    v_max3_f32 v26, v104, v105, v106
    v_max3_f32 v27, v107, v108, v109
    v_max3_f32 v26, v26, v110, v111
    v_max3_f32 v26, v26, v28, v29
    v_max_f32 v26, v26, v27
    v_mov_b32 v27, v26
    ds_read_b128 v[56:59], v15 offset:0
    ds_read_b128 v[60:63], v15 offset:1024
    v_permlane16_swap_b32 v26, v27
    v_max_f32 v26, v26, v27
    v_mov_b32 v27, v26
    ds_read_b128 v[32:35], v14 offset:2048
    ds_read_b128 v[36:39], v14 offset:3072
    v_permlane32_swap_b32 v26, v27
    v_max_f32 v26, v26, v27
    v_mul_f32 v26, s48, v26
    v_pk_fma_f32 v[104:105], v[104:105], s[48:49], v[26:27] op_sel_hi:[1,0,0] neg_lo:[0,0,1] neg_hi:[0,0,1]
    v_pk_fma_f32 v[106:107], v[106:107], s[48:49], v[26:27] op_sel_hi:[1,0,0] neg_lo:[0,0,1] neg_hi:[0,0,1]
    v_pk_fma_f32 v[108:109], v[108:109], s[48:49], v[26:27] op_sel_hi:[1,0,0] neg_lo:[0,0,1] neg_hi:[0,0,1]
    v_pk_fma_f32 v[110:111], v[110:111], s[48:49], v[26:27] op_sel_hi:[1,0,0] neg_lo:[0,0,1] neg_hi:[0,0,1]
    v_pk_fma_f32 v[28:29], v[28:29], s[48:49], v[26:27] op_sel_hi:[1,0,0] neg_lo:[0,0,1] neg_hi:[0,0,1]
    v_exp_f32 v104, v104
    v_exp_f32 v105, v105
    v_exp_f32 v106, v106
    v_exp_f32 v107, v107
    v_exp_f32 v108, v108
    v_exp_f32 v109, v109
    v_exp_f32 v110, v110
    v_exp_f32 v111, v111
    v_exp_f32 v28, v28
    v_exp_f32 v29, v29
    v_mov_b32 v93, 0
    v_cvt_pk_bf16_f32 v88, v104, v105
    v_cvt_pk_bf16_f32 v89, v106, v107
    v_cvt_pk_bf16_f32 v90, v108, v109
    v_cvt_pk_bf16_f32 v91, v110, v111
    v_cvt_pk_bf16_f32 v92, v28, v29
    s_waitcnt lgkmcnt(6)
    v_mfma_f32_16x16x32_bf16 v[72:75], v[20:23], v[88:91], 0
    v_mfma_f32_16x16x32_bf16 v[64:67], v[40:43], v[88:91], 0
    ds_read_b128 v[104:107], v14 offset:4096
    v_mfma_f32_16x16x32_bf16 v[68:71], v[44:47], v[88:91], 0
    ds_read_b128 v[108:111], v14 offset:5120
    v_mfma_f32_16x16x16_bf16 v[72:75], v[20:21], v[92:93], v[72:75]
    v_mfma_f32_16x16x16_bf16 v[64:67], v[76:77], v[92:93], v[64:67]
    ds_read_b128 v[40:43], v15 offset:2048
    v_mfma_f32_16x16x16_bf16 v[68:71], v[78:79], v[92:93], v[68:71]
    ds_read_b128 v[44:47], v15 offset:3072
    s_nop 1
    v_rcp_f32 v26, v72
    ds_read_b128 v[88:91], v15 offset:4096
    ds_read_b128 v[92:95], v15 offset:5120
    s_nop 3
    v_cndmask_b32 v64, v68, v64, s[50:51]
    v_cndmask_b32 v65, v69, v65, s[50:51]
    v_cndmask_b32 v66, v70, v66, s[50:51]
    v_cndmask_b32 v67, v71, v67, s[50:51]
    v_pk_mul_f32 v[64:65], v[64:65], v[26:27] op_sel_hi:[1,0]
    v_pk_mul_f32 v[66:67], v[66:67], v[26:27] op_sel_hi:[1,0]
    v_cvt_pk_bf16_f32 v64, v64, v65
    v_cvt_pk_bf16_f32 v65, v66, v67
    ds_write_b64 v12, v[64:65]
    s_waitcnt lgkmcnt(0)
    s_barrier
    ds_read_b128 v[64:67], v13
    ds_read_b128 v[68:71], v13 offset:1024
    v_mov_b64 v[72:73], 0
    v_mov_b64 v[74:75], 0
    v_mov_b64 v[76:77], 0
    v_mov_b64 v[78:79], 0
    v_mov_b64 v[80:81], 0
    v_mov_b64 v[82:83], 0
    v_mov_b64 v[96:97], 0
    v_mov_b64 v[98:99], 0
    v_mov_b64 v[100:101], 0
    v_mov_b64 v[102:103], 0
    s_waitcnt lgkmcnt(1)
    v_smfmac_f32_16x16x64_bf16 v[72:75], v[64:67], v[48:55], v1
    ds_read_b128 v[48:51], v14 offset:6144
    s_waitcnt lgkmcnt(1)
    v_smfmac_f32_16x16x64_bf16 v[72:75], v[68:71], v[56:63], v1
    ds_read_b128 v[52:55], v14 offset:7168
    v_smfmac_f32_16x16x64_bf16 v[76:79], v[64:67], v[32:39], v1
    ds_read_b128 v[56:59], v15 offset:6144
    v_smfmac_f32_16x16x64_bf16 v[76:79], v[68:71], v[40:47], v1
    ds_read_b128 v[60:63], v15 offset:7168
    v_add_f32 v72, v72, v74
    v_smfmac_f32_16x16x64_bf16 v[80:83], v[64:67], v[104:111], v1
    ds_read_b128 v[32:35], v14 offset:8192
    v_add_f32 v73, v73, v75
    v_smfmac_f32_16x16x64_bf16 v[80:83], v[68:71], v[88:95], v1
    ds_read_b128 v[36:39], v14 offset:9216
    ds_read_b128 v[104:107], v13 offset:14336
    v_cvt_pk_bf16_f32 v84, v72, v73
    v_add_f32 v76, v76, v78
    v_smfmac_f32_16x16x64_bf16 v[96:99], v[64:67], v[112:119], v1
    ds_read_b128 v[40:43], v15 offset:8192
    ds_read_b128 v[108:111], v13 offset:14336
    v_add_f32 v77, v77, v79
    v_cvt_pk_bf16_f32 v85, v76, v77
    v_smfmac_f32_16x16x64_bf16 v[96:99], v[68:71], v[120:127], v1
    ds_read_b128 v[44:47], v15 offset:9216
    ds_read_b128 v[88:91], v13 offset:14336
    v_add_f32 v80, v80, v82
    v_add_f32 v81, v81, v83
    v_smfmac_f32_16x16x64_bf16 v[100:103], v[64:67], v[144:151], v1
    v_cvt_pk_bf16_f32 v86, v80, v81
    v_smfmac_f32_16x16x64_bf16 v[100:103], v[68:71], v[152:159], v1
    v_add_f32 v96, v96, v98
    v_add_f32 v97, v97, v99
    s_waitcnt lgkmcnt(4)
    v_smfmac_f32_16x16x64_bf16 v[104:107], v[64:67], v[208:215], v1
    v_cvt_pk_bf16_f32 v87, v96, v97
    v_and_or_b32 v84, v84, -2, s52
    global_store_dwordx4 v16, v[84:87], s[18:19]
    v_smfmac_f32_16x16x64_bf16 v[104:107], v[68:71], v[216:223], v1
    v_add_f32 v100, v100, v102
    v_add_f32 v101, v101, v103
    s_waitcnt lgkmcnt(2)
    v_smfmac_f32_16x16x64_bf16 v[108:111], v[64:67], v[48:55], v1
    v_cvt_pk_bf16_f32 v28, v100, v101
    v_smfmac_f32_16x16x64_bf16 v[108:111], v[68:71], v[56:63], v1
    v_add_f32 v104, v104, v106
    v_add_f32 v105, v105, v107
    s_waitcnt lgkmcnt(0)
    v_smfmac_f32_16x16x64_bf16 v[88:91], v[64:67], v[32:39], v1
    v_cvt_pk_bf16_f32 v29, v104, v105
    v_smfmac_f32_16x16x64_bf16 v[88:91], v[68:71], v[40:47], v1
    v_add_f32 v108, v108, v110
    v_add_f32 v109, v109, v111
    v_cvt_pk_bf16_f32 v30, v108, v109
    s_nop 5
    v_add_f32 v88, v88, v90
    v_add_f32 v89, v89, v91
    v_cvt_pk_bf16_f32 v31, v88, v89
    v_and_or_b32 v28, v28, -2, s52
    global_store_dwordx4 v16, v[28:31], s[20:21]
    v_mov_b64 v[72:73], 0
    v_mov_b64 v[74:75], 0
    v_mov_b64 v[76:77], 0
    v_mov_b64 v[78:79], 0
    v_mov_b64 v[80:81], 0
    v_mov_b64 v[82:83], 0
    v_mov_b64 v[84:85], 0
    v_mov_b64 v[86:87], 0
    s_cmp_ge_u32 s8, 2
    s_cbranch_scc1 L_nored_11
    v_bfe_u32 v26, v13, 4, 3
    v_lshrrev_b32 v27, 1, v26
    v_and_b32 v26, 1, v26
    v_lshlrev_b32 v26, 4, v26
    v_mov_b32 v68, 0x3f80
    v_lshlrev_b32 v26, v26, v68
    v_cmp_eq_u32 vcc, 0, v27
    s_nop 1
    v_cndmask_b32 v64, 0, v26, vcc
    v_cmp_eq_u32 vcc, 1, v27
    s_nop 1
    v_cndmask_b32 v65, 0, v26, vcc
    v_cmp_eq_u32 vcc, 2, v27
    s_nop 1
    v_cndmask_b32 v66, 0, v26, vcc
    v_cmp_eq_u32 vcc, 3, v27
    s_nop 1
    v_cndmask_b32 v67, 0, v26, vcc
    s_nop 15
    s_nop 15
    s_nop 15
    global_load_dwordx4 v[32:35], v17, s[18:19] offset:0 sc1
    global_load_dwordx4 v[36:39], v17, s[18:19] offset:2048 sc1
    global_load_dwordx4 v[40:43], v17, s[30:31] offset:0 sc1
    global_load_dwordx4 v[44:47], v17, s[30:31] offset:2048 sc1
L_poll1_12:
    s_waitcnt vmcnt(3)
    v_mfma_f32_16x16x32_bf16 v[68:71], v[32:35], v[64:67], 0
    v_xor_b32 v26, s52, v32
    s_waitcnt vmcnt(2)
    v_mfma_f32_16x16x32_bf16 v[68:71], v[36:39], v[64:67], v[68:71]
    v_bitop3_b32 v26, v26, v36, s52 bitop3:0xf6
    s_waitcnt vmcnt(1)
    v_mfma_f32_16x16x32_bf16 v[68:71], v[40:43], v[64:67], v[68:71]
    v_bitop3_b32 v26, v26, v40, s52 bitop3:0xf6
    s_waitcnt vmcnt(0)
    v_mfma_f32_16x16x32_bf16 v[68:71], v[44:47], v[64:67], v[68:71]
    v_bitop3_b32 v26, v26, v44, s52 bitop3:0xf6
    v_and_b32 v26, 1, v26
    v_cmp_ne_u32 vcc, 0, v26
    s_cbranch_vccz L_ok1_13
    global_load_dwordx4 v[32:35], v17, s[18:19] offset:0 sc1
    global_load_dwordx4 v[36:39], v17, s[18:19] offset:2048 sc1
    global_load_dwordx4 v[40:43], v17, s[30:31] offset:0 sc1
    global_load_dwordx4 v[44:47], v17, s[30:31] offset:2048 sc1
    s_waitcnt vmcnt(3)
    v_mfma_f32_16x16x32_bf16 v[68:71], v[32:35], v[64:67], 0
    v_xor_b32 v26, s52, v32
    s_waitcnt vmcnt(2)
    v_mfma_f32_16x16x32_bf16 v[68:71], v[36:39], v[64:67], v[68:71]
    v_bitop3_b32 v26, v26, v36, s52 bitop3:0xf6
    s_waitcnt vmcnt(1)
    v_mfma_f32_16x16x32_bf16 v[68:71], v[40:43], v[64:67], v[68:71]
    v_bitop3_b32 v26, v26, v40, s52 bitop3:0xf6
    s_waitcnt vmcnt(0)
    v_mfma_f32_16x16x32_bf16 v[68:71], v[44:47], v[64:67], v[68:71]
    v_bitop3_b32 v26, v26, v44, s52 bitop3:0xf6
    v_and_b32 v26, 1, v26
    v_cmp_ne_u32 vcc, 0, v26
    s_cbranch_vccz L_ok1_13
    global_load_dwordx4 v[32:35], v17, s[18:19] offset:0 sc1
    global_load_dwordx4 v[36:39], v17, s[18:19] offset:2048 sc1
    global_load_dwordx4 v[40:43], v17, s[30:31] offset:0 sc1
    global_load_dwordx4 v[44:47], v17, s[30:31] offset:2048 sc1
    s_sub_u32 s12, s12, 1
    s_cbranch_scc1 L_fail
    s_branch L_poll1_12
L_ok1_13:
    s_nop 5
    v_add_f32 v68, v68, v69
    v_add_f32 v70, v70, v71
    v_cvt_pk_bf16_f32 v26, v68, v70
    v_min_u32 v26, -2, v26
    s_mov_b64 exec, s[50:51]
    global_store_dword v18, v26, s[38:39]
    v_mov_b32 v27, -1
    global_store_dword v18, v27, s[40:41]
    s_mov_b64 exec, -1
L_nored_11:
    s_barrier
    v_mov_b64 v[64:65], 0
    v_mov_b64 v[66:67], 0
    v_mov_b64 v[68:69], 0
    v_mov_b64 v[70:71], 0
    s_nop 15
    global_load_dwordx4 v[32:35], v2, s[38:39] sc1
    global_load_dwordx4 v[36:39], v2, s[38:39] offset:1024 sc1
    s_add_u32 s11, s11, 1
    v_xor_b32 v10, 16384, v10
    v_xor_b32 v11, 16384, v11
    s_add_u32 s44, s44, 262144
    s_addc_u32 s45, s45, 0
L_chkA_14:
    s_waitcnt vmcnt(0)
    v_max3_u32 v26, v32, v34, v36
    v_max_u32 v26, v26, v38
    v_cmp_eq_u32 vcc, -1, v26
    s_cbranch_vccz L_go_15
    global_load_dwordx4 v[32:35], v2, s[38:39] sc1
    global_load_dwordx4 v[36:39], v2, s[38:39] offset:1024 sc1
    s_waitcnt vmcnt(0)
    v_max3_u32 v26, v32, v34, v36
    v_max_u32 v26, v26, v38
    v_cmp_eq_u32 vcc, -1, v26
    s_cbranch_vccz L_go_15
    global_load_dwordx4 v[32:35], v2, s[38:39] sc1
    global_load_dwordx4 v[36:39], v2, s[38:39] offset:1024 sc1
    s_waitcnt vmcnt(0)
    v_max3_u32 v26, v32, v34, v36
    v_max_u32 v26, v26, v38
    v_cmp_eq_u32 vcc, -1, v26
    s_cbranch_vccz L_go_15
    global_load_dwordx4 v[32:35], v2, s[38:39] sc1
    global_load_dwordx4 v[36:39], v2, s[38:39] offset:1024 sc1
    s_sub_u32 s12, s12, 1
    s_cbranch_scc1 L_fail
    s_branch L_chkA_14
L_go_15:
    ds_write_b128 v2, v[32:35]
    ds_write_b128 v2, v[36:39] offset:1024
    v_smfmac_f32_16x16x64_bf16 v[64:67], v[32:35], a[0:7], v1
    v_smfmac_f32_16x16x64_bf16 v[68:71], v[32:35], a[64:71], v1
    v_smfmac_f32_16x16x64_bf16 v[64:67], v[36:39], a[8:15], v1
    v_smfmac_f32_16x16x64_bf16 v[68:71], v[36:39], a[72:79], v1
    v_smfmac_f32_16x16x64_bf16 v[72:75], v[32:35], a[128:135], v1
    s_waitcnt lgkmcnt(0)
    s_barrier
    ds_read_b128 v[40:43], v3
    ds_read_b128 v[44:47], v3 offset:1024
    v_smfmac_f32_16x16x64_bf16 v[76:79], v[32:35], a[192:199], v1
    ds_read_b128 v[48:51], v4
    v_smfmac_f32_16x16x64_bf16 v[72:75], v[36:39], a[136:143], v1
    ds_read_b128 v[52:55], v4 offset:1024
    v_smfmac_f32_16x16x64_bf16 v[76:79], v[36:39], a[200:207], v1
    ds_read_b128 v[56:59], v5
    v_smfmac_f32_16x16x64_bf16 v[80:83], v[32:35], v[128:135], v1
    ds_read_b128 v[60:63], v5 offset:1024
    v_smfmac_f32_16x16x64_bf16 v[84:87], v[32:35], v[192:199], v1
    v_smfmac_f32_16x16x64_bf16 v[80:83], v[36:39], v[136:143], v1
    v_smfmac_f32_16x16x64_bf16 v[84:87], v[36:39], v[200:207], v1
    s_waitcnt lgkmcnt(5)
    v_smfmac_f32_16x16x64_bf16 v[64:67], v[40:43], a[16:23], v1
    s_lshl_b32 s54, s8, 12
    s_add_u32 m0, s54, s53
    v_smfmac_f32_16x16x64_bf16 v[68:71], v[40:43], a[80:87], v1
    s_waitcnt lgkmcnt(4)
    v_readfirstlane_b32 s55, v19
    s_mov_b32 s56, s66
    s_cmp_lt_u32 s55, s56
    s_cbranch_scc1 L_p1slow_16
L_p1ok_17:
    v_smfmac_f32_16x16x64_bf16 v[64:67], v[44:47], a[24:31], v1
    global_load_lds_dwordx4 v13, s[42:43] offset:0 sc1
    v_smfmac_f32_16x16x64_bf16 v[68:71], v[44:47], a[88:95], v1
    s_waitcnt lgkmcnt(3)
    v_mov_b32 v26, s11
    v_smfmac_f32_16x16x64_bf16 v[64:67], v[48:51], a[32:39], v1
    global_load_lds_dwordx4 v13, s[42:43] offset:1024 sc1
    v_smfmac_f32_16x16x64_bf16 v[68:71], v[48:51], a[96:103], v1
    s_waitcnt lgkmcnt(2)
    s_mov_b64 exec, s[64:65]
    global_store_dword v13, v26, s[62:63] sc1
    s_mov_b64 exec, -1
    v_smfmac_f32_16x16x64_bf16 v[64:67], v[52:55], a[40:47], v1
    global_load_lds_dwordx4 v13, s[42:43] offset:2048 sc1
    v_smfmac_f32_16x16x64_bf16 v[68:71], v[52:55], a[104:111], v1
    s_waitcnt lgkmcnt(1)
    v_smfmac_f32_16x16x64_bf16 v[64:67], v[56:59], a[48:55], v1
    global_load_lds_dwordx4 v13, s[42:43] offset:3072 sc1
    v_smfmac_f32_16x16x64_bf16 v[68:71], v[56:59], a[112:119], v1
    s_waitcnt lgkmcnt(0)
    s_mov_b64 exec, 1
    global_load_dword v19, v13, s[60:61] offset:0 sc1
    s_mov_b64 exec, -1
    v_smfmac_f32_16x16x64_bf16 v[64:67], v[60:63], a[56:63], v1
    s_add_u32 s42, s42, 524288
    s_addc_u32 s43, s43, 0
    v_smfmac_f32_16x16x64_bf16 v[68:71], v[60:63], a[120:127], v1
    s_xor_b32 s53, s53, 16384
    v_smfmac_f32_16x16x64_bf16 v[72:75], v[40:43], a[144:151], v1
    v_add_f32 v64, v64, v66
    v_add_f32 v65, v65, v67
    v_smfmac_f32_16x16x64_bf16 v[76:79], v[40:43], a[208:215], v1
    v_cvt_pk_bf16_f32 v26, v64, v65
    ds_write_b32 v6, v26
    v_add_f32 v68, v68, v70
    v_smfmac_f32_16x16x64_bf16 v[72:75], v[44:47], a[152:159], v1
    v_add_f32 v69, v69, v71
    v_cvt_pk_bf16_f32 v27, v68, v69
    ds_write_b32 v6, v27 offset:256
    v_smfmac_f32_16x16x64_bf16 v[76:79], v[44:47], a[216:223], v1
    ds_read_b128 v[88:91], v0 offset:0
    v_smfmac_f32_16x16x64_bf16 v[72:75], v[48:51], a[160:167], v1
    ds_read_b128 v[92:95], v0 offset:1024
    v_smfmac_f32_16x16x64_bf16 v[76:79], v[48:51], a[224:231], v1
    ds_read_b128 v[96:99], v0 offset:2048
    v_smfmac_f32_16x16x64_bf16 v[72:75], v[52:55], a[168:175], v1
    ds_read_b128 v[100:103], v0 offset:3072
    v_smfmac_f32_16x16x64_bf16 v[76:79], v[52:55], a[232:239], v1
    s_waitcnt lgkmcnt(4)
    s_barrier
    v_smfmac_f32_16x16x64_bf16 v[72:75], v[56:59], a[176:183], v1
    ds_read_b64_tr_b16 v[64:65], v8 offset:0
    ds_read_b128 v[104:107], v0 offset:4096
    v_smfmac_f32_16x16x64_bf16 v[76:79], v[56:59], a[240:247], v1
    ds_read_b64_tr_b16 v[66:67], v8 offset:128
    ds_read_b128 v[108:111], v0 offset:5120
    v_smfmac_f32_16x16x64_bf16 v[72:75], v[60:63], a[184:191], v1
    ds_read_b64_tr_b16 v[68:69], v8 offset:512
    ds_read_b128 v[32:35], v0 offset:6144
    v_smfmac_f32_16x16x64_bf16 v[76:79], v[60:63], a[248:255], v1
    ds_read_b64_tr_b16 v[70:71], v8 offset:640
    ds_read_b128 v[36:39], v0 offset:7168
    s_waitcnt lgkmcnt(8)
    v_smfmac_f32_16x16x64_bf16 v[80:83], v[40:43], v[88:95], v1
    ds_read_b64_tr_b16 v[88:89], v8 offset:1024
    v_add_f32 v72, v72, v74
    v_smfmac_f32_16x16x64_bf16 v[84:87], v[40:43], v[96:103], v1
    ds_read_b64_tr_b16 v[90:91], v8 offset:1152
    v_add_f32 v73, v73, v75
    s_waitcnt lgkmcnt(6)
    v_smfmac_f32_16x16x64_bf16 v[80:83], v[44:47], v[104:111], v1
    v_cvt_pk_bf16_f32 v24, v72, v73
    ds_write_b32 v7, v24
    s_waitcnt lgkmcnt(3)
    v_smfmac_f32_16x16x64_bf16 v[84:87], v[44:47], v[32:39], v1
    ds_read_b64_tr_b16 v[92:93], v8 offset:1536
    v_add_f32 v76, v76, v78
    v_smfmac_f32_16x16x64_bf16 v[80:83], v[48:51], v[160:167], v1
    ds_read_b64_tr_b16 v[94:95], v8 offset:1664
    v_add_f32 v77, v77, v79
    ds_read_b128 v[40:43], v10 offset:2048
    v_smfmac_f32_16x16x64_bf16 v[84:87], v[48:51], v[224:231], v1
    v_cvt_pk_bf16_f32 v25, v76, v77
    ds_write_b32 v7, v25 offset:512
    ds_read_b128 v[44:47], v10 offset:3072
    v_smfmac_f32_16x16x64_bf16 v[80:83], v[52:55], v[168:175], v1
    ds_read_b128 v[32:35], v10 offset:0
    ds_read_b128 v[36:39], v10 offset:1024
    v_smfmac_f32_16x16x64_bf16 v[84:87], v[52:55], v[232:239], v1
    ds_read_b128 v[48:51], v10 offset:4096
    v_smfmac_f32_16x16x64_bf16 v[80:83], v[56:59], v[176:183], v1
    ds_read_b128 v[52:55], v10 offset:5120
    v_smfmac_f32_16x16x64_bf16 v[84:87], v[56:59], v[240:247], v1
    v_smfmac_f32_16x16x64_bf16 v[80:83], v[60:63], v[184:191], v1
    ds_read_b128 v[56:59], v10 offset:6144
    v_smfmac_f32_16x16x64_bf16 v[84:87], v[60:63], v[248:255], v1
    ds_read_b128 v[60:63], v10 offset:7168
    s_waitcnt lgkmcnt(7)
    s_barrier
    ds_read_b64_tr_b16 v[72:73], v9 offset:0
    ds_read_b64_tr_b16 v[74:75], v9 offset:256
    s_waitcnt lgkmcnt(8)
    v_mfma_f32_16x16x32_bf16 v[104:107], v[40:43], v[88:91], 0
    ds_read_b64_tr_b16 v[76:77], v9 offset:1024
    v_mfma_f32_16x16x32_bf16 v[104:107], v[44:47], v[92:95], v[104:107]
    ds_read_b64_tr_b16 v[78:79], v9 offset:1280
    s_waitcnt lgkmcnt(9)
    v_mfma_f32_16x16x32_bf16 v[104:107], v[32:35], v[64:67], v[104:107]
    ds_read_b64_tr_b16 v[96:97], v9 offset:2048
    s_waitcnt lgkmcnt(9)
    v_mfma_f32_16x16x32_bf16 v[104:107], v[36:39], v[68:71], v[104:107]
    ds_read_b64_tr_b16 v[98:99], v9 offset:2304
    s_waitcnt lgkmcnt(9)
    v_mfma_f32_16x16x32_bf16 v[108:111], v[48:51], v[64:67], 0
    ds_read_b64_tr_b16 v[100:101], v9 offset:3072
    s_waitcnt lgkmcnt(9)
    v_mfma_f32_16x16x32_bf16 v[108:111], v[52:55], v[68:71], v[108:111]
    ds_read_b64_tr_b16 v[102:103], v9 offset:3328
    s_waitcnt lgkmcnt(9)
    v_mfma_f32_16x16x32_bf16 v[108:111], v[56:59], v[88:91], v[108:111]
    s_waitcnt lgkmcnt(8)
    ds_read_b128 v[40:43], v11
    v_mfma_f32_16x16x32_bf16 v[108:111], v[60:63], v[92:95], v[108:111]
    ds_read_b128 v[44:47], v11 offset:1024
    s_waitcnt lgkmcnt(8)
    v_mfma_f32_16x16x32_bf16 v[28:31], v[72:75], v[64:67], 0
    v_add_f32 v80, v80, v82
    v_add_f32 v81, v81, v83
    s_waitcnt lgkmcnt(6)
    v_mfma_f32_16x16x32_bf16 v[28:31], v[76:79], v[68:71], v[28:31]
    v_cvt_pk_bf16_f32 v26, v80, v81
    v_add_f32 v84, v84, v86
    s_waitcnt lgkmcnt(4)
    v_mfma_f32_16x16x32_bf16 v[28:31], v[96:99], v[88:91], v[28:31]
    v_add_f32 v85, v85, v87
    v_cvt_pk_bf16_f32 v27, v84, v85
    s_waitcnt lgkmcnt(2)
    v_mfma_f32_16x16x32_bf16 v[28:31], v[100:103], v[92:95], v[28:31]
    global_store_dwordx4 v13, v[24:27], s[44:45] sc1
    v_mov_b32 v76, v26
    v_mov_b32 v77, 0
    v_mov_b32 v78, v27
    v_mov_b32 v79, 0
    ds_read_b128 v[48:51], v14 offset:0
    ds_read_b128 v[52:55], v14 offset:1024
    v_max3_f32 v26, v104, v105, v106
    v_max3_f32 v27, v107, v108, v109
    v_max3_f32 v26, v26, v110, v111
    v_max3_f32 v26, v26, v28, v29
    v_max_f32 v26, v26, v27
    v_mov_b32 v27, v26
    ds_read_b128 v[56:59], v15 offset:0
    ds_read_b128 v[60:63], v15 offset:1024
    v_permlane16_swap_b32 v26, v27
    v_max_f32 v26, v26, v27
    v_mov_b32 v27, v26
    ds_read_b128 v[32:35], v14 offset:2048
    ds_read_b128 v[36:39], v14 offset:3072
    v_permlane32_swap_b32 v26, v27
    v_max_f32 v26, v26, v27
    v_mul_f32 v26, s48, v26
    v_pk_fma_f32 v[104:105], v[104:105], s[48:49], v[26:27] op_sel_hi:[1,0,0] neg_lo:[0,0,1] neg_hi:[0,0,1]
    v_pk_fma_f32 v[106:107], v[106:107], s[48:49], v[26:27] op_sel_hi:[1,0,0] neg_lo:[0,0,1] neg_hi:[0,0,1]
    v_pk_fma_f32 v[108:109], v[108:109], s[48:49], v[26:27] op_sel_hi:[1,0,0] neg_lo:[0,0,1] neg_hi:[0,0,1]
    v_pk_fma_f32 v[110:111], v[110:111], s[48:49], v[26:27] op_sel_hi:[1,0,0] neg_lo:[0,0,1] neg_hi:[0,0,1]
    v_pk_fma_f32 v[28:29], v[28:29], s[48:49], v[26:27] op_sel_hi:[1,0,0] neg_lo:[0,0,1] neg_hi:[0,0,1]
    v_exp_f32 v104, v104
    v_exp_f32 v105, v105
    v_exp_f32 v106, v106
    v_exp_f32 v107, v107
    v_exp_f32 v108, v108
    v_exp_f32 v109, v109
    v_exp_f32 v110, v110
    v_exp_f32 v111, v111
    v_exp_f32 v28, v28
    v_exp_f32 v29, v29
    v_mov_b32 v93, 0
    v_cvt_pk_bf16_f32 v88, v104, v105
    v_cvt_pk_bf16_f32 v89, v106, v107
    v_cvt_pk_bf16_f32 v90, v108, v109
    v_cvt_pk_bf16_f32 v91, v110, v111
    v_cvt_pk_bf16_f32 v92, v28, v29
    s_waitcnt lgkmcnt(6)
    v_mfma_f32_16x16x32_bf16 v[72:75], v[20:23], v[88:91], 0
    v_mfma_f32_16x16x32_bf16 v[64:67], v[40:43], v[88:91], 0
    ds_read_b128 v[104:107], v14 offset:4096
    v_mfma_f32_16x16x32_bf16 v[68:71], v[44:47], v[88:91], 0
    ds_read_b128 v[108:111], v14 offset:5120
    v_mfma_f32_16x16x16_bf16 v[72:75], v[20:21], v[92:93], v[72:75]
    v_mfma_f32_16x16x16_bf16 v[64:67], v[76:77], v[92:93], v[64:67]
    ds_read_b128 v[40:43], v15 offset:2048
    v_mfma_f32_16x16x16_bf16 v[68:71], v[78:79], v[92:93], v[68:71]
    ds_read_b128 v[44:47], v15 offset:3072
    s_nop 1
    v_rcp_f32 v26, v72
    ds_read_b128 v[88:91], v15 offset:4096
    ds_read_b128 v[92:95], v15 offset:5120
    s_nop 3
    v_cndmask_b32 v64, v68, v64, s[50:51]
    v_cndmask_b32 v65, v69, v65, s[50:51]
    v_cndmask_b32 v66, v70, v66, s[50:51]
    v_cndmask_b32 v67, v71, v67, s[50:51]
    v_pk_mul_f32 v[64:65], v[64:65], v[26:27] op_sel_hi:[1,0]
    v_pk_mul_f32 v[66:67], v[66:67], v[26:27] op_sel_hi:[1,0]
    v_cvt_pk_bf16_f32 v64, v64, v65
    v_cvt_pk_bf16_f32 v65, v66, v67
    ds_write_b64 v12, v[64:65]
    s_waitcnt lgkmcnt(0)
    s_barrier
    ds_read_b128 v[64:67], v13
    ds_read_b128 v[68:71], v13 offset:1024
    v_mov_b64 v[72:73], 0
    v_mov_b64 v[74:75], 0
    v_mov_b64 v[76:77], 0
    v_mov_b64 v[78:79], 0
    v_mov_b64 v[80:81], 0
    v_mov_b64 v[82:83], 0
    v_mov_b64 v[96:97], 0
    v_mov_b64 v[98:99], 0
    v_mov_b64 v[100:101], 0
    v_mov_b64 v[102:103], 0
    s_waitcnt lgkmcnt(1)
    v_smfmac_f32_16x16x64_bf16 v[72:75], v[64:67], v[48:55], v1
    ds_read_b128 v[48:51], v14 offset:6144
    s_waitcnt lgkmcnt(1)
    v_smfmac_f32_16x16x64_bf16 v[72:75], v[68:71], v[56:63], v1
    ds_read_b128 v[52:55], v14 offset:7168
    v_smfmac_f32_16x16x64_bf16 v[76:79], v[64:67], v[32:39], v1
    ds_read_b128 v[56:59], v15 offset:6144
    v_smfmac_f32_16x16x64_bf16 v[76:79], v[68:71], v[40:47], v1
    ds_read_b128 v[60:63], v15 offset:7168
    v_add_f32 v72, v72, v74
    v_smfmac_f32_16x16x64_bf16 v[80:83], v[64:67], v[104:111], v1
    ds_read_b128 v[32:35], v14 offset:8192
    v_add_f32 v73, v73, v75
    v_smfmac_f32_16x16x64_bf16 v[80:83], v[68:71], v[88:95], v1
    ds_read_b128 v[36:39], v14 offset:9216
    ds_read_b128 v[104:107], v13 offset:14336
    v_cvt_pk_bf16_f32 v84, v72, v73
    v_add_f32 v76, v76, v78
    v_smfmac_f32_16x16x64_bf16 v[96:99], v[64:67], v[112:119], v1
    ds_read_b128 v[40:43], v15 offset:8192
    ds_read_b128 v[108:111], v13 offset:14336
    v_add_f32 v77, v77, v79
    v_cvt_pk_bf16_f32 v85, v76, v77
    v_smfmac_f32_16x16x64_bf16 v[96:99], v[68:71], v[120:127], v1
    ds_read_b128 v[44:47], v15 offset:9216
    ds_read_b128 v[88:91], v13 offset:14336
    v_add_f32 v80, v80, v82
    v_add_f32 v81, v81, v83
    v_smfmac_f32_16x16x64_bf16 v[100:103], v[64:67], v[144:151], v1
    v_cvt_pk_bf16_f32 v86, v80, v81
    v_smfmac_f32_16x16x64_bf16 v[100:103], v[68:71], v[152:159], v1
    v_add_f32 v96, v96, v98
    v_add_f32 v97, v97, v99
    s_waitcnt lgkmcnt(4)
    v_smfmac_f32_16x16x64_bf16 v[104:107], v[64:67], v[208:215], v1
    v_cvt_pk_bf16_f32 v87, v96, v97
    v_and_or_b32 v84, v84, -2, s52
    global_store_dwordx4 v16, v[84:87], s[22:23]
    v_smfmac_f32_16x16x64_bf16 v[104:107], v[68:71], v[216:223], v1
    v_add_f32 v100, v100, v102
    v_add_f32 v101, v101, v103
    s_waitcnt lgkmcnt(2)
    v_smfmac_f32_16x16x64_bf16 v[108:111], v[64:67], v[48:55], v1
    v_cvt_pk_bf16_f32 v28, v100, v101
    v_smfmac_f32_16x16x64_bf16 v[108:111], v[68:71], v[56:63], v1
    v_add_f32 v104, v104, v106
    v_add_f32 v105, v105, v107
    s_waitcnt lgkmcnt(0)
    v_smfmac_f32_16x16x64_bf16 v[88:91], v[64:67], v[32:39], v1
    v_cvt_pk_bf16_f32 v29, v104, v105
    v_smfmac_f32_16x16x64_bf16 v[88:91], v[68:71], v[40:47], v1
    v_add_f32 v108, v108, v110
    v_add_f32 v109, v109, v111
    v_cvt_pk_bf16_f32 v30, v108, v109
    s_nop 5
    v_add_f32 v88, v88, v90
    v_add_f32 v89, v89, v91
    v_cvt_pk_bf16_f32 v31, v88, v89
    v_and_or_b32 v28, v28, -2, s52
    global_store_dwordx4 v16, v[28:31], s[24:25]
    v_mov_b64 v[72:73], 0
    v_mov_b64 v[74:75], 0
    v_mov_b64 v[76:77], 0
    v_mov_b64 v[78:79], 0
    v_mov_b64 v[80:81], 0
    v_mov_b64 v[82:83], 0
    v_mov_b64 v[84:85], 0
    v_mov_b64 v[86:87], 0
    s_cmp_ge_u32 s8, 2
    s_cbranch_scc1 L_nored_18
    v_bfe_u32 v26, v13, 4, 3
    v_lshrrev_b32 v27, 1, v26
    v_and_b32 v26, 1, v26
    v_lshlrev_b32 v26, 4, v26
    v_mov_b32 v68, 0x3f80
    v_lshlrev_b32 v26, v26, v68
    v_cmp_eq_u32 vcc, 0, v27
    s_nop 1
    v_cndmask_b32 v64, 0, v26, vcc
    v_cmp_eq_u32 vcc, 1, v27
    s_nop 1
    v_cndmask_b32 v65, 0, v26, vcc
    v_cmp_eq_u32 vcc, 2, v27
    s_nop 1
    v_cndmask_b32 v66, 0, v26, vcc
    v_cmp_eq_u32 vcc, 3, v27
    s_nop 1
    v_cndmask_b32 v67, 0, v26, vcc
    s_nop 15
    s_nop 15
    s_nop 15
    global_load_dwordx4 v[32:35], v17, s[22:23] offset:0 sc1
    global_load_dwordx4 v[36:39], v17, s[22:23] offset:2048 sc1
    global_load_dwordx4 v[40:43], v17, s[32:33] offset:0 sc1
    global_load_dwordx4 v[44:47], v17, s[32:33] offset:2048 sc1
L_poll1_19:
    s_waitcnt vmcnt(3)
    v_mfma_f32_16x16x32_bf16 v[68:71], v[32:35], v[64:67], 0
    v_xor_b32 v26, s52, v32
    s_waitcnt vmcnt(2)
    v_mfma_f32_16x16x32_bf16 v[68:71], v[36:39], v[64:67], v[68:71]
    v_bitop3_b32 v26, v26, v36, s52 bitop3:0xf6
    s_waitcnt vmcnt(1)
    v_mfma_f32_16x16x32_bf16 v[68:71], v[40:43], v[64:67], v[68:71]
    v_bitop3_b32 v26, v26, v40, s52 bitop3:0xf6
    s_waitcnt vmcnt(0)
    v_mfma_f32_16x16x32_bf16 v[68:71], v[44:47], v[64:67], v[68:71]
    v_bitop3_b32 v26, v26, v44, s52 bitop3:0xf6
    v_and_b32 v26, 1, v26
    v_cmp_ne_u32 vcc, 0, v26
    s_cbranch_vccz L_ok1_20
    global_load_dwordx4 v[32:35], v17, s[22:23] offset:0 sc1
    global_load_dwordx4 v[36:39], v17, s[22:23] offset:2048 sc1
    global_load_dwordx4 v[40:43], v17, s[32:33] offset:0 sc1
    global_load_dwordx4 v[44:47], v17, s[32:33] offset:2048 sc1
    s_waitcnt vmcnt(3)
    v_mfma_f32_16x16x32_bf16 v[68:71], v[32:35], v[64:67], 0
    v_xor_b32 v26, s52, v32
    s_waitcnt vmcnt(2)
    v_mfma_f32_16x16x32_bf16 v[68:71], v[36:39], v[64:67], v[68:71]
    v_bitop3_b32 v26, v26, v36, s52 bitop3:0xf6
    s_waitcnt vmcnt(1)
    v_mfma_f32_16x16x32_bf16 v[68:71], v[40:43], v[64:67], v[68:71]
    v_bitop3_b32 v26, v26, v40, s52 bitop3:0xf6
    s_waitcnt vmcnt(0)
    v_mfma_f32_16x16x32_bf16 v[68:71], v[44:47], v[64:67], v[68:71]
    v_bitop3_b32 v26, v26, v44, s52 bitop3:0xf6
    v_and_b32 v26, 1, v26
    v_cmp_ne_u32 vcc, 0, v26
    s_cbranch_vccz L_ok1_20
    global_load_dwordx4 v[32:35], v17, s[22:23] offset:0 sc1
    global_load_dwordx4 v[36:39], v17, s[22:23] offset:2048 sc1
    global_load_dwordx4 v[40:43], v17, s[32:33] offset:0 sc1
    global_load_dwordx4 v[44:47], v17, s[32:33] offset:2048 sc1
    s_sub_u32 s12, s12, 1
    s_cbranch_scc1 L_fail
    s_branch L_poll1_19
L_ok1_20:
    s_nop 5
    v_add_f32 v68, v68, v69
    v_add_f32 v70, v70, v71
    v_cvt_pk_bf16_f32 v26, v68, v70
    v_min_u32 v26, -2, v26
    s_mov_b64 exec, s[50:51]
    global_store_dword v18, v26, s[40:41]
    v_mov_b32 v27, -1
    global_store_dword v18, v27, s[36:37]
    s_mov_b64 exec, -1
L_nored_18:
    s_barrier
    v_mov_b64 v[64:65], 0
    v_mov_b64 v[66:67], 0
    v_mov_b64 v[68:69], 0
    v_mov_b64 v[70:71], 0
    s_nop 15
    global_load_dwordx4 v[32:35], v2, s[40:41] sc1
    global_load_dwordx4 v[36:39], v2, s[40:41] offset:1024 sc1
    s_add_u32 s11, s11, 1
    v_xor_b32 v10, 16384, v10
    v_xor_b32 v11, 16384, v11
    s_add_u32 s44, s44, 262144
    s_addc_u32 s45, s45, 0
L_chkA_21:
    s_waitcnt vmcnt(0)
    v_max3_u32 v26, v32, v34, v36
    v_max_u32 v26, v26, v38
    v_cmp_eq_u32 vcc, -1, v26
    s_cbranch_vccz L_go_22
    global_load_dwordx4 v[32:35], v2, s[40:41] sc1
    global_load_dwordx4 v[36:39], v2, s[40:41] offset:1024 sc1
    s_waitcnt vmcnt(0)
    v_max3_u32 v26, v32, v34, v36
    v_max_u32 v26, v26, v38
    v_cmp_eq_u32 vcc, -1, v26
    s_cbranch_vccz L_go_22
    global_load_dwordx4 v[32:35], v2, s[40:41] sc1
    global_load_dwordx4 v[36:39], v2, s[40:41] offset:1024 sc1
    s_waitcnt vmcnt(0)
    v_max3_u32 v26, v32, v34, v36
    v_max_u32 v26, v26, v38
    v_cmp_eq_u32 vcc, -1, v26
    s_cbranch_vccz L_go_22
    global_load_dwordx4 v[32:35], v2, s[40:41] sc1
    global_load_dwordx4 v[36:39], v2, s[40:41] offset:1024 sc1
    s_sub_u32 s12, s12, 1
    s_cbranch_scc1 L_fail
    s_branch L_chkA_21
L_go_22:
    ds_write_b128 v2, v[32:35]
    ds_write_b128 v2, v[36:39] offset:1024
    v_smfmac_f32_16x16x64_bf16 v[64:67], v[32:35], a[0:7], v1
    v_smfmac_f32_16x16x64_bf16 v[68:71], v[32:35], a[64:71], v1
    v_smfmac_f32_16x16x64_bf16 v[64:67], v[36:39], a[8:15], v1
    v_smfmac_f32_16x16x64_bf16 v[68:71], v[36:39], a[72:79], v1
    v_smfmac_f32_16x16x64_bf16 v[72:75], v[32:35], a[128:135], v1
    s_waitcnt lgkmcnt(0)
    s_barrier
    ds_read_b128 v[40:43], v3
    ds_read_b128 v[44:47], v3 offset:1024
    v_smfmac_f32_16x16x64_bf16 v[76:79], v[32:35], a[192:199], v1
    ds_read_b128 v[48:51], v4
    v_smfmac_f32_16x16x64_bf16 v[72:75], v[36:39], a[136:143], v1
    ds_read_b128 v[52:55], v4 offset:1024
    v_smfmac_f32_16x16x64_bf16 v[76:79], v[36:39], a[200:207], v1
    ds_read_b128 v[56:59], v5
    v_smfmac_f32_16x16x64_bf16 v[80:83], v[32:35], v[128:135], v1
    ds_read_b128 v[60:63], v5 offset:1024
    v_smfmac_f32_16x16x64_bf16 v[84:87], v[32:35], v[192:199], v1
    v_smfmac_f32_16x16x64_bf16 v[80:83], v[36:39], v[136:143], v1
    v_smfmac_f32_16x16x64_bf16 v[84:87], v[36:39], v[200:207], v1
    s_waitcnt lgkmcnt(5)
    v_smfmac_f32_16x16x64_bf16 v[64:67], v[40:43], a[16:23], v1
    s_lshl_b32 s54, s8, 12
    s_add_u32 m0, s54, s53
    v_smfmac_f32_16x16x64_bf16 v[68:71], v[40:43], a[80:87], v1
    s_waitcnt lgkmcnt(4)
    v_readfirstlane_b32 s55, v19
    s_add_u32 s56, s66, 1
    s_cmp_lt_u32 s55, s56
    s_cbranch_scc1 L_p1slow_23
L_p1ok_24:
    v_smfmac_f32_16x16x64_bf16 v[64:67], v[44:47], a[24:31], v1
    global_load_lds_dwordx4 v13, s[42:43] offset:0 sc1
    v_smfmac_f32_16x16x64_bf16 v[68:71], v[44:47], a[88:95], v1
    s_waitcnt lgkmcnt(3)
    v_mov_b32 v26, s11
    v_smfmac_f32_16x16x64_bf16 v[64:67], v[48:51], a[32:39], v1
    global_load_lds_dwordx4 v13, s[42:43] offset:1024 sc1
    v_smfmac_f32_16x16x64_bf16 v[68:71], v[48:51], a[96:103], v1
    s_waitcnt lgkmcnt(2)
    s_mov_b64 exec, s[64:65]
    global_store_dword v13, v26, s[62:63] sc1
    s_mov_b64 exec, -1
    v_smfmac_f32_16x16x64_bf16 v[64:67], v[52:55], a[40:47], v1
    global_load_lds_dwordx4 v13, s[42:43] offset:2048 sc1
    v_smfmac_f32_16x16x64_bf16 v[68:71], v[52:55], a[104:111], v1
    s_waitcnt lgkmcnt(1)
    v_smfmac_f32_16x16x64_bf16 v[64:67], v[56:59], a[48:55], v1
    global_load_lds_dwordx4 v13, s[42:43] offset:3072 sc1
    v_smfmac_f32_16x16x64_bf16 v[68:71], v[56:59], a[112:119], v1
    s_waitcnt lgkmcnt(0)
    s_mov_b64 exec, 1
    global_load_dword v19, v13, s[60:61] offset:4 sc1
    s_mov_b64 exec, -1
    v_smfmac_f32_16x16x64_bf16 v[64:67], v[60:63], a[56:63], v1
    s_add_u32 s42, s42, 524288
    s_addc_u32 s43, s43, 0
    v_smfmac_f32_16x16x64_bf16 v[68:71], v[60:63], a[120:127], v1
    s_xor_b32 s53, s53, 16384
    v_smfmac_f32_16x16x64_bf16 v[72:75], v[40:43], a[144:151], v1
    v_add_f32 v64, v64, v66
    v_add_f32 v65, v65, v67
    v_smfmac_f32_16x16x64_bf16 v[76:79], v[40:43], a[208:215], v1
    v_cvt_pk_bf16_f32 v26, v64, v65
    ds_write_b32 v6, v26
    v_add_f32 v68, v68, v70
    v_smfmac_f32_16x16x64_bf16 v[72:75], v[44:47], a[152:159], v1
    v_add_f32 v69, v69, v71
    v_cvt_pk_bf16_f32 v27, v68, v69
    ds_write_b32 v6, v27 offset:256
    v_smfmac_f32_16x16x64_bf16 v[76:79], v[44:47], a[216:223], v1
    ds_read_b128 v[88:91], v0 offset:0
    v_smfmac_f32_16x16x64_bf16 v[72:75], v[48:51], a[160:167], v1
    ds_read_b128 v[92:95], v0 offset:1024
    v_smfmac_f32_16x16x64_bf16 v[76:79], v[48:51], a[224:231], v1
    ds_read_b128 v[96:99], v0 offset:2048
    v_smfmac_f32_16x16x64_bf16 v[72:75], v[52:55], a[168:175], v1
    ds_read_b128 v[100:103], v0 offset:3072
    v_smfmac_f32_16x16x64_bf16 v[76:79], v[52:55], a[232:239], v1
    s_waitcnt lgkmcnt(4)
    s_barrier
    v_smfmac_f32_16x16x64_bf16 v[72:75], v[56:59], a[176:183], v1
    ds_read_b64_tr_b16 v[64:65], v8 offset:0
    ds_read_b128 v[104:107], v0 offset:4096
    v_smfmac_f32_16x16x64_bf16 v[76:79], v[56:59], a[240:247], v1
    ds_read_b64_tr_b16 v[66:67], v8 offset:128
    ds_read_b128 v[108:111], v0 offset:5120
    v_smfmac_f32_16x16x64_bf16 v[72:75], v[60:63], a[184:191], v1
    ds_read_b64_tr_b16 v[68:69], v8 offset:512
    ds_read_b128 v[32:35], v0 offset:6144
    v_smfmac_f32_16x16x64_bf16 v[76:79], v[60:63], a[248:255], v1
    ds_read_b64_tr_b16 v[70:71], v8 offset:640
    ds_read_b128 v[36:39], v0 offset:7168
    s_waitcnt lgkmcnt(8)
    v_smfmac_f32_16x16x64_bf16 v[80:83], v[40:43], v[88:95], v1
    ds_read_b64_tr_b16 v[88:89], v8 offset:1024
    v_add_f32 v72, v72, v74
    v_smfmac_f32_16x16x64_bf16 v[84:87], v[40:43], v[96:103], v1
    ds_read_b64_tr_b16 v[90:91], v8 offset:1152
    v_add_f32 v73, v73, v75
    s_waitcnt lgkmcnt(6)
    v_smfmac_f32_16x16x64_bf16 v[80:83], v[44:47], v[104:111], v1
    v_cvt_pk_bf16_f32 v24, v72, v73
    ds_write_b32 v7, v24
    s_waitcnt lgkmcnt(3)
    v_smfmac_f32_16x16x64_bf16 v[84:87], v[44:47], v[32:39], v1
    ds_read_b64_tr_b16 v[92:93], v8 offset:1536
    v_add_f32 v76, v76, v78
    v_smfmac_f32_16x16x64_bf16 v[80:83], v[48:51], v[160:167], v1
    ds_read_b64_tr_b16 v[94:95], v8 offset:1664
    v_add_f32 v77, v77, v79
    ds_read_b128 v[40:43], v10 offset:2048
    v_smfmac_f32_16x16x64_bf16 v[84:87], v[48:51], v[224:231], v1
    v_cvt_pk_bf16_f32 v25, v76, v77
    ds_write_b32 v7, v25 offset:512
    ds_read_b128 v[44:47], v10 offset:3072
    v_smfmac_f32_16x16x64_bf16 v[80:83], v[52:55], v[168:175], v1
    ds_read_b128 v[32:35], v10 offset:0
    ds_read_b128 v[36:39], v10 offset:1024
    v_smfmac_f32_16x16x64_bf16 v[84:87], v[52:55], v[232:239], v1
    ds_read_b128 v[48:51], v10 offset:4096
    v_smfmac_f32_16x16x64_bf16 v[80:83], v[56:59], v[176:183], v1
    ds_read_b128 v[52:55], v10 offset:5120
    v_smfmac_f32_16x16x64_bf16 v[84:87], v[56:59], v[240:247], v1
    v_smfmac_f32_16x16x64_bf16 v[80:83], v[60:63], v[184:191], v1
    ds_read_b128 v[56:59], v10 offset:6144
    v_smfmac_f32_16x16x64_bf16 v[84:87], v[60:63], v[248:255], v1
    ds_read_b128 v[60:63], v10 offset:7168
    s_waitcnt lgkmcnt(7)
    s_barrier
    ds_read_b64_tr_b16 v[72:73], v9 offset:0
    ds_read_b64_tr_b16 v[74:75], v9 offset:256
    s_waitcnt lgkmcnt(8)
    v_mfma_f32_16x16x32_bf16 v[104:107], v[40:43], v[88:91], 0
    ds_read_b64_tr_b16 v[76:77], v9 offset:1024
    v_mfma_f32_16x16x32_bf16 v[104:107], v[44:47], v[92:95], v[104:107]
    ds_read_b64_tr_b16 v[78:79], v9 offset:1280
    s_waitcnt lgkmcnt(9)
    v_mfma_f32_16x16x32_bf16 v[104:107], v[32:35], v[64:67], v[104:107]
    ds_read_b64_tr_b16 v[96:97], v9 offset:2048
    s_waitcnt lgkmcnt(9)
    v_mfma_f32_16x16x32_bf16 v[104:107], v[36:39], v[68:71], v[104:107]
    ds_read_b64_tr_b16 v[98:99], v9 offset:2304
    s_waitcnt lgkmcnt(9)
    v_mfma_f32_16x16x32_bf16 v[108:111], v[48:51], v[64:67], 0
    ds_read_b64_tr_b16 v[100:101], v9 offset:3072
    s_waitcnt lgkmcnt(9)
    v_mfma_f32_16x16x32_bf16 v[108:111], v[52:55], v[68:71], v[108:111]
    ds_read_b64_tr_b16 v[102:103], v9 offset:3328
    s_waitcnt lgkmcnt(9)
    v_mfma_f32_16x16x32_bf16 v[108:111], v[56:59], v[88:91], v[108:111]
    s_waitcnt lgkmcnt(8)
    ds_read_b128 v[40:43], v11
    v_mfma_f32_16x16x32_bf16 v[108:111], v[60:63], v[92:95], v[108:111]
    ds_read_b128 v[44:47], v11 offset:1024
    s_waitcnt lgkmcnt(8)
    v_mfma_f32_16x16x32_bf16 v[28:31], v[72:75], v[64:67], 0
    v_add_f32 v80, v80, v82
    v_add_f32 v81, v81, v83
    s_waitcnt lgkmcnt(6)
    v_mfma_f32_16x16x32_bf16 v[28:31], v[76:79], v[68:71], v[28:31]
    v_cvt_pk_bf16_f32 v26, v80, v81
    v_add_f32 v84, v84, v86
    s_waitcnt lgkmcnt(4)
    v_mfma_f32_16x16x32_bf16 v[28:31], v[96:99], v[88:91], v[28:31]
    v_add_f32 v85, v85, v87
    v_cvt_pk_bf16_f32 v27, v84, v85
    s_waitcnt lgkmcnt(2)
    v_mfma_f32_16x16x32_bf16 v[28:31], v[100:103], v[92:95], v[28:31]
    global_store_dwordx4 v13, v[24:27], s[44:45] sc1
    v_mov_b32 v76, v26
    v_mov_b32 v77, 0
    v_mov_b32 v78, v27
    v_mov_b32 v79, 0
    ds_read_b128 v[48:51], v14 offset:0
    ds_read_b128 v[52:55], v14 offset:1024
    v_max3_f32 v26, v104, v105, v106
    v_max3_f32 v27, v107, v108, v109
    v_max3_f32 v26, v26, v110, v111
    v_max3_f32 v26, v26, v28, v29
    v_max_f32 v26, v26, v27
    v_mov_b32 v27, v26
    ds_read_b128 v[56:59], v15 offset:0
    ds_read_b128 v[60:63], v15 offset:1024
    v_permlane16_swap_b32 v26, v27
    v_max_f32 v26, v26, v27
    v_mov_b32 v27, v26
    ds_read_b128 v[32:35], v14 offset:2048
    ds_read_b128 v[36:39], v14 offset:3072
    v_permlane32_swap_b32 v26, v27
    v_max_f32 v26, v26, v27
    v_mul_f32 v26, s48, v26
    v_pk_fma_f32 v[104:105], v[104:105], s[48:49], v[26:27] op_sel_hi:[1,0,0] neg_lo:[0,0,1] neg_hi:[0,0,1]
    v_pk_fma_f32 v[106:107], v[106:107], s[48:49], v[26:27] op_sel_hi:[1,0,0] neg_lo:[0,0,1] neg_hi:[0,0,1]
    v_pk_fma_f32 v[108:109], v[108:109], s[48:49], v[26:27] op_sel_hi:[1,0,0] neg_lo:[0,0,1] neg_hi:[0,0,1]
    v_pk_fma_f32 v[110:111], v[110:111], s[48:49], v[26:27] op_sel_hi:[1,0,0] neg_lo:[0,0,1] neg_hi:[0,0,1]
    v_pk_fma_f32 v[28:29], v[28:29], s[48:49], v[26:27] op_sel_hi:[1,0,0] neg_lo:[0,0,1] neg_hi:[0,0,1]
    v_exp_f32 v104, v104
    v_exp_f32 v105, v105
    v_exp_f32 v106, v106
    v_exp_f32 v107, v107
    v_exp_f32 v108, v108
    v_exp_f32 v109, v109
    v_exp_f32 v110, v110
    v_exp_f32 v111, v111
    v_exp_f32 v28, v28
    v_exp_f32 v29, v29
    v_mov_b32 v93, 0
    v_cvt_pk_bf16_f32 v88, v104, v105
    v_cvt_pk_bf16_f32 v89, v106, v107
    v_cvt_pk_bf16_f32 v90, v108, v109
    v_cvt_pk_bf16_f32 v91, v110, v111
    v_cvt_pk_bf16_f32 v92, v28, v29
    s_waitcnt lgkmcnt(6)
    v_mfma_f32_16x16x32_bf16 v[72:75], v[20:23], v[88:91], 0
    v_mfma_f32_16x16x32_bf16 v[64:67], v[40:43], v[88:91], 0
    ds_read_b128 v[104:107], v14 offset:4096
    v_mfma_f32_16x16x32_bf16 v[68:71], v[44:47], v[88:91], 0
    ds_read_b128 v[108:111], v14 offset:5120
    v_mfma_f32_16x16x16_bf16 v[72:75], v[20:21], v[92:93], v[72:75]
    v_mfma_f32_16x16x16_bf16 v[64:67], v[76:77], v[92:93], v[64:67]
    ds_read_b128 v[40:43], v15 offset:2048
    v_mfma_f32_16x16x16_bf16 v[68:71], v[78:79], v[92:93], v[68:71]
    ds_read_b128 v[44:47], v15 offset:3072
    s_nop 1
    v_rcp_f32 v26, v72
    ds_read_b128 v[88:91], v15 offset:4096
    ds_read_b128 v[92:95], v15 offset:5120
    s_nop 3
    v_cndmask_b32 v64, v68, v64, s[50:51]
    v_cndmask_b32 v65, v69, v65, s[50:51]
    v_cndmask_b32 v66, v70, v66, s[50:51]
    v_cndmask_b32 v67, v71, v67, s[50:51]
    v_pk_mul_f32 v[64:65], v[64:65], v[26:27] op_sel_hi:[1,0]
    v_pk_mul_f32 v[66:67], v[66:67], v[26:27] op_sel_hi:[1,0]
    v_cvt_pk_bf16_f32 v64, v64, v65
    v_cvt_pk_bf16_f32 v65, v66, v67
    ds_write_b64 v12, v[64:65]
    s_waitcnt lgkmcnt(0)
    s_barrier
    ds_read_b128 v[64:67], v13
    ds_read_b128 v[68:71], v13 offset:1024
    v_mov_b64 v[72:73], 0
    v_mov_b64 v[74:75], 0
    v_mov_b64 v[76:77], 0
    v_mov_b64 v[78:79], 0
    v_mov_b64 v[80:81], 0
    v_mov_b64 v[82:83], 0
    v_mov_b64 v[96:97], 0
    v_mov_b64 v[98:99], 0
    v_mov_b64 v[100:101], 0
    v_mov_b64 v[102:103], 0
    s_waitcnt lgkmcnt(1)
    v_smfmac_f32_16x16x64_bf16 v[72:75], v[64:67], v[48:55], v1
    ds_read_b128 v[48:51], v14 offset:6144
    s_waitcnt lgkmcnt(1)
    v_smfmac_f32_16x16x64_bf16 v[72:75], v[68:71], v[56:63], v1
    ds_read_b128 v[52:55], v14 offset:7168
    v_smfmac_f32_16x16x64_bf16 v[76:79], v[64:67], v[32:39], v1
    ds_read_b128 v[56:59], v15 offset:6144
    v_smfmac_f32_16x16x64_bf16 v[76:79], v[68:71], v[40:47], v1
    ds_read_b128 v[60:63], v15 offset:7168
    v_add_f32 v72, v72, v74
    v_smfmac_f32_16x16x64_bf16 v[80:83], v[64:67], v[104:111], v1
    ds_read_b128 v[32:35], v14 offset:8192
    v_add_f32 v73, v73, v75
    v_smfmac_f32_16x16x64_bf16 v[80:83], v[68:71], v[88:95], v1
    ds_read_b128 v[36:39], v14 offset:9216
    ds_read_b128 v[104:107], v13 offset:14336
    v_cvt_pk_bf16_f32 v84, v72, v73
    v_add_f32 v76, v76, v78
    v_smfmac_f32_16x16x64_bf16 v[96:99], v[64:67], v[112:119], v1
    ds_read_b128 v[40:43], v15 offset:8192
    ds_read_b128 v[108:111], v13 offset:14336
    v_add_f32 v77, v77, v79
    v_cvt_pk_bf16_f32 v85, v76, v77
    v_smfmac_f32_16x16x64_bf16 v[96:99], v[68:71], v[120:127], v1
    ds_read_b128 v[44:47], v15 offset:9216
    ds_read_b128 v[88:91], v13 offset:14336
    v_add_f32 v80, v80, v82
    v_add_f32 v81, v81, v83
    v_smfmac_f32_16x16x64_bf16 v[100:103], v[64:67], v[144:151], v1
    v_cvt_pk_bf16_f32 v86, v80, v81
    v_smfmac_f32_16x16x64_bf16 v[100:103], v[68:71], v[152:159], v1
    v_add_f32 v96, v96, v98
    v_add_f32 v97, v97, v99
    s_waitcnt lgkmcnt(4)
    v_smfmac_f32_16x16x64_bf16 v[104:107], v[64:67], v[208:215], v1
    v_cvt_pk_bf16_f32 v87, v96, v97
    v_and_or_b32 v84, v84, -2, s52
    global_store_dwordx4 v16, v[84:87], s[26:27]
    v_smfmac_f32_16x16x64_bf16 v[104:107], v[68:71], v[216:223], v1
    v_add_f32 v100, v100, v102
    v_add_f32 v101, v101, v103
    s_waitcnt lgkmcnt(2)
    v_smfmac_f32_16x16x64_bf16 v[108:111], v[64:67], v[48:55], v1
    v_cvt_pk_bf16_f32 v28, v100, v101
    v_smfmac_f32_16x16x64_bf16 v[108:111], v[68:71], v[56:63], v1
    v_add_f32 v104, v104, v106
    v_add_f32 v105, v105, v107
    s_waitcnt lgkmcnt(0)
    v_smfmac_f32_16x16x64_bf16 v[88:91], v[64:67], v[32:39], v1
    v_cvt_pk_bf16_f32 v29, v104, v105
    v_smfmac_f32_16x16x64_bf16 v[88:91], v[68:71], v[40:47], v1
    v_add_f32 v108, v108, v110
    v_add_f32 v109, v109, v111
    v_cvt_pk_bf16_f32 v30, v108, v109
    s_nop 5
    v_add_f32 v88, v88, v90
    v_add_f32 v89, v89, v91
    v_cvt_pk_bf16_f32 v31, v88, v89
    v_and_or_b32 v28, v28, -2, s52
    global_store_dwordx4 v16, v[28:31], s[28:29]
    v_mov_b64 v[72:73], 0
    v_mov_b64 v[74:75], 0
    v_mov_b64 v[76:77], 0
    v_mov_b64 v[78:79], 0
    v_mov_b64 v[80:81], 0
    v_mov_b64 v[82:83], 0
    v_mov_b64 v[84:85], 0
    v_mov_b64 v[86:87], 0
    s_cmp_ge_u32 s8, 2
    s_cbranch_scc1 L_nored_25
    v_bfe_u32 v26, v13, 4, 3
    v_lshrrev_b32 v27, 1, v26
    v_and_b32 v26, 1, v26
    v_lshlrev_b32 v26, 4, v26
    v_mov_b32 v68, 0x3f80
    v_lshlrev_b32 v26, v26, v68
    v_cmp_eq_u32 vcc, 0, v27
    s_nop 1
    v_cndmask_b32 v64, 0, v26, vcc
    v_cmp_eq_u32 vcc, 1, v27
    s_nop 1
    v_cndmask_b32 v65, 0, v26, vcc
    v_cmp_eq_u32 vcc, 2, v27
    s_nop 1
    v_cndmask_b32 v66, 0, v26, vcc
    v_cmp_eq_u32 vcc, 3, v27
    s_nop 1
    v_cndmask_b32 v67, 0, v26, vcc
    s_nop 15
    s_nop 15
    s_nop 15
    global_load_dwordx4 v[32:35], v17, s[26:27] offset:0 sc1
    global_load_dwordx4 v[36:39], v17, s[26:27] offset:2048 sc1
    global_load_dwordx4 v[40:43], v17, s[34:35] offset:0 sc1
    global_load_dwordx4 v[44:47], v17, s[34:35] offset:2048 sc1
L_poll1_26:
    s_waitcnt vmcnt(3)
    v_mfma_f32_16x16x32_bf16 v[68:71], v[32:35], v[64:67], 0
    v_xor_b32 v26, s52, v32
    s_waitcnt vmcnt(2)
    v_mfma_f32_16x16x32_bf16 v[68:71], v[36:39], v[64:67], v[68:71]
    v_bitop3_b32 v26, v26, v36, s52 bitop3:0xf6
    s_waitcnt vmcnt(1)
    v_mfma_f32_16x16x32_bf16 v[68:71], v[40:43], v[64:67], v[68:71]
    v_bitop3_b32 v26, v26, v40, s52 bitop3:0xf6
    s_waitcnt vmcnt(0)
    v_mfma_f32_16x16x32_bf16 v[68:71], v[44:47], v[64:67], v[68:71]
    v_bitop3_b32 v26, v26, v44, s52 bitop3:0xf6
    v_and_b32 v26, 1, v26
    v_cmp_ne_u32 vcc, 0, v26
    s_cbranch_vccz L_ok1_27
    global_load_dwordx4 v[32:35], v17, s[26:27] offset:0 sc1
    global_load_dwordx4 v[36:39], v17, s[26:27] offset:2048 sc1
    global_load_dwordx4 v[40:43], v17, s[34:35] offset:0 sc1
    global_load_dwordx4 v[44:47], v17, s[34:35] offset:2048 sc1
    s_waitcnt vmcnt(3)
    v_mfma_f32_16x16x32_bf16 v[68:71], v[32:35], v[64:67], 0
    v_xor_b32 v26, s52, v32
    s_waitcnt vmcnt(2)
    v_mfma_f32_16x16x32_bf16 v[68:71], v[36:39], v[64:67], v[68:71]
    v_bitop3_b32 v26, v26, v36, s52 bitop3:0xf6
    s_waitcnt vmcnt(1)
    v_mfma_f32_16x16x32_bf16 v[68:71], v[40:43], v[64:67], v[68:71]
    v_bitop3_b32 v26, v26, v40, s52 bitop3:0xf6
    s_waitcnt vmcnt(0)
    v_mfma_f32_16x16x32_bf16 v[68:71], v[44:47], v[64:67], v[68:71]
    v_bitop3_b32 v26, v26, v44, s52 bitop3:0xf6
    v_and_b32 v26, 1, v26
    v_cmp_ne_u32 vcc, 0, v26
    s_cbranch_vccz L_ok1_27
    global_load_dwordx4 v[32:35], v17, s[26:27] offset:0 sc1
    global_load_dwordx4 v[36:39], v17, s[26:27] offset:2048 sc1
    global_load_dwordx4 v[40:43], v17, s[34:35] offset:0 sc1
    global_load_dwordx4 v[44:47], v17, s[34:35] offset:2048 sc1
    s_sub_u32 s12, s12, 1
    s_cbranch_scc1 L_fail
    s_branch L_poll1_26
L_ok1_27:
    s_nop 5
    v_add_f32 v68, v68, v69
    v_add_f32 v70, v70, v71
    v_cvt_pk_bf16_f32 v26, v68, v70
    v_min_u32 v26, -2, v26
    s_mov_b64 exec, s[50:51]
    global_store_dword v18, v26, s[36:37]
    v_mov_b32 v27, -1
    global_store_dword v18, v27, s[38:39]
    s_mov_b64 exec, -1
L_nored_25:
    s_barrier
    v_mov_b64 v[64:65], 0
    v_mov_b64 v[66:67], 0
    v_mov_b64 v[68:69], 0
    v_mov_b64 v[70:71], 0
    s_nop 15
    global_load_dwordx4 v[32:35], v2, s[36:37] sc1
    global_load_dwordx4 v[36:39], v2, s[36:37] offset:1024 sc1
    s_add_u32 s11, s11, 1
    v_xor_b32 v10, 16384, v10
    v_xor_b32 v11, 16384, v11
    s_add_u32 s44, s44, 262144
    s_addc_u32 s45, s45, 0
L_chkA_28:
    s_waitcnt vmcnt(0)
    v_max3_u32 v26, v32, v34, v36
    v_max_u32 v26, v26, v38
    v_cmp_eq_u32 vcc, -1, v26
    s_cbranch_vccz L_go_29
    global_load_dwordx4 v[32:35], v2, s[36:37] sc1
    global_load_dwordx4 v[36:39], v2, s[36:37] offset:1024 sc1
    s_waitcnt vmcnt(0)
    v_max3_u32 v26, v32, v34, v36
    v_max_u32 v26, v26, v38
    v_cmp_eq_u32 vcc, -1, v26
    s_cbranch_vccz L_go_29
    global_load_dwordx4 v[32:35], v2, s[36:37] sc1
    global_load_dwordx4 v[36:39], v2, s[36:37] offset:1024 sc1
    s_waitcnt vmcnt(0)
    v_max3_u32 v26, v32, v34, v36
    v_max_u32 v26, v26, v38
    v_cmp_eq_u32 vcc, -1, v26
    s_cbranch_vccz L_go_29
    global_load_dwordx4 v[32:35], v2, s[36:37] sc1
    global_load_dwordx4 v[36:39], v2, s[36:37] offset:1024 sc1
    s_sub_u32 s12, s12, 1
    s_cbranch_scc1 L_fail
    s_branch L_chkA_28
L_go_29:
    s_xor_b32 s52, s52, 1
    s_add_u32 s66, s66, 1
    s_cmp_lt_u32 s11, 63
    s_cbranch_scc1 L_step
    ds_write_b128 v2, v[32:35]
    ds_write_b128 v2, v[36:39] offset:1024
    v_smfmac_f32_16x16x64_bf16 v[72:75], v[32:35], a[128:135], v1
    v_smfmac_f32_16x16x64_bf16 v[76:79], v[32:35], a[192:199], v1
    v_smfmac_f32_16x16x64_bf16 v[72:75], v[36:39], a[136:143], v1
    v_smfmac_f32_16x16x64_bf16 v[76:79], v[36:39], a[200:207], v1
    v_smfmac_f32_16x16x64_bf16 v[80:83], v[32:35], v[128:135], v1
    s_waitcnt lgkmcnt(0)
    s_barrier
    ds_read_b128 v[40:43], v3
    ds_read_b128 v[44:47], v3 offset:1024
    ds_read_b128 v[48:51], v4
    ds_read_b128 v[52:55], v4 offset:1024
    ds_read_b128 v[56:59], v5
    ds_read_b128 v[60:63], v5 offset:1024
    v_smfmac_f32_16x16x64_bf16 v[84:87], v[32:35], v[192:199], v1
    v_smfmac_f32_16x16x64_bf16 v[80:83], v[36:39], v[136:143], v1
    v_smfmac_f32_16x16x64_bf16 v[84:87], v[36:39], v[200:207], v1
    ds_read_b128 v[88:91], v0 offset:0
    ds_read_b128 v[92:95], v0 offset:1024
    ds_read_b128 v[96:99], v0 offset:2048
    ds_read_b128 v[100:103], v0 offset:3072
    ds_read_b128 v[104:107], v0 offset:4096
    ds_read_b128 v[108:111], v0 offset:5120
    ds_read_b128 v[32:35], v0 offset:6144
    ds_read_b128 v[36:39], v0 offset:7168
    s_waitcnt lgkmcnt(8)
    v_smfmac_f32_16x16x64_bf16 v[72:75], v[40:43], a[144:151], v1
    v_smfmac_f32_16x16x64_bf16 v[76:79], v[40:43], a[208:215], v1
    v_smfmac_f32_16x16x64_bf16 v[72:75], v[44:47], a[152:159], v1
    v_smfmac_f32_16x16x64_bf16 v[76:79], v[44:47], a[216:223], v1
    v_smfmac_f32_16x16x64_bf16 v[72:75], v[48:51], a[160:167], v1
    v_smfmac_f32_16x16x64_bf16 v[76:79], v[48:51], a[224:231], v1
    v_smfmac_f32_16x16x64_bf16 v[72:75], v[52:55], a[168:175], v1
    v_smfmac_f32_16x16x64_bf16 v[76:79], v[52:55], a[232:239], v1
    v_smfmac_f32_16x16x64_bf16 v[72:75], v[56:59], a[176:183], v1
    v_smfmac_f32_16x16x64_bf16 v[76:79], v[56:59], a[240:247], v1
    v_smfmac_f32_16x16x64_bf16 v[72:75], v[60:63], a[184:191], v1
    v_smfmac_f32_16x16x64_bf16 v[76:79], v[60:63], a[248:255], v1
    s_waitcnt lgkmcnt(0)
    v_smfmac_f32_16x16x64_bf16 v[80:83], v[40:43], v[88:95], v1
    v_smfmac_f32_16x16x64_bf16 v[84:87], v[40:43], v[96:103], v1
    v_add_f32 v72, v72, v74
    v_add_f32 v73, v73, v75
    v_cvt_pk_bf16_f32 v24, v72, v73
    v_smfmac_f32_16x16x64_bf16 v[80:83], v[44:47], v[104:111], v1
    v_add_f32 v76, v76, v78
    v_add_f32 v77, v77, v79
    v_cvt_pk_bf16_f32 v25, v76, v77
    v_smfmac_f32_16x16x64_bf16 v[84:87], v[44:47], v[32:39], v1
    v_smfmac_f32_16x16x64_bf16 v[80:83], v[48:51], v[160:167], v1
    v_smfmac_f32_16x16x64_bf16 v[84:87], v[48:51], v[224:231], v1
    v_smfmac_f32_16x16x64_bf16 v[80:83], v[52:55], v[168:175], v1
    v_smfmac_f32_16x16x64_bf16 v[84:87], v[52:55], v[232:239], v1
    v_smfmac_f32_16x16x64_bf16 v[80:83], v[56:59], v[176:183], v1
    v_smfmac_f32_16x16x64_bf16 v[84:87], v[56:59], v[240:247], v1
    v_smfmac_f32_16x16x64_bf16 v[80:83], v[60:63], v[184:191], v1
    v_smfmac_f32_16x16x64_bf16 v[84:87], v[60:63], v[248:255], v1
    s_nop 7
    v_add_f32 v80, v80, v82
    v_add_f32 v81, v81, v83
    v_cvt_pk_bf16_f32 v26, v80, v81
    v_add_f32 v84, v84, v86
    v_add_f32 v85, v85, v87
    v_cvt_pk_bf16_f32 v27, v84, v85
    v_mov_b32 v30, s11
    s_mov_b64 exec, s[64:65]
    global_store_dword v13, v30, s[62:63] sc1
    s_mov_b64 exec, -1
    global_store_dwordx4 v13, v[24:27], s[44:45] sc1
    s_waitcnt vmcnt(0)
    s_barrier
    v_mov_b32 v30, 64
    s_mov_b64 exec, s[64:65]
    global_store_dword v13, v30, s[62:63] sc1
    s_mov_b64 exec, -1
    s_waitcnt vmcnt(0)
    s_endpgm
L_p1slow_9:
    s_mov_b64 exec, 1
    global_load_dword v19, v13, s[60:61] offset:4 sc1
    s_mov_b64 exec, -1
    s_waitcnt vmcnt(0)
    v_readfirstlane_b32 s55, v19
    s_sub_u32 s12, s12, 1
    s_cbranch_scc1 L_fail
    s_cmp_lt_u32 s55, s56
    s_cbranch_scc1 L_p1slow_9
    s_branch L_p1ok_10
L_p1slow_16:
    s_mov_b64 exec, 1
    global_load_dword v19, v13, s[60:61] offset:8 sc1
    s_mov_b64 exec, -1
    s_waitcnt vmcnt(0)
    v_readfirstlane_b32 s55, v19
    s_sub_u32 s12, s12, 1
    s_cbranch_scc1 L_fail
    s_cmp_lt_u32 s55, s56
    s_cbranch_scc1 L_p1slow_16
    s_branch L_p1ok_17
L_p1slow_23:
    s_mov_b64 exec, 1
    global_load_dword v19, v13, s[60:61] offset:0 sc1
    s_mov_b64 exec, -1
    s_waitcnt vmcnt(0)
    v_readfirstlane_b32 s55, v19
    s_sub_u32 s12, s12, 1
    s_cbranch_scc1 L_fail
    s_cmp_lt_u32 s55, s56
    s_cbranch_scc1 L_p1slow_23
    s_branch L_p1ok_24
L_worker:
    s_mov_b32 s3, s13
    s_sub_u32 s13, s13, 2
    s_and_b32 s10, s13, 1
    s_lshr_b32 s13, s13, 1
    v_mov_b32 v9, 0
    s_mov_b64 exec, 1
    s_lshl_b32 s54, s10, 5
    s_add_u32 s54, s54, s9
    s_lshl_b32 s54, s54, 4
    s_lshl_b32 s55, s13, 2
    s_add_u32 s54, s54, s55
    s_add_u32 s54, s54, 117440512
    v_mov_b32 v8, s54
    global_store_dword v8, v9, s[4:5] sc1
    s_lshl_b32 s54, s3, 5
    s_add_u32 s54, s54, s9
    s_lshl_b32 s54, s54, 2
    s_add_u32 s54, s54, 117452800
    v_mov_b32 v8, s54
    global_store_dword v8, v9, s[4:5]
    s_mov_b64 exec, -1
    s_cmp_lg_u32 s10, 1
    s_cbranch_scc1 L_nopoi_30
    v_mov_b64 v[12:13], -1
    v_mov_b64 v[14:15], -1
    s_lshl_b32 s54, s9, 11
    s_lshl_b32 s55, s8, 9
    s_add_u32 s54, s54, s55
    s_lshl_b32 s55, s13, 16
    s_add_u32 s54, s54, s55
    s_add_u32 s54, s54, 136314880
    v_lshlrev_b32 v8, 4, v0
    v_add_u32 v8, s54, v8
    s_mov_b32 exec_hi, 0
    global_store_dwordx4 v8, v[12:15], s[4:5] sc1
    v_add_u32 v8, 196608, v8
    global_store_dwordx4 v8, v[12:15], s[4:5] sc1
    v_add_u32 v8, 196608, v8
    global_store_dwordx4 v8, v[12:15], s[4:5] sc1
    v_add_u32 v8, 196608, v8
    global_store_dwordx4 v8, v[12:15], s[4:5] sc1
    v_add_u32 v8, 196608, v8
    global_store_dwordx4 v8, v[12:15], s[4:5] sc1
    v_add_u32 v8, 196608, v8
    global_store_dwordx4 v8, v[12:15], s[4:5] sc1
    v_add_u32 v8, 196608, v8
    global_store_dwordx4 v8, v[12:15], s[4:5] sc1
    v_add_u32 v8, 196608, v8
    global_store_dwordx4 v8, v[12:15], s[4:5] sc1
    v_add_u32 v8, 196608, v8
    global_store_dwordx4 v8, v[12:15], s[4:5] sc1
    v_add_u32 v8, 196608, v8
    global_store_dwordx4 v8, v[12:15], s[4:5] sc1
    v_add_u32 v8, 196608, v8
    global_store_dwordx4 v8, v[12:15], s[4:5] sc1
    v_add_u32 v8, 196608, v8
    global_store_dwordx4 v8, v[12:15], s[4:5] sc1
    v_add_u32 v8, 196608, v8
    global_store_dwordx4 v8, v[12:15], s[4:5] sc1
    v_add_u32 v8, 196608, v8
    global_store_dwordx4 v8, v[12:15], s[4:5] sc1
    v_add_u32 v8, 196608, v8
    global_store_dwordx4 v8, v[12:15], s[4:5] sc1
    v_add_u32 v8, 196608, v8
    global_store_dwordx4 v8, v[12:15], s[4:5] sc1
    v_add_u32 v8, 196608, v8
    global_store_dwordx4 v8, v[12:15], s[4:5] sc1
    v_add_u32 v8, 196608, v8
    global_store_dwordx4 v8, v[12:15], s[4:5] sc1
    v_add_u32 v8, 196608, v8
    global_store_dwordx4 v8, v[12:15], s[4:5] sc1
    v_add_u32 v8, 196608, v8
    global_store_dwordx4 v8, v[12:15], s[4:5] sc1
    v_add_u32 v8, 196608, v8
    global_store_dwordx4 v8, v[12:15], s[4:5] sc1
    v_add_u32 v8, 196608, v8
    s_cmp_lg_u32 s13, 0
    s_cbranch_scc1 L_nolast_31
    global_store_dwordx4 v8, v[12:15], s[4:5] sc1
    v_add_u32 v8, 196608, v8
L_nolast_31:
    s_mov_b64 exec, -1
L_nopoi_30:
L_p1:
    s_mul_i32 s54, s10, 56
    s_add_u32 s14, s0, s54
    s_addc_u32 s15, s1, 0
    s_load_dwordx4 s[60:63], s[14:15], 24
    s_load_dwordx2 s[18:19], s[0:1], 0
    s_waitcnt lgkmcnt(0)
    s_lshl_b32 s54, s9, 8
    s_add_u32 s60, s60, s54
    s_addc_u32 s61, s61, 0
    s_add_u32 s62, s62, s54
    s_addc_u32 s63, s63, 0
    v_lshlrev_b32 v1, 4, v0
    v_lshrrev_b32 v8, 3, v0
    s_lshl_b32 s54, s8, 3
    v_add_u32 v8, s54, v8
    v_bfe_u32 v9, v8, 1, 3
    v_and_b32 v2, 7, v0
    v_xor_b32 v2, v2, v9
    v_lshlrev_b32 v2, 4, v2
    v_lshl_add_u32 v2, v8, 10, v2
    v_and_b32 v8, 31, v0
    v_bfe_u32 v9, v8, 1, 3
    v_lshrrev_b32 v10, 5, v0
    v_xor_b32 v9, v9, v10
    v_lshlrev_b32 v9, 4, v9
    v_and_b32 v10, 7, v8
    v_lshl_add_u32 v9, v10, 7, v9
    v_lshrrev_b32 v10, 3, v8
    v_lshl_add_u32 v4, v10, 13, v9
    v_xor_b32 v5, 32, v4
    v_xor_b32 v6, 64, v4
    v_xor_b32 v7, 96, v4
    s_mov_b32 s20, s13
    s_lshl_b32 s54, s20, 15
    s_add_u32 s14, s18, s54
    s_addc_u32 s15, s19, 0
    s_lshl_b32 s54, s8, 13
    s_add_u32 s54, s54, 0
    s_add_u32 m0, s54, 0
    s_nop 0
    global_load_lds_dwordx4 v2, s[14:15] offset:0
    s_add_u32 m0, s54, 896
    s_nop 0
    global_load_lds_dwordx4 v2, s[14:15] offset:128
    s_add_u32 m0, s54, 1792
    s_nop 0
    global_load_lds_dwordx4 v2, s[14:15] offset:256
    s_add_u32 m0, s54, 2688
    s_nop 0
    global_load_lds_dwordx4 v2, s[14:15] offset:384
    s_add_u32 m0, s54, 3584
    s_nop 0
    global_load_lds_dwordx4 v2, s[14:15] offset:512
    s_add_u32 m0, s54, 4480
    s_nop 0
    global_load_lds_dwordx4 v2, s[14:15] offset:640
    s_add_u32 m0, s54, 5376
    s_nop 0
    global_load_lds_dwordx4 v2, s[14:15] offset:768
    s_add_u32 m0, s54, 6272
    s_nop 0
    global_load_lds_dwordx4 v2, s[14:15] offset:896
    s_cmp_eq_u32 s8, 1
    s_cbranch_scc1 L_p1w1_34
    s_cmp_eq_u32 s8, 2
    s_cbranch_scc1 L_p1w2_35
    s_cmp_eq_u32 s8, 3
    s_cbranch_scc1 L_p1w3_36
L_p1w0_33:
    v_lshrrev_b32 v8, 4, v0
    v_lshlrev_b32 v9, 2, v8
    v_and_b32 v10, 15, v0
    v_xor_b32 v10, v10, v9
    v_lshlrev_b32 v10, 4, v10
    v_add_u32 v8, 0, v8
    v_lshl_add_u32 v12, v8, 13, v10
    v_add_u32 v13, 32768, v12
    v_add_u32 v14, 65536, v12
    v_add_u32 v15, 98304, v12
    v_bfe_u32 v8, v0, 2, 2
    v_xor_b32 v9, 0, v8
    v_lshlrev_b32 v9, 6, v9
    v_lshrrev_b32 v10, 5, v0
    v_lshl_add_u32 v8, v10, 3, v8
    v_lshl_add_u32 v9, v8, 8, v9
    v_bfe_u32 v10, v0, 4, 1
    v_lshl_add_u32 v9, v10, 5, v9
    v_and_b32 v10, 3, v0
    v_lshl_add_u32 v11, v10, 3, v9
    s_add_u32 s14, s60, 0
    s_addc_u32 s15, s61, 0
    s_mov_b32 m0, 32768
    s_nop 0
    global_load_lds_dwordx4 v12, s[14:15]
    s_mov_b32 m0, 33792
    s_nop 0
    global_load_lds_dwordx4 v13, s[14:15]
    s_mov_b32 m0, 34816
    s_nop 0
    global_load_lds_dwordx4 v14, s[14:15]
    s_mov_b32 m0, 35840
    s_nop 0
    global_load_lds_dwordx4 v15, s[14:15]
    s_add_u32 s14, s60, 524288
    s_addc_u32 s15, s61, 0
    s_mov_b32 m0, 49152
    s_nop 0
    global_load_lds_dwordx4 v12, s[14:15]
    s_mov_b32 m0, 50176
    s_nop 0
    global_load_lds_dwordx4 v13, s[14:15]
    s_mov_b32 m0, 51200
    s_nop 0
    global_load_lds_dwordx4 v14, s[14:15]
    s_mov_b32 m0, 52224
    s_nop 0
    global_load_lds_dwordx4 v15, s[14:15]
    s_add_u32 s14, s60, 1048576
    s_addc_u32 s15, s61, 0
    s_mov_b32 m0, 65536
    s_nop 0
    global_load_lds_dwordx4 v12, s[14:15]
    s_mov_b32 m0, 66560
    s_nop 0
    global_load_lds_dwordx4 v13, s[14:15]
    s_mov_b32 m0, 67584
    s_nop 0
    global_load_lds_dwordx4 v14, s[14:15]
    s_mov_b32 m0, 68608
    s_nop 0
    global_load_lds_dwordx4 v15, s[14:15]
    s_add_u32 s14, s60, 1572864
    s_addc_u32 s15, s61, 0
    s_mov_b32 m0, 81920
    s_nop 0
    global_load_lds_dwordx4 v12, s[14:15]
    s_mov_b32 m0, 82944
    s_nop 0
    global_load_lds_dwordx4 v13, s[14:15]
    s_mov_b32 m0, 83968
    s_nop 0
    global_load_lds_dwordx4 v14, s[14:15]
    s_mov_b32 m0, 84992
    s_nop 0
    global_load_lds_dwordx4 v15, s[14:15]
    s_add_u32 s14, s60, 2097152
    s_addc_u32 s15, s61, 0
    s_mov_b32 m0, 98304
    s_nop 0
    global_load_lds_dwordx4 v12, s[14:15]
    s_mov_b32 m0, 99328
    s_nop 0
    global_load_lds_dwordx4 v13, s[14:15]
    s_mov_b32 m0, 100352
    s_nop 0
    global_load_lds_dwordx4 v14, s[14:15]
    s_mov_b32 m0, 101376
    s_nop 0
    global_load_lds_dwordx4 v15, s[14:15]
    s_add_u32 s14, s60, 2621440
    s_addc_u32 s15, s61, 0
    s_mov_b32 m0, 114688
    s_nop 0
    global_load_lds_dwordx4 v12, s[14:15]
    s_mov_b32 m0, 115712
    s_nop 0
    global_load_lds_dwordx4 v13, s[14:15]
    s_mov_b32 m0, 116736
    s_nop 0
    global_load_lds_dwordx4 v14, s[14:15]
    s_mov_b32 m0, 117760
    s_nop 0
    global_load_lds_dwordx4 v15, s[14:15]
    s_waitcnt vmcnt(20)
    s_barrier
    s_lshl_b32 s54, s3, 2
    s_add_u32 s54, s54, 32
    v_mov_b32 v8, s54
    v_mov_b32 v9, 1
    s_mov_b64 exec, 1
    global_atomic_add v8, v9, s[6:7] sc1
    s_mov_b64 exec, -1
    v_add_u32 v16, 32768, v11
    ds_read_b64_tr_b16 a[0:1], v16 offset:0
    ds_read_b64_tr_b16 a[2:3], v16 offset:1024
    ds_read_b64_tr_b16 a[4:5], v16 offset:4096
    ds_read_b64_tr_b16 a[6:7], v16 offset:5120
    ds_read_b64_tr_b16 a[8:9], v16 offset:8192
    ds_read_b64_tr_b16 a[10:11], v16 offset:9216
    ds_read_b64_tr_b16 a[12:13], v16 offset:12288
    ds_read_b64_tr_b16 a[14:15], v16 offset:13312
    s_waitcnt lgkmcnt(0)
    s_barrier
    s_add_u32 s14, s60, 3145728
    s_addc_u32 s15, s61, 0
    s_mov_b32 m0, 131072
    s_nop 0
    global_load_lds_dwordx4 v12, s[14:15]
    s_mov_b32 m0, 132096
    s_nop 0
    global_load_lds_dwordx4 v13, s[14:15]
    s_mov_b32 m0, 133120
    s_nop 0
    global_load_lds_dwordx4 v14, s[14:15]
    s_mov_b32 m0, 134144
    s_nop 0
    global_load_lds_dwordx4 v15, s[14:15]
    s_waitcnt vmcnt(20)
    s_barrier
    v_add_u32 v16, 49152, v11
    ds_read_b64_tr_b16 a[16:17], v16 offset:0
    ds_read_b64_tr_b16 a[18:19], v16 offset:1024
    ds_read_b64_tr_b16 a[20:21], v16 offset:4096
    ds_read_b64_tr_b16 a[22:23], v16 offset:5120
    ds_read_b64_tr_b16 a[24:25], v16 offset:8192
    ds_read_b64_tr_b16 a[26:27], v16 offset:9216
    ds_read_b64_tr_b16 a[28:29], v16 offset:12288
    ds_read_b64_tr_b16 a[30:31], v16 offset:13312
    s_waitcnt lgkmcnt(0)
    s_barrier
    s_add_u32 s14, s60, 3670016
    s_addc_u32 s15, s61, 0
    s_mov_b32 m0, 147456
    s_nop 0
    global_load_lds_dwordx4 v12, s[14:15]
    s_mov_b32 m0, 148480
    s_nop 0
    global_load_lds_dwordx4 v13, s[14:15]
    s_mov_b32 m0, 149504
    s_nop 0
    global_load_lds_dwordx4 v14, s[14:15]
    s_mov_b32 m0, 150528
    s_nop 0
    global_load_lds_dwordx4 v15, s[14:15]
    s_waitcnt vmcnt(20)
    s_barrier
    v_add_u32 v16, 65536, v11
    ds_read_b64_tr_b16 a[32:33], v16 offset:0
    ds_read_b64_tr_b16 a[34:35], v16 offset:1024
    ds_read_b64_tr_b16 a[36:37], v16 offset:4096
    ds_read_b64_tr_b16 a[38:39], v16 offset:5120
    ds_read_b64_tr_b16 a[40:41], v16 offset:8192
    ds_read_b64_tr_b16 a[42:43], v16 offset:9216
    ds_read_b64_tr_b16 a[44:45], v16 offset:12288
    ds_read_b64_tr_b16 a[46:47], v16 offset:13312
    s_waitcnt lgkmcnt(0)
    s_barrier
    s_add_u32 s14, s62, 0
    s_addc_u32 s15, s63, 0
    s_mov_b32 m0, 32768
    s_nop 0
    global_load_lds_dwordx4 v12, s[14:15]
    s_mov_b32 m0, 33792
    s_nop 0
    global_load_lds_dwordx4 v13, s[14:15]
    s_mov_b32 m0, 34816
    s_nop 0
    global_load_lds_dwordx4 v14, s[14:15]
    s_mov_b32 m0, 35840
    s_nop 0
    global_load_lds_dwordx4 v15, s[14:15]
    s_waitcnt vmcnt(20)
    s_barrier
    v_add_u32 v16, 81920, v11
    ds_read_b64_tr_b16 a[48:49], v16 offset:0
    ds_read_b64_tr_b16 a[50:51], v16 offset:1024
    ds_read_b64_tr_b16 a[52:53], v16 offset:4096
    ds_read_b64_tr_b16 a[54:55], v16 offset:5120
    ds_read_b64_tr_b16 a[56:57], v16 offset:8192
    ds_read_b64_tr_b16 a[58:59], v16 offset:9216
    ds_read_b64_tr_b16 a[60:61], v16 offset:12288
    ds_read_b64_tr_b16 a[62:63], v16 offset:13312
    s_waitcnt lgkmcnt(0)
    s_barrier
    s_add_u32 s14, s62, 524288
    s_addc_u32 s15, s63, 0
    s_mov_b32 m0, 49152
    s_nop 0
    global_load_lds_dwordx4 v12, s[14:15]
    s_mov_b32 m0, 50176
    s_nop 0
    global_load_lds_dwordx4 v13, s[14:15]
    s_mov_b32 m0, 51200
    s_nop 0
    global_load_lds_dwordx4 v14, s[14:15]
    s_mov_b32 m0, 52224
    s_nop 0
    global_load_lds_dwordx4 v15, s[14:15]
    s_waitcnt vmcnt(20)
    s_barrier
    v_add_u32 v16, 98304, v11
    ds_read_b64_tr_b16 a[64:65], v16 offset:0
    ds_read_b64_tr_b16 a[66:67], v16 offset:1024
    ds_read_b64_tr_b16 a[68:69], v16 offset:4096
    ds_read_b64_tr_b16 a[70:71], v16 offset:5120
    ds_read_b64_tr_b16 a[72:73], v16 offset:8192
    ds_read_b64_tr_b16 a[74:75], v16 offset:9216
    ds_read_b64_tr_b16 a[76:77], v16 offset:12288
    ds_read_b64_tr_b16 a[78:79], v16 offset:13312
    s_waitcnt lgkmcnt(0)
    s_barrier
    s_add_u32 s14, s62, 1048576
    s_addc_u32 s15, s63, 0
    s_mov_b32 m0, 65536
    s_nop 0
    global_load_lds_dwordx4 v12, s[14:15]
    s_mov_b32 m0, 66560
    s_nop 0
    global_load_lds_dwordx4 v13, s[14:15]
    s_mov_b32 m0, 67584
    s_nop 0
    global_load_lds_dwordx4 v14, s[14:15]
    s_mov_b32 m0, 68608
    s_nop 0
    global_load_lds_dwordx4 v15, s[14:15]
    s_waitcnt vmcnt(20)
    s_barrier
    v_add_u32 v16, 114688, v11
    ds_read_b64_tr_b16 a[80:81], v16 offset:0
    ds_read_b64_tr_b16 a[82:83], v16 offset:1024
    ds_read_b64_tr_b16 a[84:85], v16 offset:4096
    ds_read_b64_tr_b16 a[86:87], v16 offset:5120
    ds_read_b64_tr_b16 a[88:89], v16 offset:8192
    ds_read_b64_tr_b16 a[90:91], v16 offset:9216
    ds_read_b64_tr_b16 a[92:93], v16 offset:12288
    ds_read_b64_tr_b16 a[94:95], v16 offset:13312
    s_waitcnt lgkmcnt(0)
    s_barrier
    s_add_u32 s14, s62, 1572864
    s_addc_u32 s15, s63, 0
    s_mov_b32 m0, 81920
    s_nop 0
    global_load_lds_dwordx4 v12, s[14:15]
    s_mov_b32 m0, 82944
    s_nop 0
    global_load_lds_dwordx4 v13, s[14:15]
    s_mov_b32 m0, 83968
    s_nop 0
    global_load_lds_dwordx4 v14, s[14:15]
    s_mov_b32 m0, 84992
    s_nop 0
    global_load_lds_dwordx4 v15, s[14:15]
    s_waitcnt vmcnt(20)
    s_barrier
    v_add_u32 v16, 131072, v11
    ds_read_b64_tr_b16 a[96:97], v16 offset:0
    ds_read_b64_tr_b16 a[98:99], v16 offset:1024
    ds_read_b64_tr_b16 a[100:101], v16 offset:4096
    ds_read_b64_tr_b16 a[102:103], v16 offset:5120
    ds_read_b64_tr_b16 a[104:105], v16 offset:8192
    ds_read_b64_tr_b16 a[106:107], v16 offset:9216
    ds_read_b64_tr_b16 a[108:109], v16 offset:12288
    ds_read_b64_tr_b16 a[110:111], v16 offset:13312
    s_waitcnt lgkmcnt(0)
    s_barrier
    s_add_u32 s14, s62, 2097152
    s_addc_u32 s15, s63, 0
    s_mov_b32 m0, 98304
    s_nop 0
    global_load_lds_dwordx4 v12, s[14:15]
    s_mov_b32 m0, 99328
    s_nop 0
    global_load_lds_dwordx4 v13, s[14:15]
    s_mov_b32 m0, 100352
    s_nop 0
    global_load_lds_dwordx4 v14, s[14:15]
    s_mov_b32 m0, 101376
    s_nop 0
    global_load_lds_dwordx4 v15, s[14:15]
    s_waitcnt vmcnt(20)
    s_barrier
    v_add_u32 v16, 147456, v11
    ds_read_b64_tr_b16 a[112:113], v16 offset:0
    ds_read_b64_tr_b16 a[114:115], v16 offset:1024
    ds_read_b64_tr_b16 a[116:117], v16 offset:4096
    ds_read_b64_tr_b16 a[118:119], v16 offset:5120
    ds_read_b64_tr_b16 a[120:121], v16 offset:8192
    ds_read_b64_tr_b16 a[122:123], v16 offset:9216
    ds_read_b64_tr_b16 a[124:125], v16 offset:12288
    ds_read_b64_tr_b16 a[126:127], v16 offset:13312
    s_waitcnt lgkmcnt(0)
    s_barrier
    s_add_u32 s14, s62, 2621440
    s_addc_u32 s15, s63, 0
    s_mov_b32 m0, 114688
    s_nop 0
    global_load_lds_dwordx4 v12, s[14:15]
    s_mov_b32 m0, 115712
    s_nop 0
    global_load_lds_dwordx4 v13, s[14:15]
    s_mov_b32 m0, 116736
    s_nop 0
    global_load_lds_dwordx4 v14, s[14:15]
    s_mov_b32 m0, 117760
    s_nop 0
    global_load_lds_dwordx4 v15, s[14:15]
    s_waitcnt vmcnt(20)
    s_barrier
    v_add_u32 v16, 32768, v11
    ds_read_b64_tr_b16 a[128:129], v16 offset:0
    ds_read_b64_tr_b16 a[130:131], v16 offset:1024
    ds_read_b64_tr_b16 a[132:133], v16 offset:4096
    ds_read_b64_tr_b16 a[134:135], v16 offset:5120
    ds_read_b64_tr_b16 a[136:137], v16 offset:8192
    ds_read_b64_tr_b16 a[138:139], v16 offset:9216
    ds_read_b64_tr_b16 a[140:141], v16 offset:12288
    ds_read_b64_tr_b16 a[142:143], v16 offset:13312
    s_waitcnt lgkmcnt(0)
    s_barrier
    s_add_u32 s14, s62, 3145728
    s_addc_u32 s15, s63, 0
    s_mov_b32 m0, 131072
    s_nop 0
    global_load_lds_dwordx4 v12, s[14:15]
    s_mov_b32 m0, 132096
    s_nop 0
    global_load_lds_dwordx4 v13, s[14:15]
    s_mov_b32 m0, 133120
    s_nop 0
    global_load_lds_dwordx4 v14, s[14:15]
    s_mov_b32 m0, 134144
    s_nop 0
    global_load_lds_dwordx4 v15, s[14:15]
    s_waitcnt vmcnt(20)
    s_barrier
    v_add_u32 v16, 49152, v11
    ds_read_b64_tr_b16 a[144:145], v16 offset:0
    ds_read_b64_tr_b16 a[146:147], v16 offset:1024
    ds_read_b64_tr_b16 a[148:149], v16 offset:4096
    ds_read_b64_tr_b16 a[150:151], v16 offset:5120
    ds_read_b64_tr_b16 a[152:153], v16 offset:8192
    ds_read_b64_tr_b16 a[154:155], v16 offset:9216
    ds_read_b64_tr_b16 a[156:157], v16 offset:12288
    ds_read_b64_tr_b16 a[158:159], v16 offset:13312
    s_waitcnt lgkmcnt(0)
    s_barrier
    s_add_u32 s14, s62, 3670016
    s_addc_u32 s15, s63, 0
    s_mov_b32 m0, 147456
    s_nop 0
    global_load_lds_dwordx4 v12, s[14:15]
    s_mov_b32 m0, 148480
    s_nop 0
    global_load_lds_dwordx4 v13, s[14:15]
    s_mov_b32 m0, 149504
    s_nop 0
    global_load_lds_dwordx4 v14, s[14:15]
    s_mov_b32 m0, 150528
    s_nop 0
    global_load_lds_dwordx4 v15, s[14:15]
    s_waitcnt vmcnt(20)
    s_barrier
    v_add_u32 v16, 65536, v11
    ds_read_b64_tr_b16 a[160:161], v16 offset:0
    ds_read_b64_tr_b16 a[162:163], v16 offset:1024
    ds_read_b64_tr_b16 a[164:165], v16 offset:4096
    ds_read_b64_tr_b16 a[166:167], v16 offset:5120
    ds_read_b64_tr_b16 a[168:169], v16 offset:8192
    ds_read_b64_tr_b16 a[170:171], v16 offset:9216
    ds_read_b64_tr_b16 a[172:173], v16 offset:12288
    ds_read_b64_tr_b16 a[174:175], v16 offset:13312
    s_waitcnt lgkmcnt(0)
    s_barrier
    s_waitcnt vmcnt(16)
    s_barrier
    v_add_u32 v16, 81920, v11
    ds_read_b64_tr_b16 a[176:177], v16 offset:0
    ds_read_b64_tr_b16 a[178:179], v16 offset:1024
    ds_read_b64_tr_b16 a[180:181], v16 offset:4096
    ds_read_b64_tr_b16 a[182:183], v16 offset:5120
    ds_read_b64_tr_b16 a[184:185], v16 offset:8192
    ds_read_b64_tr_b16 a[186:187], v16 offset:9216
    ds_read_b64_tr_b16 a[188:189], v16 offset:12288
    ds_read_b64_tr_b16 a[190:191], v16 offset:13312
    s_waitcnt lgkmcnt(0)
    s_barrier
    s_waitcnt vmcnt(12)
    s_barrier
    v_add_u32 v16, 98304, v11
    ds_read_b64_tr_b16 a[192:193], v16 offset:0
    ds_read_b64_tr_b16 a[194:195], v16 offset:1024
    ds_read_b64_tr_b16 a[196:197], v16 offset:4096
    ds_read_b64_tr_b16 a[198:199], v16 offset:5120
    ds_read_b64_tr_b16 a[200:201], v16 offset:8192
    ds_read_b64_tr_b16 a[202:203], v16 offset:9216
    ds_read_b64_tr_b16 a[204:205], v16 offset:12288
    ds_read_b64_tr_b16 a[206:207], v16 offset:13312
    s_waitcnt lgkmcnt(0)
    s_barrier
    s_waitcnt vmcnt(8)
    s_barrier
    v_add_u32 v16, 114688, v11
    ds_read_b64_tr_b16 a[208:209], v16 offset:0
    ds_read_b64_tr_b16 a[210:211], v16 offset:1024
    ds_read_b64_tr_b16 a[212:213], v16 offset:4096
    ds_read_b64_tr_b16 a[214:215], v16 offset:5120
    ds_read_b64_tr_b16 a[216:217], v16 offset:8192
    ds_read_b64_tr_b16 a[218:219], v16 offset:9216
    ds_read_b64_tr_b16 a[220:221], v16 offset:12288
    ds_read_b64_tr_b16 a[222:223], v16 offset:13312
    s_waitcnt lgkmcnt(0)
    s_barrier
    s_waitcnt vmcnt(4)
    s_barrier
    v_add_u32 v16, 131072, v11
    ds_read_b64_tr_b16 a[224:225], v16 offset:0
    ds_read_b64_tr_b16 a[226:227], v16 offset:1024
    ds_read_b64_tr_b16 a[228:229], v16 offset:4096
    ds_read_b64_tr_b16 a[230:231], v16 offset:5120
    ds_read_b64_tr_b16 a[232:233], v16 offset:8192
    ds_read_b64_tr_b16 a[234:235], v16 offset:9216
    ds_read_b64_tr_b16 a[236:237], v16 offset:12288
    ds_read_b64_tr_b16 a[238:239], v16 offset:13312
    s_waitcnt lgkmcnt(0)
    s_barrier
    s_waitcnt vmcnt(0)
    s_barrier
    v_add_u32 v16, 147456, v11
    ds_read_b64_tr_b16 a[240:241], v16 offset:0
    ds_read_b64_tr_b16 a[242:243], v16 offset:1024
    ds_read_b64_tr_b16 a[244:245], v16 offset:4096
    ds_read_b64_tr_b16 a[246:247], v16 offset:5120
    ds_read_b64_tr_b16 a[248:249], v16 offset:8192
    ds_read_b64_tr_b16 a[250:251], v16 offset:9216
    ds_read_b64_tr_b16 a[252:253], v16 offset:12288
    ds_read_b64_tr_b16 a[254:255], v16 offset:13312
    s_waitcnt lgkmcnt(0)
    s_barrier
    s_branch L_p1w_32
L_p1w1_34:
    v_lshrrev_b32 v8, 4, v0
    v_lshlrev_b32 v9, 2, v8
    v_and_b32 v10, 15, v0
    v_xor_b32 v10, v10, v9
    v_lshlrev_b32 v10, 4, v10
    v_add_u32 v8, 16, v8
    v_lshl_add_u32 v12, v8, 13, v10
    v_add_u32 v13, 32768, v12
    v_add_u32 v14, 65536, v12
    v_add_u32 v15, 98304, v12
    v_bfe_u32 v8, v0, 2, 2
    v_xor_b32 v9, 1, v8
    v_lshlrev_b32 v9, 6, v9
    v_lshrrev_b32 v10, 5, v0
    v_lshl_add_u32 v8, v10, 3, v8
    v_lshl_add_u32 v9, v8, 8, v9
    v_bfe_u32 v10, v0, 4, 1
    v_lshl_add_u32 v9, v10, 5, v9
    v_and_b32 v10, 3, v0
    v_lshl_add_u32 v11, v10, 3, v9
    s_add_u32 s14, s60, 0
    s_addc_u32 s15, s61, 0
    s_mov_b32 m0, 36864
    s_nop 0
    global_load_lds_dwordx4 v12, s[14:15]
    s_mov_b32 m0, 37888
    s_nop 0
    global_load_lds_dwordx4 v13, s[14:15]
    s_mov_b32 m0, 38912
    s_nop 0
    global_load_lds_dwordx4 v14, s[14:15]
    s_mov_b32 m0, 39936
    s_nop 0
    global_load_lds_dwordx4 v15, s[14:15]
    s_add_u32 s14, s60, 524288
    s_addc_u32 s15, s61, 0
    s_mov_b32 m0, 53248
    s_nop 0
    global_load_lds_dwordx4 v12, s[14:15]
    s_mov_b32 m0, 54272
    s_nop 0
    global_load_lds_dwordx4 v13, s[14:15]
    s_mov_b32 m0, 55296
    s_nop 0
    global_load_lds_dwordx4 v14, s[14:15]
    s_mov_b32 m0, 56320
    s_nop 0
    global_load_lds_dwordx4 v15, s[14:15]
    s_add_u32 s14, s60, 1048576
    s_addc_u32 s15, s61, 0
    s_mov_b32 m0, 69632
    s_nop 0
    global_load_lds_dwordx4 v12, s[14:15]
    s_mov_b32 m0, 70656
    s_nop 0
    global_load_lds_dwordx4 v13, s[14:15]
    s_mov_b32 m0, 71680
    s_nop 0
    global_load_lds_dwordx4 v14, s[14:15]
    s_mov_b32 m0, 72704
    s_nop 0
    global_load_lds_dwordx4 v15, s[14:15]
    s_add_u32 s14, s60, 1572864
    s_addc_u32 s15, s61, 0
    s_mov_b32 m0, 86016
    s_nop 0
    global_load_lds_dwordx4 v12, s[14:15]
    s_mov_b32 m0, 87040
    s_nop 0
    global_load_lds_dwordx4 v13, s[14:15]
    s_mov_b32 m0, 88064
    s_nop 0
    global_load_lds_dwordx4 v14, s[14:15]
    s_mov_b32 m0, 89088
    s_nop 0
    global_load_lds_dwordx4 v15, s[14:15]
    s_add_u32 s14, s60, 2097152
    s_addc_u32 s15, s61, 0
    s_mov_b32 m0, 102400
    s_nop 0
    global_load_lds_dwordx4 v12, s[14:15]
    s_mov_b32 m0, 103424
    s_nop 0
    global_load_lds_dwordx4 v13, s[14:15]
    s_mov_b32 m0, 104448
    s_nop 0
    global_load_lds_dwordx4 v14, s[14:15]
    s_mov_b32 m0, 105472
    s_nop 0
    global_load_lds_dwordx4 v15, s[14:15]
    s_add_u32 s14, s60, 2621440
    s_addc_u32 s15, s61, 0
    s_mov_b32 m0, 118784
    s_nop 0
    global_load_lds_dwordx4 v12, s[14:15]
    s_mov_b32 m0, 119808
    s_nop 0
    global_load_lds_dwordx4 v13, s[14:15]
    s_mov_b32 m0, 120832
    s_nop 0
    global_load_lds_dwordx4 v14, s[14:15]
    s_mov_b32 m0, 121856
    s_nop 0
    global_load_lds_dwordx4 v15, s[14:15]
    s_waitcnt vmcnt(20)
    s_barrier
    v_add_u32 v16, 32768, v11
    ds_read_b64_tr_b16 a[0:1], v16 offset:0
    ds_read_b64_tr_b16 a[2:3], v16 offset:1024
    ds_read_b64_tr_b16 a[4:5], v16 offset:4096
    ds_read_b64_tr_b16 a[6:7], v16 offset:5120
    ds_read_b64_tr_b16 a[8:9], v16 offset:8192
    ds_read_b64_tr_b16 a[10:11], v16 offset:9216
    ds_read_b64_tr_b16 a[12:13], v16 offset:12288
    ds_read_b64_tr_b16 a[14:15], v16 offset:13312
    s_waitcnt lgkmcnt(0)
    s_barrier
    s_add_u32 s14, s60, 3145728
    s_addc_u32 s15, s61, 0
    s_mov_b32 m0, 135168
    s_nop 0
    global_load_lds_dwordx4 v12, s[14:15]
    s_mov_b32 m0, 136192
    s_nop 0
    global_load_lds_dwordx4 v13, s[14:15]
    s_mov_b32 m0, 137216
    s_nop 0
    global_load_lds_dwordx4 v14, s[14:15]
    s_mov_b32 m0, 138240
    s_nop 0
    global_load_lds_dwordx4 v15, s[14:15]
    s_waitcnt vmcnt(20)
    s_barrier
    v_add_u32 v16, 49152, v11
    ds_read_b64_tr_b16 a[16:17], v16 offset:0
    ds_read_b64_tr_b16 a[18:19], v16 offset:1024
    ds_read_b64_tr_b16 a[20:21], v16 offset:4096
    ds_read_b64_tr_b16 a[22:23], v16 offset:5120
    ds_read_b64_tr_b16 a[24:25], v16 offset:8192
    ds_read_b64_tr_b16 a[26:27], v16 offset:9216
    ds_read_b64_tr_b16 a[28:29], v16 offset:12288
    ds_read_b64_tr_b16 a[30:31], v16 offset:13312
    s_waitcnt lgkmcnt(0)
    s_barrier
    s_add_u32 s14, s60, 3670016
    s_addc_u32 s15, s61, 0
    s_mov_b32 m0, 151552
    s_nop 0
    global_load_lds_dwordx4 v12, s[14:15]
    s_mov_b32 m0, 152576
    s_nop 0
    global_load_lds_dwordx4 v13, s[14:15]
    s_mov_b32 m0, 153600
    s_nop 0
    global_load_lds_dwordx4 v14, s[14:15]
    s_mov_b32 m0, 154624
    s_nop 0
    global_load_lds_dwordx4 v15, s[14:15]
    s_waitcnt vmcnt(20)
    s_barrier
    v_add_u32 v16, 65536, v11
    ds_read_b64_tr_b16 a[32:33], v16 offset:0
    ds_read_b64_tr_b16 a[34:35], v16 offset:1024
    ds_read_b64_tr_b16 a[36:37], v16 offset:4096
    ds_read_b64_tr_b16 a[38:39], v16 offset:5120
    ds_read_b64_tr_b16 a[40:41], v16 offset:8192
    ds_read_b64_tr_b16 a[42:43], v16 offset:9216
    ds_read_b64_tr_b16 a[44:45], v16 offset:12288
    ds_read_b64_tr_b16 a[46:47], v16 offset:13312
    s_waitcnt lgkmcnt(0)
    s_barrier
    s_add_u32 s14, s62, 0
    s_addc_u32 s15, s63, 0
    s_mov_b32 m0, 36864
    s_nop 0
    global_load_lds_dwordx4 v12, s[14:15]
    s_mov_b32 m0, 37888
    s_nop 0
    global_load_lds_dwordx4 v13, s[14:15]
    s_mov_b32 m0, 38912
    s_nop 0
    global_load_lds_dwordx4 v14, s[14:15]
    s_mov_b32 m0, 39936
    s_nop 0
    global_load_lds_dwordx4 v15, s[14:15]
    s_waitcnt vmcnt(20)
    s_barrier
    v_add_u32 v16, 81920, v11
    ds_read_b64_tr_b16 a[48:49], v16 offset:0
    ds_read_b64_tr_b16 a[50:51], v16 offset:1024
    ds_read_b64_tr_b16 a[52:53], v16 offset:4096
    ds_read_b64_tr_b16 a[54:55], v16 offset:5120
    ds_read_b64_tr_b16 a[56:57], v16 offset:8192
    ds_read_b64_tr_b16 a[58:59], v16 offset:9216
    ds_read_b64_tr_b16 a[60:61], v16 offset:12288
    ds_read_b64_tr_b16 a[62:63], v16 offset:13312
    s_waitcnt lgkmcnt(0)
    s_barrier
    s_add_u32 s14, s62, 524288
    s_addc_u32 s15, s63, 0
    s_mov_b32 m0, 53248
    s_nop 0
    global_load_lds_dwordx4 v12, s[14:15]
    s_mov_b32 m0, 54272
    s_nop 0
    global_load_lds_dwordx4 v13, s[14:15]
    s_mov_b32 m0, 55296
    s_nop 0
    global_load_lds_dwordx4 v14, s[14:15]
    s_mov_b32 m0, 56320
    s_nop 0
    global_load_lds_dwordx4 v15, s[14:15]
    s_waitcnt vmcnt(20)
    s_barrier
    v_add_u32 v16, 98304, v11
    ds_read_b64_tr_b16 a[64:65], v16 offset:0
    ds_read_b64_tr_b16 a[66:67], v16 offset:1024
    ds_read_b64_tr_b16 a[68:69], v16 offset:4096
    ds_read_b64_tr_b16 a[70:71], v16 offset:5120
    ds_read_b64_tr_b16 a[72:73], v16 offset:8192
    ds_read_b64_tr_b16 a[74:75], v16 offset:9216
    ds_read_b64_tr_b16 a[76:77], v16 offset:12288
    ds_read_b64_tr_b16 a[78:79], v16 offset:13312
    s_waitcnt lgkmcnt(0)
    s_barrier
    s_add_u32 s14, s62, 1048576
    s_addc_u32 s15, s63, 0
    s_mov_b32 m0, 69632
    s_nop 0
    global_load_lds_dwordx4 v12, s[14:15]
    s_mov_b32 m0, 70656
    s_nop 0
    global_load_lds_dwordx4 v13, s[14:15]
    s_mov_b32 m0, 71680
    s_nop 0
    global_load_lds_dwordx4 v14, s[14:15]
    s_mov_b32 m0, 72704
    s_nop 0
    global_load_lds_dwordx4 v15, s[14:15]
    s_waitcnt vmcnt(20)
    s_barrier
    v_add_u32 v16, 114688, v11
    ds_read_b64_tr_b16 a[80:81], v16 offset:0
    ds_read_b64_tr_b16 a[82:83], v16 offset:1024
    ds_read_b64_tr_b16 a[84:85], v16 offset:4096
    ds_read_b64_tr_b16 a[86:87], v16 offset:5120
    ds_read_b64_tr_b16 a[88:89], v16 offset:8192
    ds_read_b64_tr_b16 a[90:91], v16 offset:9216
    ds_read_b64_tr_b16 a[92:93], v16 offset:12288
    ds_read_b64_tr_b16 a[94:95], v16 offset:13312
    s_waitcnt lgkmcnt(0)
    s_barrier
    s_add_u32 s14, s62, 1572864
    s_addc_u32 s15, s63, 0
    s_mov_b32 m0, 86016
    s_nop 0
    global_load_lds_dwordx4 v12, s[14:15]
    s_mov_b32 m0, 87040
    s_nop 0
    global_load_lds_dwordx4 v13, s[14:15]
    s_mov_b32 m0, 88064
    s_nop 0
    global_load_lds_dwordx4 v14, s[14:15]
    s_mov_b32 m0, 89088
    s_nop 0
    global_load_lds_dwordx4 v15, s[14:15]
    s_waitcnt vmcnt(20)
    s_barrier
    v_add_u32 v16, 131072, v11
    ds_read_b64_tr_b16 a[96:97], v16 offset:0
    ds_read_b64_tr_b16 a[98:99], v16 offset:1024
    ds_read_b64_tr_b16 a[100:101], v16 offset:4096
    ds_read_b64_tr_b16 a[102:103], v16 offset:5120
    ds_read_b64_tr_b16 a[104:105], v16 offset:8192
    ds_read_b64_tr_b16 a[106:107], v16 offset:9216
    ds_read_b64_tr_b16 a[108:109], v16 offset:12288
    ds_read_b64_tr_b16 a[110:111], v16 offset:13312
    s_waitcnt lgkmcnt(0)
    s_barrier
    s_add_u32 s14, s62, 2097152
    s_addc_u32 s15, s63, 0
    s_mov_b32 m0, 102400
    s_nop 0
    global_load_lds_dwordx4 v12, s[14:15]
    s_mov_b32 m0, 103424
    s_nop 0
    global_load_lds_dwordx4 v13, s[14:15]
    s_mov_b32 m0, 104448
    s_nop 0
    global_load_lds_dwordx4 v14, s[14:15]
    s_mov_b32 m0, 105472
    s_nop 0
    global_load_lds_dwordx4 v15, s[14:15]
    s_waitcnt vmcnt(20)
    s_barrier
    v_add_u32 v16, 147456, v11
    ds_read_b64_tr_b16 a[112:113], v16 offset:0
    ds_read_b64_tr_b16 a[114:115], v16 offset:1024
    ds_read_b64_tr_b16 a[116:117], v16 offset:4096
    ds_read_b64_tr_b16 a[118:119], v16 offset:5120
    ds_read_b64_tr_b16 a[120:121], v16 offset:8192
    ds_read_b64_tr_b16 a[122:123], v16 offset:9216
    ds_read_b64_tr_b16 a[124:125], v16 offset:12288
    ds_read_b64_tr_b16 a[126:127], v16 offset:13312
    s_waitcnt lgkmcnt(0)
    s_barrier
    s_add_u32 s14, s62, 2621440
    s_addc_u32 s15, s63, 0
    s_mov_b32 m0, 118784
    s_nop 0
    global_load_lds_dwordx4 v12, s[14:15]
    s_mov_b32 m0, 119808
    s_nop 0
    global_load_lds_dwordx4 v13, s[14:15]
    s_mov_b32 m0, 120832
    s_nop 0
    global_load_lds_dwordx4 v14, s[14:15]
    s_mov_b32 m0, 121856
    s_nop 0
    global_load_lds_dwordx4 v15, s[14:15]
    s_waitcnt vmcnt(20)
    s_barrier
    v_add_u32 v16, 32768, v11
    ds_read_b64_tr_b16 a[128:129], v16 offset:0
    ds_read_b64_tr_b16 a[130:131], v16 offset:1024
    ds_read_b64_tr_b16 a[132:133], v16 offset:4096
    ds_read_b64_tr_b16 a[134:135], v16 offset:5120
    ds_read_b64_tr_b16 a[136:137], v16 offset:8192
    ds_read_b64_tr_b16 a[138:139], v16 offset:9216
    ds_read_b64_tr_b16 a[140:141], v16 offset:12288
    ds_read_b64_tr_b16 a[142:143], v16 offset:13312
    s_waitcnt lgkmcnt(0)
    s_barrier
    s_add_u32 s14, s62, 3145728
    s_addc_u32 s15, s63, 0
    s_mov_b32 m0, 135168
    s_nop 0
    global_load_lds_dwordx4 v12, s[14:15]
    s_mov_b32 m0, 136192
    s_nop 0
    global_load_lds_dwordx4 v13, s[14:15]
    s_mov_b32 m0, 137216
    s_nop 0
    global_load_lds_dwordx4 v14, s[14:15]
    s_mov_b32 m0, 138240
    s_nop 0
    global_load_lds_dwordx4 v15, s[14:15]
    s_waitcnt vmcnt(20)
    s_barrier
    v_add_u32 v16, 49152, v11
    ds_read_b64_tr_b16 a[144:145], v16 offset:0
    ds_read_b64_tr_b16 a[146:147], v16 offset:1024
    ds_read_b64_tr_b16 a[148:149], v16 offset:4096
    ds_read_b64_tr_b16 a[150:151], v16 offset:5120
    ds_read_b64_tr_b16 a[152:153], v16 offset:8192
    ds_read_b64_tr_b16 a[154:155], v16 offset:9216
    ds_read_b64_tr_b16 a[156:157], v16 offset:12288
    ds_read_b64_tr_b16 a[158:159], v16 offset:13312
    s_waitcnt lgkmcnt(0)
    s_barrier
    s_add_u32 s14, s62, 3670016
    s_addc_u32 s15, s63, 0
    s_mov_b32 m0, 151552
    s_nop 0
    global_load_lds_dwordx4 v12, s[14:15]
    s_mov_b32 m0, 152576
    s_nop 0
    global_load_lds_dwordx4 v13, s[14:15]
    s_mov_b32 m0, 153600
    s_nop 0
    global_load_lds_dwordx4 v14, s[14:15]
    s_mov_b32 m0, 154624
    s_nop 0
    global_load_lds_dwordx4 v15, s[14:15]
    s_waitcnt vmcnt(20)
    s_barrier
    v_add_u32 v16, 65536, v11
    ds_read_b64_tr_b16 a[160:161], v16 offset:0
    ds_read_b64_tr_b16 a[162:163], v16 offset:1024
    ds_read_b64_tr_b16 a[164:165], v16 offset:4096
    ds_read_b64_tr_b16 a[166:167], v16 offset:5120
    ds_read_b64_tr_b16 a[168:169], v16 offset:8192
    ds_read_b64_tr_b16 a[170:171], v16 offset:9216
    ds_read_b64_tr_b16 a[172:173], v16 offset:12288
    ds_read_b64_tr_b16 a[174:175], v16 offset:13312
    s_waitcnt lgkmcnt(0)
    s_barrier
    s_waitcnt vmcnt(16)
    s_barrier
    v_add_u32 v16, 81920, v11
    ds_read_b64_tr_b16 a[176:177], v16 offset:0
    ds_read_b64_tr_b16 a[178:179], v16 offset:1024
    ds_read_b64_tr_b16 a[180:181], v16 offset:4096
    ds_read_b64_tr_b16 a[182:183], v16 offset:5120
    ds_read_b64_tr_b16 a[184:185], v16 offset:8192
    ds_read_b64_tr_b16 a[186:187], v16 offset:9216
    ds_read_b64_tr_b16 a[188:189], v16 offset:12288
    ds_read_b64_tr_b16 a[190:191], v16 offset:13312
    s_waitcnt lgkmcnt(0)
    s_barrier
    s_waitcnt vmcnt(12)
    s_barrier
    v_add_u32 v16, 98304, v11
    ds_read_b64_tr_b16 a[192:193], v16 offset:0
    ds_read_b64_tr_b16 a[194:195], v16 offset:1024
    ds_read_b64_tr_b16 a[196:197], v16 offset:4096
    ds_read_b64_tr_b16 a[198:199], v16 offset:5120
    ds_read_b64_tr_b16 a[200:201], v16 offset:8192
    ds_read_b64_tr_b16 a[202:203], v16 offset:9216
    ds_read_b64_tr_b16 a[204:205], v16 offset:12288
    ds_read_b64_tr_b16 a[206:207], v16 offset:13312
    s_waitcnt lgkmcnt(0)
    s_barrier
    s_waitcnt vmcnt(8)
    s_barrier
    v_add_u32 v16, 114688, v11
    ds_read_b64_tr_b16 a[208:209], v16 offset:0
    ds_read_b64_tr_b16 a[210:211], v16 offset:1024
    ds_read_b64_tr_b16 a[212:213], v16 offset:4096
    ds_read_b64_tr_b16 a[214:215], v16 offset:5120
    ds_read_b64_tr_b16 a[216:217], v16 offset:8192
    ds_read_b64_tr_b16 a[218:219], v16 offset:9216
    ds_read_b64_tr_b16 a[220:221], v16 offset:12288
    ds_read_b64_tr_b16 a[222:223], v16 offset:13312
    s_waitcnt lgkmcnt(0)
    s_barrier
    s_waitcnt vmcnt(4)
    s_barrier
    v_add_u32 v16, 131072, v11
    ds_read_b64_tr_b16 a[224:225], v16 offset:0
    ds_read_b64_tr_b16 a[226:227], v16 offset:1024
    ds_read_b64_tr_b16 a[228:229], v16 offset:4096
    ds_read_b64_tr_b16 a[230:231], v16 offset:5120
    ds_read_b64_tr_b16 a[232:233], v16 offset:8192
    ds_read_b64_tr_b16 a[234:235], v16 offset:9216
    ds_read_b64_tr_b16 a[236:237], v16 offset:12288
    ds_read_b64_tr_b16 a[238:239], v16 offset:13312
    s_waitcnt lgkmcnt(0)
    s_barrier
    s_waitcnt vmcnt(0)
    s_barrier
    v_add_u32 v16, 147456, v11
    ds_read_b64_tr_b16 a[240:241], v16 offset:0
    ds_read_b64_tr_b16 a[242:243], v16 offset:1024
    ds_read_b64_tr_b16 a[244:245], v16 offset:4096
    ds_read_b64_tr_b16 a[246:247], v16 offset:5120
    ds_read_b64_tr_b16 a[248:249], v16 offset:8192
    ds_read_b64_tr_b16 a[250:251], v16 offset:9216
    ds_read_b64_tr_b16 a[252:253], v16 offset:12288
    ds_read_b64_tr_b16 a[254:255], v16 offset:13312
    s_waitcnt lgkmcnt(0)
    s_barrier
    s_branch L_p1w_32
L_p1w2_35:
    v_lshrrev_b32 v8, 4, v0
    v_lshlrev_b32 v9, 2, v8
    v_and_b32 v10, 15, v0
    v_xor_b32 v10, v10, v9
    v_lshlrev_b32 v10, 4, v10
    v_add_u32 v8, 32, v8
    v_lshl_add_u32 v12, v8, 13, v10
    v_add_u32 v13, 32768, v12
    v_add_u32 v14, 65536, v12
    v_add_u32 v15, 98304, v12
    v_bfe_u32 v8, v0, 2, 2
    v_xor_b32 v9, 2, v8
    v_lshlrev_b32 v9, 6, v9
    v_lshrrev_b32 v10, 5, v0
    v_lshl_add_u32 v8, v10, 3, v8
    v_lshl_add_u32 v9, v8, 8, v9
    v_bfe_u32 v10, v0, 4, 1
    v_lshl_add_u32 v9, v10, 5, v9
    v_and_b32 v10, 3, v0
    v_lshl_add_u32 v11, v10, 3, v9
    s_add_u32 s14, s60, 0
    s_addc_u32 s15, s61, 0
    s_mov_b32 m0, 40960
    s_nop 0
    global_load_lds_dwordx4 v12, s[14:15]
    s_mov_b32 m0, 41984
    s_nop 0
    global_load_lds_dwordx4 v13, s[14:15]
    s_mov_b32 m0, 43008
    s_nop 0
    global_load_lds_dwordx4 v14, s[14:15]
    s_mov_b32 m0, 44032
    s_nop 0
    global_load_lds_dwordx4 v15, s[14:15]
    s_add_u32 s14, s60, 524288
    s_addc_u32 s15, s61, 0
    s_mov_b32 m0, 57344
    s_nop 0
    global_load_lds_dwordx4 v12, s[14:15]
    s_mov_b32 m0, 58368
    s_nop 0
    global_load_lds_dwordx4 v13, s[14:15]
    s_mov_b32 m0, 59392
    s_nop 0
    global_load_lds_dwordx4 v14, s[14:15]
    s_mov_b32 m0, 60416
    s_nop 0
    global_load_lds_dwordx4 v15, s[14:15]
    s_add_u32 s14, s60, 1048576
    s_addc_u32 s15, s61, 0
    s_mov_b32 m0, 73728
    s_nop 0
    global_load_lds_dwordx4 v12, s[14:15]
    s_mov_b32 m0, 74752
    s_nop 0
    global_load_lds_dwordx4 v13, s[14:15]
    s_mov_b32 m0, 75776
    s_nop 0
    global_load_lds_dwordx4 v14, s[14:15]
    s_mov_b32 m0, 76800
    s_nop 0
    global_load_lds_dwordx4 v15, s[14:15]
    s_add_u32 s14, s60, 1572864
    s_addc_u32 s15, s61, 0
    s_mov_b32 m0, 90112
    s_nop 0
    global_load_lds_dwordx4 v12, s[14:15]
    s_mov_b32 m0, 91136
    s_nop 0
    global_load_lds_dwordx4 v13, s[14:15]
    s_mov_b32 m0, 92160
    s_nop 0
    global_load_lds_dwordx4 v14, s[14:15]
    s_mov_b32 m0, 93184
    s_nop 0
    global_load_lds_dwordx4 v15, s[14:15]
    s_add_u32 s14, s60, 2097152
    s_addc_u32 s15, s61, 0
    s_mov_b32 m0, 106496
    s_nop 0
    global_load_lds_dwordx4 v12, s[14:15]
    s_mov_b32 m0, 107520
    s_nop 0
    global_load_lds_dwordx4 v13, s[14:15]
    s_mov_b32 m0, 108544
    s_nop 0
    global_load_lds_dwordx4 v14, s[14:15]
    s_mov_b32 m0, 109568
    s_nop 0
    global_load_lds_dwordx4 v15, s[14:15]
    s_add_u32 s14, s60, 2621440
    s_addc_u32 s15, s61, 0
    s_mov_b32 m0, 122880
    s_nop 0
    global_load_lds_dwordx4 v12, s[14:15]
    s_mov_b32 m0, 123904
    s_nop 0
    global_load_lds_dwordx4 v13, s[14:15]
    s_mov_b32 m0, 124928
    s_nop 0
    global_load_lds_dwordx4 v14, s[14:15]
    s_mov_b32 m0, 125952
    s_nop 0
    global_load_lds_dwordx4 v15, s[14:15]
    s_waitcnt vmcnt(20)
    s_barrier
    v_add_u32 v16, 32768, v11
    ds_read_b64_tr_b16 a[0:1], v16 offset:0
    ds_read_b64_tr_b16 a[2:3], v16 offset:1024
    ds_read_b64_tr_b16 a[4:5], v16 offset:4096
    ds_read_b64_tr_b16 a[6:7], v16 offset:5120
    ds_read_b64_tr_b16 a[8:9], v16 offset:8192
    ds_read_b64_tr_b16 a[10:11], v16 offset:9216
    ds_read_b64_tr_b16 a[12:13], v16 offset:12288
    ds_read_b64_tr_b16 a[14:15], v16 offset:13312
    s_waitcnt lgkmcnt(0)
    s_barrier
    s_add_u32 s14, s60, 3145728
    s_addc_u32 s15, s61, 0
    s_mov_b32 m0, 139264
    s_nop 0
    global_load_lds_dwordx4 v12, s[14:15]
    s_mov_b32 m0, 140288
    s_nop 0
    global_load_lds_dwordx4 v13, s[14:15]
    s_mov_b32 m0, 141312
    s_nop 0
    global_load_lds_dwordx4 v14, s[14:15]
    s_mov_b32 m0, 142336
    s_nop 0
    global_load_lds_dwordx4 v15, s[14:15]
    s_waitcnt vmcnt(20)
    s_barrier
    v_add_u32 v16, 49152, v11
    ds_read_b64_tr_b16 a[16:17], v16 offset:0
    ds_read_b64_tr_b16 a[18:19], v16 offset:1024
    ds_read_b64_tr_b16 a[20:21], v16 offset:4096
    ds_read_b64_tr_b16 a[22:23], v16 offset:5120
    ds_read_b64_tr_b16 a[24:25], v16 offset:8192
    ds_read_b64_tr_b16 a[26:27], v16 offset:9216
    ds_read_b64_tr_b16 a[28:29], v16 offset:12288
    ds_read_b64_tr_b16 a[30:31], v16 offset:13312
    s_waitcnt lgkmcnt(0)
    s_barrier
    s_add_u32 s14, s60, 3670016
    s_addc_u32 s15, s61, 0
    s_mov_b32 m0, 155648
    s_nop 0
    global_load_lds_dwordx4 v12, s[14:15]
    s_mov_b32 m0, 156672
    s_nop 0
    global_load_lds_dwordx4 v13, s[14:15]
    s_mov_b32 m0, 157696
    s_nop 0
    global_load_lds_dwordx4 v14, s[14:15]
    s_mov_b32 m0, 158720
    s_nop 0
    global_load_lds_dwordx4 v15, s[14:15]
    s_waitcnt vmcnt(20)
    s_barrier
    v_add_u32 v16, 65536, v11
    ds_read_b64_tr_b16 a[32:33], v16 offset:0
    ds_read_b64_tr_b16 a[34:35], v16 offset:1024
    ds_read_b64_tr_b16 a[36:37], v16 offset:4096
    ds_read_b64_tr_b16 a[38:39], v16 offset:5120
    ds_read_b64_tr_b16 a[40:41], v16 offset:8192
    ds_read_b64_tr_b16 a[42:43], v16 offset:9216
    ds_read_b64_tr_b16 a[44:45], v16 offset:12288
    ds_read_b64_tr_b16 a[46:47], v16 offset:13312
    s_waitcnt lgkmcnt(0)
    s_barrier
    s_add_u32 s14, s62, 0
    s_addc_u32 s15, s63, 0
    s_mov_b32 m0, 40960
    s_nop 0
    global_load_lds_dwordx4 v12, s[14:15]
    s_mov_b32 m0, 41984
    s_nop 0
    global_load_lds_dwordx4 v13, s[14:15]
    s_mov_b32 m0, 43008
    s_nop 0
    global_load_lds_dwordx4 v14, s[14:15]
    s_mov_b32 m0, 44032
    s_nop 0
    global_load_lds_dwordx4 v15, s[14:15]
    s_waitcnt vmcnt(20)
    s_barrier
    v_add_u32 v16, 81920, v11
    ds_read_b64_tr_b16 a[48:49], v16 offset:0
    ds_read_b64_tr_b16 a[50:51], v16 offset:1024
    ds_read_b64_tr_b16 a[52:53], v16 offset:4096
    ds_read_b64_tr_b16 a[54:55], v16 offset:5120
    ds_read_b64_tr_b16 a[56:57], v16 offset:8192
    ds_read_b64_tr_b16 a[58:59], v16 offset:9216
    ds_read_b64_tr_b16 a[60:61], v16 offset:12288
    ds_read_b64_tr_b16 a[62:63], v16 offset:13312
    s_waitcnt lgkmcnt(0)
    s_barrier
    s_add_u32 s14, s62, 524288
    s_addc_u32 s15, s63, 0
    s_mov_b32 m0, 57344
    s_nop 0
    global_load_lds_dwordx4 v12, s[14:15]
    s_mov_b32 m0, 58368
    s_nop 0
    global_load_lds_dwordx4 v13, s[14:15]
    s_mov_b32 m0, 59392
    s_nop 0
    global_load_lds_dwordx4 v14, s[14:15]
    s_mov_b32 m0, 60416
    s_nop 0
    global_load_lds_dwordx4 v15, s[14:15]
    s_waitcnt vmcnt(20)
    s_barrier
    v_add_u32 v16, 98304, v11
    ds_read_b64_tr_b16 a[64:65], v16 offset:0
    ds_read_b64_tr_b16 a[66:67], v16 offset:1024
    ds_read_b64_tr_b16 a[68:69], v16 offset:4096
    ds_read_b64_tr_b16 a[70:71], v16 offset:5120
    ds_read_b64_tr_b16 a[72:73], v16 offset:8192
    ds_read_b64_tr_b16 a[74:75], v16 offset:9216
    ds_read_b64_tr_b16 a[76:77], v16 offset:12288
    ds_read_b64_tr_b16 a[78:79], v16 offset:13312
    s_waitcnt lgkmcnt(0)
    s_barrier
    s_add_u32 s14, s62, 1048576
    s_addc_u32 s15, s63, 0
    s_mov_b32 m0, 73728
    s_nop 0
    global_load_lds_dwordx4 v12, s[14:15]
    s_mov_b32 m0, 74752
    s_nop 0
    global_load_lds_dwordx4 v13, s[14:15]
    s_mov_b32 m0, 75776
    s_nop 0
    global_load_lds_dwordx4 v14, s[14:15]
    s_mov_b32 m0, 76800
    s_nop 0
    global_load_lds_dwordx4 v15, s[14:15]
    s_waitcnt vmcnt(20)
    s_barrier
    v_add_u32 v16, 114688, v11
    ds_read_b64_tr_b16 a[80:81], v16 offset:0
    ds_read_b64_tr_b16 a[82:83], v16 offset:1024
    ds_read_b64_tr_b16 a[84:85], v16 offset:4096
    ds_read_b64_tr_b16 a[86:87], v16 offset:5120
    ds_read_b64_tr_b16 a[88:89], v16 offset:8192
    ds_read_b64_tr_b16 a[90:91], v16 offset:9216
    ds_read_b64_tr_b16 a[92:93], v16 offset:12288
    ds_read_b64_tr_b16 a[94:95], v16 offset:13312
    s_waitcnt lgkmcnt(0)
    s_barrier
    s_add_u32 s14, s62, 1572864
    s_addc_u32 s15, s63, 0
    s_mov_b32 m0, 90112
    s_nop 0
    global_load_lds_dwordx4 v12, s[14:15]
    s_mov_b32 m0, 91136
    s_nop 0
    global_load_lds_dwordx4 v13, s[14:15]
    s_mov_b32 m0, 92160
    s_nop 0
    global_load_lds_dwordx4 v14, s[14:15]
    s_mov_b32 m0, 93184
    s_nop 0
    global_load_lds_dwordx4 v15, s[14:15]
    s_waitcnt vmcnt(20)
    s_barrier
    v_add_u32 v16, 131072, v11
    ds_read_b64_tr_b16 a[96:97], v16 offset:0
    ds_read_b64_tr_b16 a[98:99], v16 offset:1024
    ds_read_b64_tr_b16 a[100:101], v16 offset:4096
    ds_read_b64_tr_b16 a[102:103], v16 offset:5120
    ds_read_b64_tr_b16 a[104:105], v16 offset:8192
    ds_read_b64_tr_b16 a[106:107], v16 offset:9216
    ds_read_b64_tr_b16 a[108:109], v16 offset:12288
    ds_read_b64_tr_b16 a[110:111], v16 offset:13312
    s_waitcnt lgkmcnt(0)
    s_barrier
    s_add_u32 s14, s62, 2097152
    s_addc_u32 s15, s63, 0
    s_mov_b32 m0, 106496
    s_nop 0
    global_load_lds_dwordx4 v12, s[14:15]
    s_mov_b32 m0, 107520
    s_nop 0
    global_load_lds_dwordx4 v13, s[14:15]
    s_mov_b32 m0, 108544
    s_nop 0
    global_load_lds_dwordx4 v14, s[14:15]
    s_mov_b32 m0, 109568
    s_nop 0
    global_load_lds_dwordx4 v15, s[14:15]
    s_waitcnt vmcnt(20)
    s_barrier
    v_add_u32 v16, 147456, v11
    ds_read_b64_tr_b16 a[112:113], v16 offset:0
    ds_read_b64_tr_b16 a[114:115], v16 offset:1024
    ds_read_b64_tr_b16 a[116:117], v16 offset:4096
    ds_read_b64_tr_b16 a[118:119], v16 offset:5120
    ds_read_b64_tr_b16 a[120:121], v16 offset:8192
    ds_read_b64_tr_b16 a[122:123], v16 offset:9216
    ds_read_b64_tr_b16 a[124:125], v16 offset:12288
    ds_read_b64_tr_b16 a[126:127], v16 offset:13312
    s_waitcnt lgkmcnt(0)
    s_barrier
    s_add_u32 s14, s62, 2621440
    s_addc_u32 s15, s63, 0
    s_mov_b32 m0, 122880
    s_nop 0
    global_load_lds_dwordx4 v12, s[14:15]
    s_mov_b32 m0, 123904
    s_nop 0
    global_load_lds_dwordx4 v13, s[14:15]
    s_mov_b32 m0, 124928
    s_nop 0
    global_load_lds_dwordx4 v14, s[14:15]
    s_mov_b32 m0, 125952
    s_nop 0
    global_load_lds_dwordx4 v15, s[14:15]
    s_waitcnt vmcnt(20)
    s_barrier
    v_add_u32 v16, 32768, v11
    ds_read_b64_tr_b16 a[128:129], v16 offset:0
    ds_read_b64_tr_b16 a[130:131], v16 offset:1024
    ds_read_b64_tr_b16 a[132:133], v16 offset:4096
    ds_read_b64_tr_b16 a[134:135], v16 offset:5120
    ds_read_b64_tr_b16 a[136:137], v16 offset:8192
    ds_read_b64_tr_b16 a[138:139], v16 offset:9216
    ds_read_b64_tr_b16 a[140:141], v16 offset:12288
    ds_read_b64_tr_b16 a[142:143], v16 offset:13312
    s_waitcnt lgkmcnt(0)
    s_barrier
    s_add_u32 s14, s62, 3145728
    s_addc_u32 s15, s63, 0
    s_mov_b32 m0, 139264
    s_nop 0
    global_load_lds_dwordx4 v12, s[14:15]
    s_mov_b32 m0, 140288
    s_nop 0
    global_load_lds_dwordx4 v13, s[14:15]
    s_mov_b32 m0, 141312
    s_nop 0
    global_load_lds_dwordx4 v14, s[14:15]
    s_mov_b32 m0, 142336
    s_nop 0
    global_load_lds_dwordx4 v15, s[14:15]
    s_waitcnt vmcnt(20)
    s_barrier
    v_add_u32 v16, 49152, v11
    ds_read_b64_tr_b16 a[144:145], v16 offset:0
    ds_read_b64_tr_b16 a[146:147], v16 offset:1024
    ds_read_b64_tr_b16 a[148:149], v16 offset:4096
    ds_read_b64_tr_b16 a[150:151], v16 offset:5120
    ds_read_b64_tr_b16 a[152:153], v16 offset:8192
    ds_read_b64_tr_b16 a[154:155], v16 offset:9216
    ds_read_b64_tr_b16 a[156:157], v16 offset:12288
    ds_read_b64_tr_b16 a[158:159], v16 offset:13312
    s_waitcnt lgkmcnt(0)
    s_barrier
    s_add_u32 s14, s62, 3670016
    s_addc_u32 s15, s63, 0
    s_mov_b32 m0, 155648
    s_nop 0
    global_load_lds_dwordx4 v12, s[14:15]
    s_mov_b32 m0, 156672
    s_nop 0
    global_load_lds_dwordx4 v13, s[14:15]
    s_mov_b32 m0, 157696
    s_nop 0
    global_load_lds_dwordx4 v14, s[14:15]
    s_mov_b32 m0, 158720
    s_nop 0
    global_load_lds_dwordx4 v15, s[14:15]
    s_waitcnt vmcnt(20)
    s_barrier
    v_add_u32 v16, 65536, v11
    ds_read_b64_tr_b16 a[160:161], v16 offset:0
    ds_read_b64_tr_b16 a[162:163], v16 offset:1024
    ds_read_b64_tr_b16 a[164:165], v16 offset:4096
    ds_read_b64_tr_b16 a[166:167], v16 offset:5120
    ds_read_b64_tr_b16 a[168:169], v16 offset:8192
    ds_read_b64_tr_b16 a[170:171], v16 offset:9216
    ds_read_b64_tr_b16 a[172:173], v16 offset:12288
    ds_read_b64_tr_b16 a[174:175], v16 offset:13312
    s_waitcnt lgkmcnt(0)
    s_barrier
    s_waitcnt vmcnt(16)
    s_barrier
    v_add_u32 v16, 81920, v11
    ds_read_b64_tr_b16 a[176:177], v16 offset:0
    ds_read_b64_tr_b16 a[178:179], v16 offset:1024
    ds_read_b64_tr_b16 a[180:181], v16 offset:4096
    ds_read_b64_tr_b16 a[182:183], v16 offset:5120
    ds_read_b64_tr_b16 a[184:185], v16 offset:8192
    ds_read_b64_tr_b16 a[186:187], v16 offset:9216
    ds_read_b64_tr_b16 a[188:189], v16 offset:12288
    ds_read_b64_tr_b16 a[190:191], v16 offset:13312
    s_waitcnt lgkmcnt(0)
    s_barrier
    s_waitcnt vmcnt(12)
    s_barrier
    v_add_u32 v16, 98304, v11
    ds_read_b64_tr_b16 a[192:193], v16 offset:0
    ds_read_b64_tr_b16 a[194:195], v16 offset:1024
    ds_read_b64_tr_b16 a[196:197], v16 offset:4096
    ds_read_b64_tr_b16 a[198:199], v16 offset:5120
    ds_read_b64_tr_b16 a[200:201], v16 offset:8192
    ds_read_b64_tr_b16 a[202:203], v16 offset:9216
    ds_read_b64_tr_b16 a[204:205], v16 offset:12288
    ds_read_b64_tr_b16 a[206:207], v16 offset:13312
    s_waitcnt lgkmcnt(0)
    s_barrier
    s_waitcnt vmcnt(8)
    s_barrier
    v_add_u32 v16, 114688, v11
    ds_read_b64_tr_b16 a[208:209], v16 offset:0
    ds_read_b64_tr_b16 a[210:211], v16 offset:1024
    ds_read_b64_tr_b16 a[212:213], v16 offset:4096
    ds_read_b64_tr_b16 a[214:215], v16 offset:5120
    ds_read_b64_tr_b16 a[216:217], v16 offset:8192
    ds_read_b64_tr_b16 a[218:219], v16 offset:9216
    ds_read_b64_tr_b16 a[220:221], v16 offset:12288
    ds_read_b64_tr_b16 a[222:223], v16 offset:13312
    s_waitcnt lgkmcnt(0)
    s_barrier
    s_waitcnt vmcnt(4)
    s_barrier
    v_add_u32 v16, 131072, v11
    ds_read_b64_tr_b16 a[224:225], v16 offset:0
    ds_read_b64_tr_b16 a[226:227], v16 offset:1024
    ds_read_b64_tr_b16 a[228:229], v16 offset:4096
    ds_read_b64_tr_b16 a[230:231], v16 offset:5120
    ds_read_b64_tr_b16 a[232:233], v16 offset:8192
    ds_read_b64_tr_b16 a[234:235], v16 offset:9216
    ds_read_b64_tr_b16 a[236:237], v16 offset:12288
    ds_read_b64_tr_b16 a[238:239], v16 offset:13312
    s_waitcnt lgkmcnt(0)
    s_barrier
    s_waitcnt vmcnt(0)
    s_barrier
    v_add_u32 v16, 147456, v11
    ds_read_b64_tr_b16 a[240:241], v16 offset:0
    ds_read_b64_tr_b16 a[242:243], v16 offset:1024
    ds_read_b64_tr_b16 a[244:245], v16 offset:4096
    ds_read_b64_tr_b16 a[246:247], v16 offset:5120
    ds_read_b64_tr_b16 a[248:249], v16 offset:8192
    ds_read_b64_tr_b16 a[250:251], v16 offset:9216
    ds_read_b64_tr_b16 a[252:253], v16 offset:12288
    ds_read_b64_tr_b16 a[254:255], v16 offset:13312
    s_waitcnt lgkmcnt(0)
    s_barrier
    s_branch L_p1w_32
L_p1w3_36:
    v_lshrrev_b32 v8, 4, v0
    v_lshlrev_b32 v9, 2, v8
    v_and_b32 v10, 15, v0
    v_xor_b32 v10, v10, v9
    v_lshlrev_b32 v10, 4, v10
    v_add_u32 v8, 48, v8
    v_lshl_add_u32 v12, v8, 13, v10
    v_add_u32 v13, 32768, v12
    v_add_u32 v14, 65536, v12
    v_add_u32 v15, 98304, v12
    v_bfe_u32 v8, v0, 2, 2
    v_xor_b32 v9, 3, v8
    v_lshlrev_b32 v9, 6, v9
    v_lshrrev_b32 v10, 5, v0
    v_lshl_add_u32 v8, v10, 3, v8
    v_lshl_add_u32 v9, v8, 8, v9
    v_bfe_u32 v10, v0, 4, 1
    v_lshl_add_u32 v9, v10, 5, v9
    v_and_b32 v10, 3, v0
    v_lshl_add_u32 v11, v10, 3, v9
    s_add_u32 s14, s60, 0
    s_addc_u32 s15, s61, 0
    s_mov_b32 m0, 45056
    s_nop 0
    global_load_lds_dwordx4 v12, s[14:15]
    s_mov_b32 m0, 46080
    s_nop 0
    global_load_lds_dwordx4 v13, s[14:15]
    s_mov_b32 m0, 47104
    s_nop 0
    global_load_lds_dwordx4 v14, s[14:15]
    s_mov_b32 m0, 48128
    s_nop 0
    global_load_lds_dwordx4 v15, s[14:15]
    s_add_u32 s14, s60, 524288
    s_addc_u32 s15, s61, 0
    s_mov_b32 m0, 61440
    s_nop 0
    global_load_lds_dwordx4 v12, s[14:15]
    s_mov_b32 m0, 62464
    s_nop 0
    global_load_lds_dwordx4 v13, s[14:15]
    s_mov_b32 m0, 63488
    s_nop 0
    global_load_lds_dwordx4 v14, s[14:15]
    s_mov_b32 m0, 64512
    s_nop 0
    global_load_lds_dwordx4 v15, s[14:15]
    s_add_u32 s14, s60, 1048576
    s_addc_u32 s15, s61, 0
    s_mov_b32 m0, 77824
    s_nop 0
    global_load_lds_dwordx4 v12, s[14:15]
    s_mov_b32 m0, 78848
    s_nop 0
    global_load_lds_dwordx4 v13, s[14:15]
    s_mov_b32 m0, 79872
    s_nop 0
    global_load_lds_dwordx4 v14, s[14:15]
    s_mov_b32 m0, 80896
    s_nop 0
    global_load_lds_dwordx4 v15, s[14:15]
    s_add_u32 s14, s60, 1572864
    s_addc_u32 s15, s61, 0
    s_mov_b32 m0, 94208
    s_nop 0
    global_load_lds_dwordx4 v12, s[14:15]
    s_mov_b32 m0, 95232
    s_nop 0
    global_load_lds_dwordx4 v13, s[14:15]
    s_mov_b32 m0, 96256
    s_nop 0
    global_load_lds_dwordx4 v14, s[14:15]
    s_mov_b32 m0, 97280
    s_nop 0
    global_load_lds_dwordx4 v15, s[14:15]
    s_add_u32 s14, s60, 2097152
    s_addc_u32 s15, s61, 0
    s_mov_b32 m0, 110592
    s_nop 0
    global_load_lds_dwordx4 v12, s[14:15]
    s_mov_b32 m0, 111616
    s_nop 0
    global_load_lds_dwordx4 v13, s[14:15]
    s_mov_b32 m0, 112640
    s_nop 0
    global_load_lds_dwordx4 v14, s[14:15]
    s_mov_b32 m0, 113664
    s_nop 0
    global_load_lds_dwordx4 v15, s[14:15]
    s_add_u32 s14, s60, 2621440
    s_addc_u32 s15, s61, 0
    s_mov_b32 m0, 126976
    s_nop 0
    global_load_lds_dwordx4 v12, s[14:15]
    s_mov_b32 m0, 128000
    s_nop 0
    global_load_lds_dwordx4 v13, s[14:15]
    s_mov_b32 m0, 129024
    s_nop 0
    global_load_lds_dwordx4 v14, s[14:15]
    s_mov_b32 m0, 130048
    s_nop 0
    global_load_lds_dwordx4 v15, s[14:15]
    s_waitcnt vmcnt(20)
    s_barrier
    v_add_u32 v16, 32768, v11
    ds_read_b64_tr_b16 a[0:1], v16 offset:0
    ds_read_b64_tr_b16 a[2:3], v16 offset:1024
    ds_read_b64_tr_b16 a[4:5], v16 offset:4096
    ds_read_b64_tr_b16 a[6:7], v16 offset:5120
    ds_read_b64_tr_b16 a[8:9], v16 offset:8192
    ds_read_b64_tr_b16 a[10:11], v16 offset:9216
    ds_read_b64_tr_b16 a[12:13], v16 offset:12288
    ds_read_b64_tr_b16 a[14:15], v16 offset:13312
    s_waitcnt lgkmcnt(0)
    s_barrier
    s_add_u32 s14, s60, 3145728
    s_addc_u32 s15, s61, 0
    s_mov_b32 m0, 143360
    s_nop 0
    global_load_lds_dwordx4 v12, s[14:15]
    s_mov_b32 m0, 144384
    s_nop 0
    global_load_lds_dwordx4 v13, s[14:15]
    s_mov_b32 m0, 145408
    s_nop 0
    global_load_lds_dwordx4 v14, s[14:15]
    s_mov_b32 m0, 146432
    s_nop 0
    global_load_lds_dwordx4 v15, s[14:15]
    s_waitcnt vmcnt(20)
    s_barrier
    v_add_u32 v16, 49152, v11
    ds_read_b64_tr_b16 a[16:17], v16 offset:0
    ds_read_b64_tr_b16 a[18:19], v16 offset:1024
    ds_read_b64_tr_b16 a[20:21], v16 offset:4096
    ds_read_b64_tr_b16 a[22:23], v16 offset:5120
    ds_read_b64_tr_b16 a[24:25], v16 offset:8192
    ds_read_b64_tr_b16 a[26:27], v16 offset:9216
    ds_read_b64_tr_b16 a[28:29], v16 offset:12288
    ds_read_b64_tr_b16 a[30:31], v16 offset:13312
    s_waitcnt lgkmcnt(0)
    s_barrier
    s_add_u32 s14, s60, 3670016
    s_addc_u32 s15, s61, 0
    s_mov_b32 m0, 159744
    s_nop 0
    global_load_lds_dwordx4 v12, s[14:15]
    s_mov_b32 m0, 160768
    s_nop 0
    global_load_lds_dwordx4 v13, s[14:15]
    s_mov_b32 m0, 161792
    s_nop 0
    global_load_lds_dwordx4 v14, s[14:15]
    s_mov_b32 m0, 162816
    s_nop 0
    global_load_lds_dwordx4 v15, s[14:15]
    s_waitcnt vmcnt(20)
    s_barrier
    v_add_u32 v16, 65536, v11
    ds_read_b64_tr_b16 a[32:33], v16 offset:0
    ds_read_b64_tr_b16 a[34:35], v16 offset:1024
    ds_read_b64_tr_b16 a[36:37], v16 offset:4096
    ds_read_b64_tr_b16 a[38:39], v16 offset:5120
    ds_read_b64_tr_b16 a[40:41], v16 offset:8192
    ds_read_b64_tr_b16 a[42:43], v16 offset:9216
    ds_read_b64_tr_b16 a[44:45], v16 offset:12288
    ds_read_b64_tr_b16 a[46:47], v16 offset:13312
    s_waitcnt lgkmcnt(0)
    s_barrier
    s_add_u32 s14, s62, 0
    s_addc_u32 s15, s63, 0
    s_mov_b32 m0, 45056
    s_nop 0
    global_load_lds_dwordx4 v12, s[14:15]
    s_mov_b32 m0, 46080
    s_nop 0
    global_load_lds_dwordx4 v13, s[14:15]
    s_mov_b32 m0, 47104
    s_nop 0
    global_load_lds_dwordx4 v14, s[14:15]
    s_mov_b32 m0, 48128
    s_nop 0
    global_load_lds_dwordx4 v15, s[14:15]
    s_waitcnt vmcnt(20)
    s_barrier
    v_add_u32 v16, 81920, v11
    ds_read_b64_tr_b16 a[48:49], v16 offset:0
    ds_read_b64_tr_b16 a[50:51], v16 offset:1024
    ds_read_b64_tr_b16 a[52:53], v16 offset:4096
    ds_read_b64_tr_b16 a[54:55], v16 offset:5120
    ds_read_b64_tr_b16 a[56:57], v16 offset:8192
    ds_read_b64_tr_b16 a[58:59], v16 offset:9216
    ds_read_b64_tr_b16 a[60:61], v16 offset:12288
    ds_read_b64_tr_b16 a[62:63], v16 offset:13312
    s_waitcnt lgkmcnt(0)
    s_barrier
    s_add_u32 s14, s62, 524288
    s_addc_u32 s15, s63, 0
    s_mov_b32 m0, 61440
    s_nop 0
    global_load_lds_dwordx4 v12, s[14:15]
    s_mov_b32 m0, 62464
    s_nop 0
    global_load_lds_dwordx4 v13, s[14:15]
    s_mov_b32 m0, 63488
    s_nop 0
    global_load_lds_dwordx4 v14, s[14:15]
    s_mov_b32 m0, 64512
    s_nop 0
    global_load_lds_dwordx4 v15, s[14:15]
    s_waitcnt vmcnt(20)
    s_barrier
    v_add_u32 v16, 98304, v11
    ds_read_b64_tr_b16 a[64:65], v16 offset:0
    ds_read_b64_tr_b16 a[66:67], v16 offset:1024
    ds_read_b64_tr_b16 a[68:69], v16 offset:4096
    ds_read_b64_tr_b16 a[70:71], v16 offset:5120
    ds_read_b64_tr_b16 a[72:73], v16 offset:8192
    ds_read_b64_tr_b16 a[74:75], v16 offset:9216
    ds_read_b64_tr_b16 a[76:77], v16 offset:12288
    ds_read_b64_tr_b16 a[78:79], v16 offset:13312
    s_waitcnt lgkmcnt(0)
    s_barrier
    s_add_u32 s14, s62, 1048576
    s_addc_u32 s15, s63, 0
    s_mov_b32 m0, 77824
    s_nop 0
    global_load_lds_dwordx4 v12, s[14:15]
    s_mov_b32 m0, 78848
    s_nop 0
    global_load_lds_dwordx4 v13, s[14:15]
    s_mov_b32 m0, 79872
    s_nop 0
    global_load_lds_dwordx4 v14, s[14:15]
    s_mov_b32 m0, 80896
    s_nop 0
    global_load_lds_dwordx4 v15, s[14:15]
    s_waitcnt vmcnt(20)
    s_barrier
    v_add_u32 v16, 114688, v11
    ds_read_b64_tr_b16 a[80:81], v16 offset:0
    ds_read_b64_tr_b16 a[82:83], v16 offset:1024
    ds_read_b64_tr_b16 a[84:85], v16 offset:4096
    ds_read_b64_tr_b16 a[86:87], v16 offset:5120
    ds_read_b64_tr_b16 a[88:89], v16 offset:8192
    ds_read_b64_tr_b16 a[90:91], v16 offset:9216
    ds_read_b64_tr_b16 a[92:93], v16 offset:12288
    ds_read_b64_tr_b16 a[94:95], v16 offset:13312
    s_waitcnt lgkmcnt(0)
    s_barrier
    s_add_u32 s14, s62, 1572864
    s_addc_u32 s15, s63, 0
    s_mov_b32 m0, 94208
    s_nop 0
    global_load_lds_dwordx4 v12, s[14:15]
    s_mov_b32 m0, 95232
    s_nop 0
    global_load_lds_dwordx4 v13, s[14:15]
    s_mov_b32 m0, 96256
    s_nop 0
    global_load_lds_dwordx4 v14, s[14:15]
    s_mov_b32 m0, 97280
    s_nop 0
    global_load_lds_dwordx4 v15, s[14:15]
    s_waitcnt vmcnt(20)
    s_barrier
    v_add_u32 v16, 131072, v11
    ds_read_b64_tr_b16 a[96:97], v16 offset:0
    ds_read_b64_tr_b16 a[98:99], v16 offset:1024
    ds_read_b64_tr_b16 a[100:101], v16 offset:4096
    ds_read_b64_tr_b16 a[102:103], v16 offset:5120
    ds_read_b64_tr_b16 a[104:105], v16 offset:8192
    ds_read_b64_tr_b16 a[106:107], v16 offset:9216
    ds_read_b64_tr_b16 a[108:109], v16 offset:12288
    ds_read_b64_tr_b16 a[110:111], v16 offset:13312
    s_waitcnt lgkmcnt(0)
    s_barrier
    s_add_u32 s14, s62, 2097152
    s_addc_u32 s15, s63, 0
    s_mov_b32 m0, 110592
    s_nop 0
    global_load_lds_dwordx4 v12, s[14:15]
    s_mov_b32 m0, 111616
    s_nop 0
    global_load_lds_dwordx4 v13, s[14:15]
    s_mov_b32 m0, 112640
    s_nop 0
    global_load_lds_dwordx4 v14, s[14:15]
    s_mov_b32 m0, 113664
    s_nop 0
    global_load_lds_dwordx4 v15, s[14:15]
    s_waitcnt vmcnt(20)
    s_barrier
    v_add_u32 v16, 147456, v11
    ds_read_b64_tr_b16 a[112:113], v16 offset:0
    ds_read_b64_tr_b16 a[114:115], v16 offset:1024
    ds_read_b64_tr_b16 a[116:117], v16 offset:4096
    ds_read_b64_tr_b16 a[118:119], v16 offset:5120
    ds_read_b64_tr_b16 a[120:121], v16 offset:8192
    ds_read_b64_tr_b16 a[122:123], v16 offset:9216
    ds_read_b64_tr_b16 a[124:125], v16 offset:12288
    ds_read_b64_tr_b16 a[126:127], v16 offset:13312
    s_waitcnt lgkmcnt(0)
    s_barrier
    s_add_u32 s14, s62, 2621440
    s_addc_u32 s15, s63, 0
    s_mov_b32 m0, 126976
    s_nop 0
    global_load_lds_dwordx4 v12, s[14:15]
    s_mov_b32 m0, 128000
    s_nop 0
    global_load_lds_dwordx4 v13, s[14:15]
    s_mov_b32 m0, 129024
    s_nop 0
    global_load_lds_dwordx4 v14, s[14:15]
    s_mov_b32 m0, 130048
    s_nop 0
    global_load_lds_dwordx4 v15, s[14:15]
    s_waitcnt vmcnt(20)
    s_barrier
    v_add_u32 v16, 32768, v11
    ds_read_b64_tr_b16 a[128:129], v16 offset:0
    ds_read_b64_tr_b16 a[130:131], v16 offset:1024
    ds_read_b64_tr_b16 a[132:133], v16 offset:4096
    ds_read_b64_tr_b16 a[134:135], v16 offset:5120
    ds_read_b64_tr_b16 a[136:137], v16 offset:8192
    ds_read_b64_tr_b16 a[138:139], v16 offset:9216
    ds_read_b64_tr_b16 a[140:141], v16 offset:12288
    ds_read_b64_tr_b16 a[142:143], v16 offset:13312
    s_waitcnt lgkmcnt(0)
    s_barrier
    s_add_u32 s14, s62, 3145728
    s_addc_u32 s15, s63, 0
    s_mov_b32 m0, 143360
    s_nop 0
    global_load_lds_dwordx4 v12, s[14:15]
    s_mov_b32 m0, 144384
    s_nop 0
    global_load_lds_dwordx4 v13, s[14:15]
    s_mov_b32 m0, 145408
    s_nop 0
    global_load_lds_dwordx4 v14, s[14:15]
    s_mov_b32 m0, 146432
    s_nop 0
    global_load_lds_dwordx4 v15, s[14:15]
    s_waitcnt vmcnt(20)
    s_barrier
    v_add_u32 v16, 49152, v11
    ds_read_b64_tr_b16 a[144:145], v16 offset:0
    ds_read_b64_tr_b16 a[146:147], v16 offset:1024
    ds_read_b64_tr_b16 a[148:149], v16 offset:4096
    ds_read_b64_tr_b16 a[150:151], v16 offset:5120
    ds_read_b64_tr_b16 a[152:153], v16 offset:8192
    ds_read_b64_tr_b16 a[154:155], v16 offset:9216
    ds_read_b64_tr_b16 a[156:157], v16 offset:12288
    ds_read_b64_tr_b16 a[158:159], v16 offset:13312
    s_waitcnt lgkmcnt(0)
    s_barrier
    s_add_u32 s14, s62, 3670016
    s_addc_u32 s15, s63, 0
    s_mov_b32 m0, 159744
    s_nop 0
    global_load_lds_dwordx4 v12, s[14:15]
    s_mov_b32 m0, 160768
    s_nop 0
    global_load_lds_dwordx4 v13, s[14:15]
    s_mov_b32 m0, 161792
    s_nop 0
    global_load_lds_dwordx4 v14, s[14:15]
    s_mov_b32 m0, 162816
    s_nop 0
    global_load_lds_dwordx4 v15, s[14:15]
    s_waitcnt vmcnt(20)
    s_barrier
    v_add_u32 v16, 65536, v11
    ds_read_b64_tr_b16 a[160:161], v16 offset:0
    ds_read_b64_tr_b16 a[162:163], v16 offset:1024
    ds_read_b64_tr_b16 a[164:165], v16 offset:4096
    ds_read_b64_tr_b16 a[166:167], v16 offset:5120
    ds_read_b64_tr_b16 a[168:169], v16 offset:8192
    ds_read_b64_tr_b16 a[170:171], v16 offset:9216
    ds_read_b64_tr_b16 a[172:173], v16 offset:12288
    ds_read_b64_tr_b16 a[174:175], v16 offset:13312
    s_waitcnt lgkmcnt(0)
    s_barrier
    s_waitcnt vmcnt(16)
    s_barrier
    v_add_u32 v16, 81920, v11
    ds_read_b64_tr_b16 a[176:177], v16 offset:0
    ds_read_b64_tr_b16 a[178:179], v16 offset:1024
    ds_read_b64_tr_b16 a[180:181], v16 offset:4096
    ds_read_b64_tr_b16 a[182:183], v16 offset:5120
    ds_read_b64_tr_b16 a[184:185], v16 offset:8192
    ds_read_b64_tr_b16 a[186:187], v16 offset:9216
    ds_read_b64_tr_b16 a[188:189], v16 offset:12288
    ds_read_b64_tr_b16 a[190:191], v16 offset:13312
    s_waitcnt lgkmcnt(0)
    s_barrier
    s_waitcnt vmcnt(12)
    s_barrier
    v_add_u32 v16, 98304, v11
    ds_read_b64_tr_b16 a[192:193], v16 offset:0
    ds_read_b64_tr_b16 a[194:195], v16 offset:1024
    ds_read_b64_tr_b16 a[196:197], v16 offset:4096
    ds_read_b64_tr_b16 a[198:199], v16 offset:5120
    ds_read_b64_tr_b16 a[200:201], v16 offset:8192
    ds_read_b64_tr_b16 a[202:203], v16 offset:9216
    ds_read_b64_tr_b16 a[204:205], v16 offset:12288
    ds_read_b64_tr_b16 a[206:207], v16 offset:13312
    s_waitcnt lgkmcnt(0)
    s_barrier
    s_waitcnt vmcnt(8)
    s_barrier
    v_add_u32 v16, 114688, v11
    ds_read_b64_tr_b16 a[208:209], v16 offset:0
    ds_read_b64_tr_b16 a[210:211], v16 offset:1024
    ds_read_b64_tr_b16 a[212:213], v16 offset:4096
    ds_read_b64_tr_b16 a[214:215], v16 offset:5120
    ds_read_b64_tr_b16 a[216:217], v16 offset:8192
    ds_read_b64_tr_b16 a[218:219], v16 offset:9216
    ds_read_b64_tr_b16 a[220:221], v16 offset:12288
    ds_read_b64_tr_b16 a[222:223], v16 offset:13312
    s_waitcnt lgkmcnt(0)
    s_barrier
    s_waitcnt vmcnt(4)
    s_barrier
    v_add_u32 v16, 131072, v11
    ds_read_b64_tr_b16 a[224:225], v16 offset:0
    ds_read_b64_tr_b16 a[226:227], v16 offset:1024
    ds_read_b64_tr_b16 a[228:229], v16 offset:4096
    ds_read_b64_tr_b16 a[230:231], v16 offset:5120
    ds_read_b64_tr_b16 a[232:233], v16 offset:8192
    ds_read_b64_tr_b16 a[234:235], v16 offset:9216
    ds_read_b64_tr_b16 a[236:237], v16 offset:12288
    ds_read_b64_tr_b16 a[238:239], v16 offset:13312
    s_waitcnt lgkmcnt(0)
    s_barrier
    s_waitcnt vmcnt(0)
    s_barrier
    v_add_u32 v16, 147456, v11
    ds_read_b64_tr_b16 a[240:241], v16 offset:0
    ds_read_b64_tr_b16 a[242:243], v16 offset:1024
    ds_read_b64_tr_b16 a[244:245], v16 offset:4096
    ds_read_b64_tr_b16 a[246:247], v16 offset:5120
    ds_read_b64_tr_b16 a[248:249], v16 offset:8192
    ds_read_b64_tr_b16 a[250:251], v16 offset:9216
    ds_read_b64_tr_b16 a[252:253], v16 offset:12288
    ds_read_b64_tr_b16 a[254:255], v16 offset:13312
    s_waitcnt lgkmcnt(0)
    s_barrier
L_p1w_32:
    v_and_b32 v8, 15, v0
    v_lshrrev_b32 v9, 5, v0
    v_lshl_add_u32 v8, v9, 4, v8
    v_lshlrev_b32 v8, 4, v8
    v_bfe_u32 v9, v0, 4, 1
    v_lshl_add_u32 v10, v9, 12, v8
    s_lshl_b32 s54, s8, 10
    v_add_u32 v10, s54, v10
    v_lshl_add_u32 v11, v9, 10, v8
    s_lshl_b32 s54, s8, 11
    s_add_u32 s54, s54, 8192
    v_add_u32 v11, s54, v11
    s_cmp_eq_u32 s13, 0
    s_cselect_b32 s22, 22, 21
    s_mov_b32 s21, 0
    s_mov_b32 s23, 0
    s_lshl_b32 s54, s10, 5
    s_add_u32 s54, s54, s9
    s_lshl_b32 s54, s54, 4
    s_lshl_b32 s55, s13, 2
    s_add_u32 s54, s54, s55
    s_add_u32 s54, s54, 117440512
    s_add_u32 s26, s4, s54
    s_addc_u32 s27, s5, 0
.p2align 6
L_p1_loop:
    s_waitcnt vmcnt(4)
    s_barrier
    s_cmp_lt_u32 s21, 2
    s_cbranch_scc1 L_nofl_37
    s_cmp_lg_u32 s8, 0
    s_cbranch_scc1 L_nofl_37
    s_sub_u32 s54, s21, 1
    v_mov_b32 v8, s54
    v_mov_b32 v9, 0
    s_mov_b64 exec, 1
    global_store_dword v9, v8, s[26:27] sc1
    s_mov_b64 exec, -1
L_nofl_37:
    s_add_u32 s56, s21, 1
    s_cmp_ge_u32 s56, s22
    s_cbranch_scc1 L_nonext_38
    s_add_u32 s56, s20, 3
    s_xor_b32 s57, s23, 32768
    s_lshl_b32 s54, s56, 15
    s_add_u32 s14, s18, s54
    s_addc_u32 s15, s19, 0
    s_lshl_b32 s54, s8, 13
    s_add_u32 s54, s54, s57
    s_add_u32 m0, s54, 0
    s_nop 0
    global_load_lds_dwordx4 v2, s[14:15] offset:0
    s_add_u32 m0, s54, 896
    s_nop 0
    global_load_lds_dwordx4 v2, s[14:15] offset:128
    s_add_u32 m0, s54, 1792
    s_nop 0
    global_load_lds_dwordx4 v2, s[14:15] offset:256
    s_add_u32 m0, s54, 2688
    s_nop 0
    global_load_lds_dwordx4 v2, s[14:15] offset:384
    s_add_u32 m0, s54, 3584
    s_nop 0
    global_load_lds_dwordx4 v2, s[14:15] offset:512
    s_add_u32 m0, s54, 4480
    s_nop 0
    global_load_lds_dwordx4 v2, s[14:15] offset:640
    s_add_u32 m0, s54, 5376
    s_nop 0
    global_load_lds_dwordx4 v2, s[14:15] offset:768
    s_add_u32 m0, s54, 6272
    s_nop 0
    global_load_lds_dwordx4 v2, s[14:15] offset:896
L_nonext_38:
    s_lshl_b32 s54, s10, 6
    s_add_u32 s54, s54, s20
    s_lshl_b32 s54, s54, 5
    s_add_u32 s54, s54, s9
    s_lshl_b32 s54, s54, 14
    s_add_u32 s24, s4, s54
    s_addc_u32 s25, s5, 0
    v_add_u32 v12, s23, v4
    v_add_u32 v13, s23, v5
    v_add_u32 v14, s23, v6
    v_add_u32 v15, s23, v7
    ds_read_b128 v[64:67], v12 offset:0
    ds_read_b128 v[68:71], v13 offset:0
    ds_read_b128 v[72:75], v14 offset:0
    s_waitcnt lgkmcnt(2)
    v_mfma_f32_32x32x16_bf16 v[32:47], a[0:3], v[64:67], 0
    v_mfma_f32_32x32x16_bf16 v[48:63], v[64:67], a[128:131], 0
    ds_read_b128 v[76:79], v15 offset:0
    s_waitcnt lgkmcnt(2)
    v_mfma_f32_32x32x16_bf16 v[32:47], a[4:7], v[68:71], v[32:47]
    v_mfma_f32_32x32x16_bf16 v[48:63], v[68:71], a[132:135], v[48:63]
    ds_read_b128 v[64:67], v12 offset:1024
    s_waitcnt lgkmcnt(2)
    v_mfma_f32_32x32x16_bf16 v[32:47], a[8:11], v[72:75], v[32:47]
    v_mfma_f32_32x32x16_bf16 v[48:63], v[72:75], a[136:139], v[48:63]
    ds_read_b128 v[68:71], v13 offset:1024
    s_waitcnt lgkmcnt(2)
    v_mfma_f32_32x32x16_bf16 v[32:47], a[12:15], v[76:79], v[32:47]
    v_mfma_f32_32x32x16_bf16 v[48:63], v[76:79], a[140:143], v[48:63]
    ds_read_b128 v[72:75], v14 offset:1024
    s_waitcnt lgkmcnt(2)
    v_mfma_f32_32x32x16_bf16 v[32:47], a[16:19], v[64:67], v[32:47]
    v_mfma_f32_32x32x16_bf16 v[48:63], v[64:67], a[144:147], v[48:63]
    ds_read_b128 v[76:79], v15 offset:1024
    s_waitcnt lgkmcnt(2)
    v_mfma_f32_32x32x16_bf16 v[32:47], a[20:23], v[68:71], v[32:47]
    v_mfma_f32_32x32x16_bf16 v[48:63], v[68:71], a[148:151], v[48:63]
    ds_read_b128 v[64:67], v12 offset:2048
    s_waitcnt lgkmcnt(2)
    v_mfma_f32_32x32x16_bf16 v[32:47], a[24:27], v[72:75], v[32:47]
    v_mfma_f32_32x32x16_bf16 v[48:63], v[72:75], a[152:155], v[48:63]
    ds_read_b128 v[68:71], v13 offset:2048
    s_waitcnt lgkmcnt(2)
    v_mfma_f32_32x32x16_bf16 v[32:47], a[28:31], v[76:79], v[32:47]
    v_mfma_f32_32x32x16_bf16 v[48:63], v[76:79], a[156:159], v[48:63]
    ds_read_b128 v[72:75], v14 offset:2048
    s_waitcnt lgkmcnt(2)
    v_mfma_f32_32x32x16_bf16 v[32:47], a[32:35], v[64:67], v[32:47]
    v_mfma_f32_32x32x16_bf16 v[48:63], v[64:67], a[160:163], v[48:63]
    ds_read_b128 v[76:79], v15 offset:2048
    s_waitcnt lgkmcnt(2)
    v_mfma_f32_32x32x16_bf16 v[32:47], a[36:39], v[68:71], v[32:47]
    v_mfma_f32_32x32x16_bf16 v[48:63], v[68:71], a[164:167], v[48:63]
    ds_read_b128 v[64:67], v12 offset:3072
    s_waitcnt lgkmcnt(2)
    v_mfma_f32_32x32x16_bf16 v[32:47], a[40:43], v[72:75], v[32:47]
    v_mfma_f32_32x32x16_bf16 v[48:63], v[72:75], a[168:171], v[48:63]
    ds_read_b128 v[68:71], v13 offset:3072
    s_waitcnt lgkmcnt(2)
    v_mfma_f32_32x32x16_bf16 v[32:47], a[44:47], v[76:79], v[32:47]
    v_mfma_f32_32x32x16_bf16 v[48:63], v[76:79], a[172:175], v[48:63]
    ds_read_b128 v[72:75], v14 offset:3072
    s_waitcnt lgkmcnt(2)
    v_mfma_f32_32x32x16_bf16 v[32:47], a[48:51], v[64:67], v[32:47]
    v_mfma_f32_32x32x16_bf16 v[48:63], v[64:67], a[176:179], v[48:63]
    ds_read_b128 v[76:79], v15 offset:3072
    s_waitcnt lgkmcnt(2)
    v_mfma_f32_32x32x16_bf16 v[32:47], a[52:55], v[68:71], v[32:47]
    v_mfma_f32_32x32x16_bf16 v[48:63], v[68:71], a[180:183], v[48:63]
    ds_read_b128 v[64:67], v12 offset:4096
    s_waitcnt lgkmcnt(2)
    v_mfma_f32_32x32x16_bf16 v[32:47], a[56:59], v[72:75], v[32:47]
    v_mfma_f32_32x32x16_bf16 v[48:63], v[72:75], a[184:187], v[48:63]
    ds_read_b128 v[68:71], v13 offset:4096
    s_waitcnt lgkmcnt(2)
    v_mfma_f32_32x32x16_bf16 v[32:47], a[60:63], v[76:79], v[32:47]
    v_mfma_f32_32x32x16_bf16 v[48:63], v[76:79], a[188:191], v[48:63]
    ds_read_b128 v[72:75], v14 offset:4096
    s_waitcnt lgkmcnt(2)
    v_mfma_f32_32x32x16_bf16 v[32:47], a[64:67], v[64:67], v[32:47]
    v_mfma_f32_32x32x16_bf16 v[48:63], v[64:67], a[192:195], v[48:63]
    ds_read_b128 v[76:79], v15 offset:4096
    s_waitcnt lgkmcnt(2)
    v_mfma_f32_32x32x16_bf16 v[32:47], a[68:71], v[68:71], v[32:47]
    v_mfma_f32_32x32x16_bf16 v[48:63], v[68:71], a[196:199], v[48:63]
    ds_read_b128 v[64:67], v12 offset:5120
    s_waitcnt lgkmcnt(2)
    v_mfma_f32_32x32x16_bf16 v[32:47], a[72:75], v[72:75], v[32:47]
    v_mfma_f32_32x32x16_bf16 v[48:63], v[72:75], a[200:203], v[48:63]
    ds_read_b128 v[68:71], v13 offset:5120
    s_waitcnt lgkmcnt(2)
    v_mfma_f32_32x32x16_bf16 v[32:47], a[76:79], v[76:79], v[32:47]
    v_mfma_f32_32x32x16_bf16 v[48:63], v[76:79], a[204:207], v[48:63]
    ds_read_b128 v[72:75], v14 offset:5120
    s_waitcnt lgkmcnt(2)
    v_mfma_f32_32x32x16_bf16 v[32:47], a[80:83], v[64:67], v[32:47]
    v_mfma_f32_32x32x16_bf16 v[48:63], v[64:67], a[208:211], v[48:63]
    ds_read_b128 v[76:79], v15 offset:5120
    s_waitcnt lgkmcnt(2)
    v_mfma_f32_32x32x16_bf16 v[32:47], a[84:87], v[68:71], v[32:47]
    v_mfma_f32_32x32x16_bf16 v[48:63], v[68:71], a[212:215], v[48:63]
    ds_read_b128 v[64:67], v12 offset:6144
    s_waitcnt lgkmcnt(2)
    v_mfma_f32_32x32x16_bf16 v[32:47], a[88:91], v[72:75], v[32:47]
    v_mfma_f32_32x32x16_bf16 v[48:63], v[72:75], a[216:219], v[48:63]
    ds_read_b128 v[68:71], v13 offset:6144
    s_waitcnt lgkmcnt(2)
    v_mfma_f32_32x32x16_bf16 v[32:47], a[92:95], v[76:79], v[32:47]
    v_mfma_f32_32x32x16_bf16 v[48:63], v[76:79], a[220:223], v[48:63]
    ds_read_b128 v[72:75], v14 offset:6144
    s_waitcnt lgkmcnt(2)
    v_mfma_f32_32x32x16_bf16 v[32:47], a[96:99], v[64:67], v[32:47]
    v_mfma_f32_32x32x16_bf16 v[48:63], v[64:67], a[224:227], v[48:63]
    ds_read_b128 v[76:79], v15 offset:6144
    s_waitcnt lgkmcnt(2)
    v_mfma_f32_32x32x16_bf16 v[32:47], a[100:103], v[68:71], v[32:47]
    v_mfma_f32_32x32x16_bf16 v[48:63], v[68:71], a[228:231], v[48:63]
    ds_read_b128 v[64:67], v12 offset:7168
    s_waitcnt lgkmcnt(2)
    v_mfma_f32_32x32x16_bf16 v[32:47], a[104:107], v[72:75], v[32:47]
    v_mfma_f32_32x32x16_bf16 v[48:63], v[72:75], a[232:235], v[48:63]
    ds_read_b128 v[68:71], v13 offset:7168
    s_waitcnt lgkmcnt(2)
    v_mfma_f32_32x32x16_bf16 v[32:47], a[108:111], v[76:79], v[32:47]
    v_mfma_f32_32x32x16_bf16 v[48:63], v[76:79], a[236:239], v[48:63]
    ds_read_b128 v[72:75], v14 offset:7168
    s_waitcnt lgkmcnt(2)
    v_mfma_f32_32x32x16_bf16 v[32:47], a[112:115], v[64:67], v[32:47]
    v_mfma_f32_32x32x16_bf16 v[48:63], v[64:67], a[240:243], v[48:63]
    ds_read_b128 v[76:79], v15 offset:7168
    s_waitcnt lgkmcnt(2)
    v_mfma_f32_32x32x16_bf16 v[32:47], a[116:119], v[68:71], v[32:47]
    v_mfma_f32_32x32x16_bf16 v[48:63], v[68:71], a[244:247], v[48:63]
    s_waitcnt lgkmcnt(1)
    v_mfma_f32_32x32x16_bf16 v[32:47], a[120:123], v[72:75], v[32:47]
    v_mfma_f32_32x32x16_bf16 v[48:63], v[72:75], a[248:251], v[48:63]
    s_waitcnt lgkmcnt(0)
    v_mfma_f32_32x32x16_bf16 v[32:47], a[124:127], v[76:79], v[32:47]
    v_mfma_f32_32x32x16_bf16 v[48:63], v[76:79], a[252:255], v[48:63]
    s_nop 15
    s_nop 3
    v_cvt_pk_bf16_f32 v16, v32, v33
    v_cvt_pk_bf16_f32 v17, v34, v35
    v_cvt_pk_bf16_f32 v18, v36, v37
    v_cvt_pk_bf16_f32 v19, v38, v39
    v_cvt_pk_bf16_f32 v20, v40, v41
    v_cvt_pk_bf16_f32 v21, v42, v43
    v_cvt_pk_bf16_f32 v22, v44, v45
    v_cvt_pk_bf16_f32 v23, v46, v47
    global_store_dwordx4 v10, v[16:19], s[24:25] sc1
    global_store_dwordx4 v10, v[20:23], s[24:25] offset:512 sc1
    v_cvt_pk_bf16_f32 v24, v48, v49
    v_cvt_pk_bf16_f32 v25, v50, v51
    v_cvt_pk_bf16_f32 v26, v56, v57
    v_cvt_pk_bf16_f32 v27, v58, v59
    v_cvt_pk_bf16_f32 v28, v52, v53
    v_cvt_pk_bf16_f32 v29, v54, v55
    v_cvt_pk_bf16_f32 v30, v60, v61
    v_cvt_pk_bf16_f32 v31, v62, v63
    global_store_dwordx4 v11, v[24:27], s[24:25] sc1
    global_store_dwordx4 v11, v[28:31], s[24:25] offset:512 sc1
    s_cmp_lg_u32 s10, 1
    s_cbranch_scc1 L_nogate_39
    s_cmp_lg_u32 s9, s21
    s_cbranch_scc1 L_nogate_39
    s_cmp_lg_u32 s8, 0
    s_cbranch_scc1 L_nogate_39
    s_load_dwordx2 s[16:17], s[0:1], 112
    v_lshrrev_b32 v8, 5, v0
    v_lshlrev_b32 v8, 4, v8
    s_waitcnt lgkmcnt(0)
    global_load_dwordx4 v[80:83], v8, s[16:17] offset:0
    global_load_dwordx4 v[84:87], v8, s[16:17] offset:32
    global_load_dwordx4 v[88:91], v8, s[16:17] offset:64
    global_load_dwordx4 v[92:95], v8, s[16:17] offset:96
    global_load_dwordx4 v[96:99], v8, s[16:17] offset:128
    global_load_dwordx4 v[100:103], v8, s[16:17] offset:160
    global_load_dwordx4 v[104:107], v8, s[16:17] offset:192
    global_load_dwordx4 v[108:111], v8, s[16:17] offset:224
    global_load_dwordx4 v[112:115], v8, s[16:17] offset:256
    global_load_dwordx4 v[116:119], v8, s[16:17] offset:288
    global_load_dwordx4 v[120:123], v8, s[16:17] offset:320
    global_load_dwordx4 v[124:127], v8, s[16:17] offset:352
    global_load_dwordx4 v[128:131], v8, s[16:17] offset:384
    global_load_dwordx4 v[132:135], v8, s[16:17] offset:416
    global_load_dwordx4 v[136:139], v8, s[16:17] offset:448
    global_load_dwordx4 v[140:143], v8, s[16:17] offset:480
    s_waitcnt vmcnt(0)
    ds_read_b128 v[64:67], v12 offset:0
    s_waitcnt lgkmcnt(0)
    v_mfma_f32_32x32x16_bf16 v[32:47], v[80:83], v[64:67], 0
    ds_read_b128 v[64:67], v13 offset:0
    s_waitcnt lgkmcnt(0)
    v_mfma_f32_32x32x16_bf16 v[32:47], v[84:87], v[64:67], v[32:47]
    ds_read_b128 v[64:67], v14 offset:0
    s_waitcnt lgkmcnt(0)
    v_mfma_f32_32x32x16_bf16 v[32:47], v[88:91], v[64:67], v[32:47]
    ds_read_b128 v[64:67], v15 offset:0
    s_waitcnt lgkmcnt(0)
    v_mfma_f32_32x32x16_bf16 v[32:47], v[92:95], v[64:67], v[32:47]
    ds_read_b128 v[64:67], v12 offset:1024
    s_waitcnt lgkmcnt(0)
    v_mfma_f32_32x32x16_bf16 v[32:47], v[96:99], v[64:67], v[32:47]
    ds_read_b128 v[64:67], v13 offset:1024
    s_waitcnt lgkmcnt(0)
    v_mfma_f32_32x32x16_bf16 v[32:47], v[100:103], v[64:67], v[32:47]
    ds_read_b128 v[64:67], v14 offset:1024
    s_waitcnt lgkmcnt(0)
    v_mfma_f32_32x32x16_bf16 v[32:47], v[104:107], v[64:67], v[32:47]
    ds_read_b128 v[64:67], v15 offset:1024
    s_waitcnt lgkmcnt(0)
    v_mfma_f32_32x32x16_bf16 v[32:47], v[108:111], v[64:67], v[32:47]
    ds_read_b128 v[64:67], v12 offset:2048
    s_waitcnt lgkmcnt(0)
    v_mfma_f32_32x32x16_bf16 v[32:47], v[112:115], v[64:67], v[32:47]
    ds_read_b128 v[64:67], v13 offset:2048
    s_waitcnt lgkmcnt(0)
    v_mfma_f32_32x32x16_bf16 v[32:47], v[116:119], v[64:67], v[32:47]
    ds_read_b128 v[64:67], v14 offset:2048
    s_waitcnt lgkmcnt(0)
    v_mfma_f32_32x32x16_bf16 v[32:47], v[120:123], v[64:67], v[32:47]
    ds_read_b128 v[64:67], v15 offset:2048
    s_waitcnt lgkmcnt(0)
    v_mfma_f32_32x32x16_bf16 v[32:47], v[124:127], v[64:67], v[32:47]
    ds_read_b128 v[64:67], v12 offset:3072
    s_waitcnt lgkmcnt(0)
    v_mfma_f32_32x32x16_bf16 v[32:47], v[128:131], v[64:67], v[32:47]
    ds_read_b128 v[64:67], v13 offset:3072
    s_waitcnt lgkmcnt(0)
    v_mfma_f32_32x32x16_bf16 v[32:47], v[132:135], v[64:67], v[32:47]
    ds_read_b128 v[64:67], v14 offset:3072
    s_waitcnt lgkmcnt(0)
    v_mfma_f32_32x32x16_bf16 v[32:47], v[136:139], v[64:67], v[32:47]
    ds_read_b128 v[64:67], v15 offset:3072
    s_waitcnt lgkmcnt(0)
    v_mfma_f32_32x32x16_bf16 v[32:47], v[140:143], v[64:67], v[32:47]
    global_load_dwordx4 v[80:83], v8, s[16:17] offset:512
    global_load_dwordx4 v[84:87], v8, s[16:17] offset:544
    global_load_dwordx4 v[88:91], v8, s[16:17] offset:576
    global_load_dwordx4 v[92:95], v8, s[16:17] offset:608
    global_load_dwordx4 v[96:99], v8, s[16:17] offset:640
    global_load_dwordx4 v[100:103], v8, s[16:17] offset:672
    global_load_dwordx4 v[104:107], v8, s[16:17] offset:704
    global_load_dwordx4 v[108:111], v8, s[16:17] offset:736
    global_load_dwordx4 v[112:115], v8, s[16:17] offset:768
    global_load_dwordx4 v[116:119], v8, s[16:17] offset:800
    global_load_dwordx4 v[120:123], v8, s[16:17] offset:832
    global_load_dwordx4 v[124:127], v8, s[16:17] offset:864
    global_load_dwordx4 v[128:131], v8, s[16:17] offset:896
    global_load_dwordx4 v[132:135], v8, s[16:17] offset:928
    global_load_dwordx4 v[136:139], v8, s[16:17] offset:960
    global_load_dwordx4 v[140:143], v8, s[16:17] offset:992
    s_waitcnt vmcnt(0)
    ds_read_b128 v[64:67], v12 offset:4096
    s_waitcnt lgkmcnt(0)
    v_mfma_f32_32x32x16_bf16 v[32:47], v[80:83], v[64:67], v[32:47]
    ds_read_b128 v[64:67], v13 offset:4096
    s_waitcnt lgkmcnt(0)
    v_mfma_f32_32x32x16_bf16 v[32:47], v[84:87], v[64:67], v[32:47]
    ds_read_b128 v[64:67], v14 offset:4096
    s_waitcnt lgkmcnt(0)
    v_mfma_f32_32x32x16_bf16 v[32:47], v[88:91], v[64:67], v[32:47]
    ds_read_b128 v[64:67], v15 offset:4096
    s_waitcnt lgkmcnt(0)
    v_mfma_f32_32x32x16_bf16 v[32:47], v[92:95], v[64:67], v[32:47]
    ds_read_b128 v[64:67], v12 offset:5120
    s_waitcnt lgkmcnt(0)
    v_mfma_f32_32x32x16_bf16 v[32:47], v[96:99], v[64:67], v[32:47]
    ds_read_b128 v[64:67], v13 offset:5120
    s_waitcnt lgkmcnt(0)
    v_mfma_f32_32x32x16_bf16 v[32:47], v[100:103], v[64:67], v[32:47]
    ds_read_b128 v[64:67], v14 offset:5120
    s_waitcnt lgkmcnt(0)
    v_mfma_f32_32x32x16_bf16 v[32:47], v[104:107], v[64:67], v[32:47]
    ds_read_b128 v[64:67], v15 offset:5120
    s_waitcnt lgkmcnt(0)
    v_mfma_f32_32x32x16_bf16 v[32:47], v[108:111], v[64:67], v[32:47]
    ds_read_b128 v[64:67], v12 offset:6144
    s_waitcnt lgkmcnt(0)
    v_mfma_f32_32x32x16_bf16 v[32:47], v[112:115], v[64:67], v[32:47]
    ds_read_b128 v[64:67], v13 offset:6144
    s_waitcnt lgkmcnt(0)
    v_mfma_f32_32x32x16_bf16 v[32:47], v[116:119], v[64:67], v[32:47]
    ds_read_b128 v[64:67], v14 offset:6144
    s_waitcnt lgkmcnt(0)
    v_mfma_f32_32x32x16_bf16 v[32:47], v[120:123], v[64:67], v[32:47]
    ds_read_b128 v[64:67], v15 offset:6144
    s_waitcnt lgkmcnt(0)
    v_mfma_f32_32x32x16_bf16 v[32:47], v[124:127], v[64:67], v[32:47]
    ds_read_b128 v[64:67], v12 offset:7168
    s_waitcnt lgkmcnt(0)
    v_mfma_f32_32x32x16_bf16 v[32:47], v[128:131], v[64:67], v[32:47]
    ds_read_b128 v[64:67], v13 offset:7168
    s_waitcnt lgkmcnt(0)
    v_mfma_f32_32x32x16_bf16 v[32:47], v[132:135], v[64:67], v[32:47]
    ds_read_b128 v[64:67], v14 offset:7168
    s_waitcnt lgkmcnt(0)
    v_mfma_f32_32x32x16_bf16 v[32:47], v[136:139], v[64:67], v[32:47]
    ds_read_b128 v[64:67], v15 offset:7168
    s_waitcnt lgkmcnt(0)
    v_mfma_f32_32x32x16_bf16 v[32:47], v[140:143], v[64:67], v[32:47]
    s_nop 15
    s_nop 3
    v_mul_f32 v8, 0xbfb8aa3b, v32
    v_exp_f32 v8, v8
    s_nop 0
    v_add_f32 v8, 1.0, v8
    v_rcp_f32 v8, v8
    s_lshl_b32 s54, s20, 7
    s_add_u32 s54, s54, 117506048
    s_add_u32 s16, s4, s54
    s_addc_u32 s17, s5, 0
    v_lshlrev_b32 v9, 2, v0
    s_mov_b32 exec_hi, 0
    global_store_dword v9, v8, s[16:17]
    s_mov_b64 exec, -1
    s_waitcnt vmcnt(0)
L_nogate_39:
    s_add_u32 s20, s20, 3
    s_xor_b32 s23, s23, 32768
    s_add_u32 s21, s21, 1
    s_cmp_lt_u32 s21, s22
    s_cbranch_scc1 L_p1_loop
    s_waitcnt vmcnt(0)
    s_barrier
    s_cmp_lg_u32 s8, 0
    s_cbranch_scc1 L_nofl2_40
    v_mov_b32 v8, s22
    v_mov_b32 v9, 0
    s_mov_b64 exec, 1
    global_store_dword v9, v8, s[26:27] sc1
    s_mov_b64 exec, -1
L_nofl2_40:
    v_and_b32 v8, 7, v0
    v_lshlrev_b32 v8, 2, v8
    v_add_u32 v8, 32, v8
L_wclr_41:
    global_load_dword v9, v8, s[6:7] sc1
    s_waitcnt vmcnt(0)
    v_cmp_gt_u32 vcc, 32, v9
    s_sub_u32 s12, s12, 1
    s_cbranch_scc1 L_fail
    s_cbranch_vccnz L_wclr_41
L_f:
    s_mul_i32 s54, s10, 56
    s_add_u32 s14, s0, s54
    s_addc_u32 s15, s1, 0
    s_load_dwordx2 s[60:61], s[14:15], 16
    s_load_dwordx2 s[62:63], s[14:15], 40
    s_load_dwordx2 s[26:27], s[0:1], 120
    s_load_dwordx2 s[18:19], s[0:1], 0
    s_waitcnt lgkmcnt(0)
    s_lshl_b32 s54, s9, 8
    s_add_u32 s60, s60, s54
    s_addc_u32 s61, s61, 0
    s_lshl_b32 s54, s9, 17
    s_add_u32 s62, s62, s54
    s_addc_u32 s63, s63, 0
    v_lshlrev_b32 v1, 4, v0
    v_lshrrev_b32 v8, 3, v0
    s_lshl_b32 s54, s8, 3
    v_add_u32 v8, s54, v8
    v_bfe_u32 v9, v8, 1, 3
    v_and_b32 v2, 7, v0
    v_xor_b32 v2, v2, v9
    v_lshlrev_b32 v2, 4, v2
    v_lshl_add_u32 v2, v8, 10, v2
    v_and_b32 v8, 31, v0
    v_bfe_u32 v9, v8, 1, 3
    v_lshrrev_b32 v10, 5, v0
    v_xor_b32 v9, v9, v10
    v_lshlrev_b32 v9, 4, v9
    v_and_b32 v10, 7, v8
    v_lshl_add_u32 v9, v10, 7, v9
    v_lshrrev_b32 v10, 3, v8
    v_lshl_add_u32 v4, v10, 13, v9
    v_xor_b32 v5, 32, v4
    v_xor_b32 v6, 64, v4
    v_xor_b32 v7, 96, v4
    s_mov_b32 s20, s13
    s_lshl_b32 s54, s20, 15
    s_add_u32 s14, s18, s54
    s_addc_u32 s15, s19, 0
    s_lshl_b32 s54, s8, 13
    s_add_u32 s54, s54, 0
    s_add_u32 m0, s54, 0
    s_nop 0
    global_load_lds_dwordx4 v2, s[14:15] offset:0
    s_add_u32 m0, s54, 896
    s_nop 0
    global_load_lds_dwordx4 v2, s[14:15] offset:128
    s_add_u32 m0, s54, 1792
    s_nop 0
    global_load_lds_dwordx4 v2, s[14:15] offset:256
    s_add_u32 m0, s54, 2688
    s_nop 0
    global_load_lds_dwordx4 v2, s[14:15] offset:384
    s_add_u32 m0, s54, 3584
    s_nop 0
    global_load_lds_dwordx4 v2, s[14:15] offset:512
    s_add_u32 m0, s54, 4480
    s_nop 0
    global_load_lds_dwordx4 v2, s[14:15] offset:640
    s_add_u32 m0, s54, 5376
    s_nop 0
    global_load_lds_dwordx4 v2, s[14:15] offset:768
    s_add_u32 m0, s54, 6272
    s_nop 0
    global_load_lds_dwordx4 v2, s[14:15] offset:896
    s_cmp_eq_u32 s8, 1
    s_cbranch_scc1 L_fw1_44
    s_cmp_eq_u32 s8, 2
    s_cbranch_scc1 L_fw2_45
    s_cmp_eq_u32 s8, 3
    s_cbranch_scc1 L_fw3_46
L_fw0_43:
    v_lshrrev_b32 v8, 4, v0
    v_lshlrev_b32 v9, 2, v8
    v_and_b32 v10, 15, v0
    v_xor_b32 v10, v10, v9
    v_lshlrev_b32 v10, 4, v10
    v_add_u32 v8, 0, v8
    v_lshl_add_u32 v12, v8, 13, v10
    v_add_u32 v13, 32768, v12
    v_add_u32 v14, 65536, v12
    v_add_u32 v15, 98304, v12
    v_bfe_u32 v8, v0, 2, 2
    v_xor_b32 v9, 0, v8
    v_lshlrev_b32 v9, 6, v9
    v_lshrrev_b32 v10, 5, v0
    v_lshl_add_u32 v17, v10, 3, v8
    v_lshl_add_u32 v9, v17, 8, v9
    v_bfe_u32 v17, v0, 4, 1
    v_lshl_add_u32 v9, v17, 5, v9
    v_and_b32 v18, 3, v0
    v_lshl_add_u32 v11, v18, 3, v9
    v_lshl_add_u32 v19, v10, 2, v8
    v_lshlrev_b32 v19, 10, v19
    v_lshl_add_u32 v19, v8, 6, v19
    v_lshl_add_u32 v19, v17, 5, v19
    v_lshl_add_u32 v19, v18, 3, v19
    v_add_u32 v19, 32768, v19
    s_add_u32 s14, s60, 0
    s_addc_u32 s15, s61, 0
    s_mov_b32 m0, 32768
    s_nop 0
    global_load_lds_dwordx4 v12, s[14:15]
    s_mov_b32 m0, 33792
    s_nop 0
    global_load_lds_dwordx4 v13, s[14:15]
    s_mov_b32 m0, 34816
    s_nop 0
    global_load_lds_dwordx4 v14, s[14:15]
    s_mov_b32 m0, 35840
    s_nop 0
    global_load_lds_dwordx4 v15, s[14:15]
    s_add_u32 s14, s60, 524288
    s_addc_u32 s15, s61, 0
    s_mov_b32 m0, 49152
    s_nop 0
    global_load_lds_dwordx4 v12, s[14:15]
    s_mov_b32 m0, 50176
    s_nop 0
    global_load_lds_dwordx4 v13, s[14:15]
    s_mov_b32 m0, 51200
    s_nop 0
    global_load_lds_dwordx4 v14, s[14:15]
    s_mov_b32 m0, 52224
    s_nop 0
    global_load_lds_dwordx4 v15, s[14:15]
    s_add_u32 s14, s60, 1048576
    s_addc_u32 s15, s61, 0
    s_mov_b32 m0, 65536
    s_nop 0
    global_load_lds_dwordx4 v12, s[14:15]
    s_mov_b32 m0, 66560
    s_nop 0
    global_load_lds_dwordx4 v13, s[14:15]
    s_mov_b32 m0, 67584
    s_nop 0
    global_load_lds_dwordx4 v14, s[14:15]
    s_mov_b32 m0, 68608
    s_nop 0
    global_load_lds_dwordx4 v15, s[14:15]
    s_add_u32 s14, s60, 1572864
    s_addc_u32 s15, s61, 0
    s_mov_b32 m0, 81920
    s_nop 0
    global_load_lds_dwordx4 v12, s[14:15]
    s_mov_b32 m0, 82944
    s_nop 0
    global_load_lds_dwordx4 v13, s[14:15]
    s_mov_b32 m0, 83968
    s_nop 0
    global_load_lds_dwordx4 v14, s[14:15]
    s_mov_b32 m0, 84992
    s_nop 0
    global_load_lds_dwordx4 v15, s[14:15]
    s_add_u32 s14, s60, 2097152
    s_addc_u32 s15, s61, 0
    s_mov_b32 m0, 98304
    s_nop 0
    global_load_lds_dwordx4 v12, s[14:15]
    s_mov_b32 m0, 99328
    s_nop 0
    global_load_lds_dwordx4 v13, s[14:15]
    s_mov_b32 m0, 100352
    s_nop 0
    global_load_lds_dwordx4 v14, s[14:15]
    s_mov_b32 m0, 101376
    s_nop 0
    global_load_lds_dwordx4 v15, s[14:15]
    s_add_u32 s14, s60, 2621440
    s_addc_u32 s15, s61, 0
    s_mov_b32 m0, 114688
    s_nop 0
    global_load_lds_dwordx4 v12, s[14:15]
    s_mov_b32 m0, 115712
    s_nop 0
    global_load_lds_dwordx4 v13, s[14:15]
    s_mov_b32 m0, 116736
    s_nop 0
    global_load_lds_dwordx4 v14, s[14:15]
    s_mov_b32 m0, 117760
    s_nop 0
    global_load_lds_dwordx4 v15, s[14:15]
    s_add_u32 s14, s60, 3145728
    s_addc_u32 s15, s61, 0
    s_mov_b32 m0, 131072
    s_nop 0
    global_load_lds_dwordx4 v12, s[14:15]
    s_mov_b32 m0, 132096
    s_nop 0
    global_load_lds_dwordx4 v13, s[14:15]
    s_mov_b32 m0, 133120
    s_nop 0
    global_load_lds_dwordx4 v14, s[14:15]
    s_mov_b32 m0, 134144
    s_nop 0
    global_load_lds_dwordx4 v15, s[14:15]
    s_add_u32 s14, s60, 3670016
    s_addc_u32 s15, s61, 0
    s_mov_b32 m0, 147456
    s_nop 0
    global_load_lds_dwordx4 v12, s[14:15]
    s_mov_b32 m0, 148480
    s_nop 0
    global_load_lds_dwordx4 v13, s[14:15]
    s_mov_b32 m0, 149504
    s_nop 0
    global_load_lds_dwordx4 v14, s[14:15]
    s_mov_b32 m0, 150528
    s_nop 0
    global_load_lds_dwordx4 v15, s[14:15]
    s_waitcnt vmcnt(28)
    s_barrier
    v_add_u32 v16, 32768, v11
    ds_read_b64_tr_b16 a[0:1], v16 offset:0
    ds_read_b64_tr_b16 a[2:3], v16 offset:1024
    ds_read_b64_tr_b16 a[4:5], v16 offset:4096
    ds_read_b64_tr_b16 a[6:7], v16 offset:5120
    ds_read_b64_tr_b16 a[8:9], v16 offset:8192
    ds_read_b64_tr_b16 a[10:11], v16 offset:9216
    ds_read_b64_tr_b16 a[12:13], v16 offset:12288
    ds_read_b64_tr_b16 a[14:15], v16 offset:13312
    s_waitcnt lgkmcnt(0)
    s_barrier
    s_add_u32 s14, s62, 0
    s_addc_u32 s15, s63, 0
    v_xor_b32 v20, 0, v1
    s_mov_b32 m0, 32768
    s_nop 0
    global_load_lds_dwordx4 v20, s[14:15]
    s_add_u32 s14, s62, 1024
    s_addc_u32 s15, s63, 0
    v_xor_b32 v20, 64, v1
    s_mov_b32 m0, 33792
    s_nop 0
    global_load_lds_dwordx4 v20, s[14:15]
    s_add_u32 s14, s62, 2048
    s_addc_u32 s15, s63, 0
    v_xor_b32 v20, 128, v1
    s_mov_b32 m0, 34816
    s_nop 0
    global_load_lds_dwordx4 v20, s[14:15]
    s_add_u32 s14, s62, 3072
    s_addc_u32 s15, s63, 0
    v_xor_b32 v20, 192, v1
    s_mov_b32 m0, 35840
    s_nop 0
    global_load_lds_dwordx4 v20, s[14:15]
    s_waitcnt vmcnt(28)
    s_barrier
    v_add_u32 v16, 49152, v11
    ds_read_b64_tr_b16 a[16:17], v16 offset:0
    ds_read_b64_tr_b16 a[18:19], v16 offset:1024
    ds_read_b64_tr_b16 a[20:21], v16 offset:4096
    ds_read_b64_tr_b16 a[22:23], v16 offset:5120
    ds_read_b64_tr_b16 a[24:25], v16 offset:8192
    ds_read_b64_tr_b16 a[26:27], v16 offset:9216
    ds_read_b64_tr_b16 a[28:29], v16 offset:12288
    ds_read_b64_tr_b16 a[30:31], v16 offset:13312
    s_waitcnt lgkmcnt(0)
    s_barrier
    s_add_u32 s14, s62, 16384
    s_addc_u32 s15, s63, 0
    v_xor_b32 v20, 0, v1
    s_mov_b32 m0, 49152
    s_nop 0
    global_load_lds_dwordx4 v20, s[14:15]
    s_add_u32 s14, s62, 17408
    s_addc_u32 s15, s63, 0
    v_xor_b32 v20, 64, v1
    s_mov_b32 m0, 50176
    s_nop 0
    global_load_lds_dwordx4 v20, s[14:15]
    s_add_u32 s14, s62, 18432
    s_addc_u32 s15, s63, 0
    v_xor_b32 v20, 128, v1
    s_mov_b32 m0, 51200
    s_nop 0
    global_load_lds_dwordx4 v20, s[14:15]
    s_add_u32 s14, s62, 19456
    s_addc_u32 s15, s63, 0
    v_xor_b32 v20, 192, v1
    s_mov_b32 m0, 52224
    s_nop 0
    global_load_lds_dwordx4 v20, s[14:15]
    s_waitcnt vmcnt(28)
    s_barrier
    v_add_u32 v16, 65536, v11
    ds_read_b64_tr_b16 a[32:33], v16 offset:0
    ds_read_b64_tr_b16 a[34:35], v16 offset:1024
    ds_read_b64_tr_b16 a[36:37], v16 offset:4096
    ds_read_b64_tr_b16 a[38:39], v16 offset:5120
    ds_read_b64_tr_b16 a[40:41], v16 offset:8192
    ds_read_b64_tr_b16 a[42:43], v16 offset:9216
    ds_read_b64_tr_b16 a[44:45], v16 offset:12288
    ds_read_b64_tr_b16 a[46:47], v16 offset:13312
    s_waitcnt lgkmcnt(0)
    s_barrier
    s_add_u32 s14, s62, 32768
    s_addc_u32 s15, s63, 0
    v_xor_b32 v20, 0, v1
    s_mov_b32 m0, 65536
    s_nop 0
    global_load_lds_dwordx4 v20, s[14:15]
    s_add_u32 s14, s62, 33792
    s_addc_u32 s15, s63, 0
    v_xor_b32 v20, 64, v1
    s_mov_b32 m0, 66560
    s_nop 0
    global_load_lds_dwordx4 v20, s[14:15]
    s_add_u32 s14, s62, 34816
    s_addc_u32 s15, s63, 0
    v_xor_b32 v20, 128, v1
    s_mov_b32 m0, 67584
    s_nop 0
    global_load_lds_dwordx4 v20, s[14:15]
    s_add_u32 s14, s62, 35840
    s_addc_u32 s15, s63, 0
    v_xor_b32 v20, 192, v1
    s_mov_b32 m0, 68608
    s_nop 0
    global_load_lds_dwordx4 v20, s[14:15]
    s_waitcnt vmcnt(28)
    s_barrier
    v_add_u32 v16, 81920, v11
    ds_read_b64_tr_b16 a[48:49], v16 offset:0
    ds_read_b64_tr_b16 a[50:51], v16 offset:1024
    ds_read_b64_tr_b16 a[52:53], v16 offset:4096
    ds_read_b64_tr_b16 a[54:55], v16 offset:5120
    ds_read_b64_tr_b16 a[56:57], v16 offset:8192
    ds_read_b64_tr_b16 a[58:59], v16 offset:9216
    ds_read_b64_tr_b16 a[60:61], v16 offset:12288
    ds_read_b64_tr_b16 a[62:63], v16 offset:13312
    s_waitcnt lgkmcnt(0)
    s_barrier
    s_add_u32 s14, s62, 49152
    s_addc_u32 s15, s63, 0
    v_xor_b32 v20, 0, v1
    s_mov_b32 m0, 81920
    s_nop 0
    global_load_lds_dwordx4 v20, s[14:15]
    s_add_u32 s14, s62, 50176
    s_addc_u32 s15, s63, 0
    v_xor_b32 v20, 64, v1
    s_mov_b32 m0, 82944
    s_nop 0
    global_load_lds_dwordx4 v20, s[14:15]
    s_add_u32 s14, s62, 51200
    s_addc_u32 s15, s63, 0
    v_xor_b32 v20, 128, v1
    s_mov_b32 m0, 83968
    s_nop 0
    global_load_lds_dwordx4 v20, s[14:15]
    s_add_u32 s14, s62, 52224
    s_addc_u32 s15, s63, 0
    v_xor_b32 v20, 192, v1
    s_mov_b32 m0, 84992
    s_nop 0
    global_load_lds_dwordx4 v20, s[14:15]
    s_waitcnt vmcnt(28)
    s_barrier
    v_add_u32 v16, 98304, v11
    ds_read_b64_tr_b16 a[64:65], v16 offset:0
    ds_read_b64_tr_b16 a[66:67], v16 offset:1024
    ds_read_b64_tr_b16 a[68:69], v16 offset:4096
    ds_read_b64_tr_b16 a[70:71], v16 offset:5120
    ds_read_b64_tr_b16 a[72:73], v16 offset:8192
    ds_read_b64_tr_b16 a[74:75], v16 offset:9216
    ds_read_b64_tr_b16 a[76:77], v16 offset:12288
    ds_read_b64_tr_b16 a[78:79], v16 offset:13312
    s_waitcnt lgkmcnt(0)
    s_barrier
    s_add_u32 s14, s62, 65536
    s_addc_u32 s15, s63, 0
    v_xor_b32 v20, 0, v1
    s_mov_b32 m0, 98304
    s_nop 0
    global_load_lds_dwordx4 v20, s[14:15]
    s_add_u32 s14, s62, 66560
    s_addc_u32 s15, s63, 0
    v_xor_b32 v20, 64, v1
    s_mov_b32 m0, 99328
    s_nop 0
    global_load_lds_dwordx4 v20, s[14:15]
    s_add_u32 s14, s62, 67584
    s_addc_u32 s15, s63, 0
    v_xor_b32 v20, 128, v1
    s_mov_b32 m0, 100352
    s_nop 0
    global_load_lds_dwordx4 v20, s[14:15]
    s_add_u32 s14, s62, 68608
    s_addc_u32 s15, s63, 0
    v_xor_b32 v20, 192, v1
    s_mov_b32 m0, 101376
    s_nop 0
    global_load_lds_dwordx4 v20, s[14:15]
    s_waitcnt vmcnt(28)
    s_barrier
    v_add_u32 v16, 114688, v11
    ds_read_b64_tr_b16 a[80:81], v16 offset:0
    ds_read_b64_tr_b16 a[82:83], v16 offset:1024
    ds_read_b64_tr_b16 a[84:85], v16 offset:4096
    ds_read_b64_tr_b16 a[86:87], v16 offset:5120
    ds_read_b64_tr_b16 a[88:89], v16 offset:8192
    ds_read_b64_tr_b16 a[90:91], v16 offset:9216
    ds_read_b64_tr_b16 a[92:93], v16 offset:12288
    ds_read_b64_tr_b16 a[94:95], v16 offset:13312
    s_waitcnt lgkmcnt(0)
    s_barrier
    s_add_u32 s14, s62, 81920
    s_addc_u32 s15, s63, 0
    v_xor_b32 v20, 0, v1
    s_mov_b32 m0, 114688
    s_nop 0
    global_load_lds_dwordx4 v20, s[14:15]
    s_add_u32 s14, s62, 82944
    s_addc_u32 s15, s63, 0
    v_xor_b32 v20, 64, v1
    s_mov_b32 m0, 115712
    s_nop 0
    global_load_lds_dwordx4 v20, s[14:15]
    s_add_u32 s14, s62, 83968
    s_addc_u32 s15, s63, 0
    v_xor_b32 v20, 128, v1
    s_mov_b32 m0, 116736
    s_nop 0
    global_load_lds_dwordx4 v20, s[14:15]
    s_add_u32 s14, s62, 84992
    s_addc_u32 s15, s63, 0
    v_xor_b32 v20, 192, v1
    s_mov_b32 m0, 117760
    s_nop 0
    global_load_lds_dwordx4 v20, s[14:15]
    s_waitcnt vmcnt(28)
    s_barrier
    v_add_u32 v16, 131072, v11
    ds_read_b64_tr_b16 a[96:97], v16 offset:0
    ds_read_b64_tr_b16 a[98:99], v16 offset:1024
    ds_read_b64_tr_b16 a[100:101], v16 offset:4096
    ds_read_b64_tr_b16 a[102:103], v16 offset:5120
    ds_read_b64_tr_b16 a[104:105], v16 offset:8192
    ds_read_b64_tr_b16 a[106:107], v16 offset:9216
    ds_read_b64_tr_b16 a[108:109], v16 offset:12288
    ds_read_b64_tr_b16 a[110:111], v16 offset:13312
    s_waitcnt lgkmcnt(0)
    s_barrier
    s_add_u32 s14, s62, 98304
    s_addc_u32 s15, s63, 0
    v_xor_b32 v20, 0, v1
    s_mov_b32 m0, 131072
    s_nop 0
    global_load_lds_dwordx4 v20, s[14:15]
    s_add_u32 s14, s62, 99328
    s_addc_u32 s15, s63, 0
    v_xor_b32 v20, 64, v1
    s_mov_b32 m0, 132096
    s_nop 0
    global_load_lds_dwordx4 v20, s[14:15]
    s_add_u32 s14, s62, 100352
    s_addc_u32 s15, s63, 0
    v_xor_b32 v20, 128, v1
    s_mov_b32 m0, 133120
    s_nop 0
    global_load_lds_dwordx4 v20, s[14:15]
    s_add_u32 s14, s62, 101376
    s_addc_u32 s15, s63, 0
    v_xor_b32 v20, 192, v1
    s_mov_b32 m0, 134144
    s_nop 0
    global_load_lds_dwordx4 v20, s[14:15]
    s_waitcnt vmcnt(28)
    s_barrier
    v_add_u32 v16, 147456, v11
    ds_read_b64_tr_b16 a[112:113], v16 offset:0
    ds_read_b64_tr_b16 a[114:115], v16 offset:1024
    ds_read_b64_tr_b16 a[116:117], v16 offset:4096
    ds_read_b64_tr_b16 a[118:119], v16 offset:5120
    ds_read_b64_tr_b16 a[120:121], v16 offset:8192
    ds_read_b64_tr_b16 a[122:123], v16 offset:9216
    ds_read_b64_tr_b16 a[124:125], v16 offset:12288
    ds_read_b64_tr_b16 a[126:127], v16 offset:13312
    s_waitcnt lgkmcnt(0)
    s_barrier
    s_add_u32 s14, s62, 114688
    s_addc_u32 s15, s63, 0
    v_xor_b32 v20, 0, v1
    s_mov_b32 m0, 147456
    s_nop 0
    global_load_lds_dwordx4 v20, s[14:15]
    s_add_u32 s14, s62, 115712
    s_addc_u32 s15, s63, 0
    v_xor_b32 v20, 64, v1
    s_mov_b32 m0, 148480
    s_nop 0
    global_load_lds_dwordx4 v20, s[14:15]
    s_add_u32 s14, s62, 116736
    s_addc_u32 s15, s63, 0
    v_xor_b32 v20, 128, v1
    s_mov_b32 m0, 149504
    s_nop 0
    global_load_lds_dwordx4 v20, s[14:15]
    s_add_u32 s14, s62, 117760
    s_addc_u32 s15, s63, 0
    v_xor_b32 v20, 192, v1
    s_mov_b32 m0, 150528
    s_nop 0
    global_load_lds_dwordx4 v20, s[14:15]
    s_waitcnt vmcnt(24)
    s_barrier
    v_xor_b32 v16, 0, v19
    v_add_u32 v16, 0, v16
    ds_read_b64_tr_b16 a[128:129], v16 offset:0
    ds_read_b64_tr_b16 a[130:131], v16 offset:16384
    ds_read_b64_tr_b16 a[132:133], v16 offset:8192
    ds_read_b64_tr_b16 a[134:135], v16 offset:24576
    v_xor_b32 v16, 64, v19
    v_add_u32 v16, 0, v16
    ds_read_b64_tr_b16 a[160:161], v16 offset:0
    ds_read_b64_tr_b16 a[162:163], v16 offset:16384
    ds_read_b64_tr_b16 a[164:165], v16 offset:8192
    ds_read_b64_tr_b16 a[166:167], v16 offset:24576
    v_xor_b32 v16, 128, v19
    v_add_u32 v16, 0, v16
    ds_read_b64_tr_b16 a[192:193], v16 offset:0
    ds_read_b64_tr_b16 a[194:195], v16 offset:16384
    ds_read_b64_tr_b16 a[196:197], v16 offset:8192
    ds_read_b64_tr_b16 a[198:199], v16 offset:24576
    v_xor_b32 v16, 192, v19
    v_add_u32 v16, 0, v16
    ds_read_b64_tr_b16 a[224:225], v16 offset:0
    ds_read_b64_tr_b16 a[226:227], v16 offset:16384
    ds_read_b64_tr_b16 a[228:229], v16 offset:8192
    ds_read_b64_tr_b16 a[230:231], v16 offset:24576
    s_waitcnt lgkmcnt(0)
    s_waitcnt vmcnt(16)
    s_barrier
    v_xor_b32 v16, 0, v19
    v_add_u32 v16, 32768, v16
    ds_read_b64_tr_b16 a[136:137], v16 offset:0
    ds_read_b64_tr_b16 a[138:139], v16 offset:16384
    ds_read_b64_tr_b16 a[140:141], v16 offset:8192
    ds_read_b64_tr_b16 a[142:143], v16 offset:24576
    v_xor_b32 v16, 64, v19
    v_add_u32 v16, 32768, v16
    ds_read_b64_tr_b16 a[168:169], v16 offset:0
    ds_read_b64_tr_b16 a[170:171], v16 offset:16384
    ds_read_b64_tr_b16 a[172:173], v16 offset:8192
    ds_read_b64_tr_b16 a[174:175], v16 offset:24576
    v_xor_b32 v16, 128, v19
    v_add_u32 v16, 32768, v16
    ds_read_b64_tr_b16 a[200:201], v16 offset:0
    ds_read_b64_tr_b16 a[202:203], v16 offset:16384
    ds_read_b64_tr_b16 a[204:205], v16 offset:8192
    ds_read_b64_tr_b16 a[206:207], v16 offset:24576
    v_xor_b32 v16, 192, v19
    v_add_u32 v16, 32768, v16
    ds_read_b64_tr_b16 a[232:233], v16 offset:0
    ds_read_b64_tr_b16 a[234:235], v16 offset:16384
    ds_read_b64_tr_b16 a[236:237], v16 offset:8192
    ds_read_b64_tr_b16 a[238:239], v16 offset:24576
    s_waitcnt lgkmcnt(0)
    s_waitcnt vmcnt(8)
    s_barrier
    v_xor_b32 v16, 0, v19
    v_add_u32 v16, 65536, v16
    ds_read_b64_tr_b16 a[144:145], v16 offset:0
    ds_read_b64_tr_b16 a[146:147], v16 offset:16384
    ds_read_b64_tr_b16 a[148:149], v16 offset:8192
    ds_read_b64_tr_b16 a[150:151], v16 offset:24576
    v_xor_b32 v16, 64, v19
    v_add_u32 v16, 65536, v16
    ds_read_b64_tr_b16 a[176:177], v16 offset:0
    ds_read_b64_tr_b16 a[178:179], v16 offset:16384
    ds_read_b64_tr_b16 a[180:181], v16 offset:8192
    ds_read_b64_tr_b16 a[182:183], v16 offset:24576
    v_xor_b32 v16, 128, v19
    v_add_u32 v16, 65536, v16
    ds_read_b64_tr_b16 a[208:209], v16 offset:0
    ds_read_b64_tr_b16 a[210:211], v16 offset:16384
    ds_read_b64_tr_b16 a[212:213], v16 offset:8192
    ds_read_b64_tr_b16 a[214:215], v16 offset:24576
    v_xor_b32 v16, 192, v19
    v_add_u32 v16, 65536, v16
    ds_read_b64_tr_b16 a[240:241], v16 offset:0
    ds_read_b64_tr_b16 a[242:243], v16 offset:16384
    ds_read_b64_tr_b16 a[244:245], v16 offset:8192
    ds_read_b64_tr_b16 a[246:247], v16 offset:24576
    s_waitcnt lgkmcnt(0)
    s_waitcnt vmcnt(0)
    s_barrier
    v_xor_b32 v16, 0, v19
    v_add_u32 v16, 98304, v16
    ds_read_b64_tr_b16 a[152:153], v16 offset:0
    ds_read_b64_tr_b16 a[154:155], v16 offset:16384
    ds_read_b64_tr_b16 a[156:157], v16 offset:8192
    ds_read_b64_tr_b16 a[158:159], v16 offset:24576
    v_xor_b32 v16, 64, v19
    v_add_u32 v16, 98304, v16
    ds_read_b64_tr_b16 a[184:185], v16 offset:0
    ds_read_b64_tr_b16 a[186:187], v16 offset:16384
    ds_read_b64_tr_b16 a[188:189], v16 offset:8192
    ds_read_b64_tr_b16 a[190:191], v16 offset:24576
    v_xor_b32 v16, 128, v19
    v_add_u32 v16, 98304, v16
    ds_read_b64_tr_b16 a[216:217], v16 offset:0
    ds_read_b64_tr_b16 a[218:219], v16 offset:16384
    ds_read_b64_tr_b16 a[220:221], v16 offset:8192
    ds_read_b64_tr_b16 a[222:223], v16 offset:24576
    v_xor_b32 v16, 192, v19
    v_add_u32 v16, 98304, v16
    ds_read_b64_tr_b16 a[248:249], v16 offset:0
    ds_read_b64_tr_b16 a[250:251], v16 offset:16384
    ds_read_b64_tr_b16 a[252:253], v16 offset:8192
    ds_read_b64_tr_b16 a[254:255], v16 offset:24576
    s_waitcnt lgkmcnt(0)
    s_barrier
    s_branch L_fw_42
L_fw1_44:
    v_lshrrev_b32 v8, 4, v0
    v_lshlrev_b32 v9, 2, v8
    v_and_b32 v10, 15, v0
    v_xor_b32 v10, v10, v9
    v_lshlrev_b32 v10, 4, v10
    v_add_u32 v8, 16, v8
    v_lshl_add_u32 v12, v8, 13, v10
    v_add_u32 v13, 32768, v12
    v_add_u32 v14, 65536, v12
    v_add_u32 v15, 98304, v12
    v_bfe_u32 v8, v0, 2, 2
    v_xor_b32 v9, 1, v8
    v_lshlrev_b32 v9, 6, v9
    v_lshrrev_b32 v10, 5, v0
    v_lshl_add_u32 v17, v10, 3, v8
    v_lshl_add_u32 v9, v17, 8, v9
    v_bfe_u32 v17, v0, 4, 1
    v_lshl_add_u32 v9, v17, 5, v9
    v_and_b32 v18, 3, v0
    v_lshl_add_u32 v11, v18, 3, v9
    v_lshl_add_u32 v19, v10, 2, v8
    v_lshlrev_b32 v19, 10, v19
    v_lshl_add_u32 v19, v8, 6, v19
    v_lshl_add_u32 v19, v17, 5, v19
    v_lshl_add_u32 v19, v18, 3, v19
    v_add_u32 v19, 33024, v19
    s_add_u32 s14, s60, 0
    s_addc_u32 s15, s61, 0
    s_mov_b32 m0, 36864
    s_nop 0
    global_load_lds_dwordx4 v12, s[14:15]
    s_mov_b32 m0, 37888
    s_nop 0
    global_load_lds_dwordx4 v13, s[14:15]
    s_mov_b32 m0, 38912
    s_nop 0
    global_load_lds_dwordx4 v14, s[14:15]
    s_mov_b32 m0, 39936
    s_nop 0
    global_load_lds_dwordx4 v15, s[14:15]
    s_add_u32 s14, s60, 524288
    s_addc_u32 s15, s61, 0
    s_mov_b32 m0, 53248
    s_nop 0
    global_load_lds_dwordx4 v12, s[14:15]
    s_mov_b32 m0, 54272
    s_nop 0
    global_load_lds_dwordx4 v13, s[14:15]
    s_mov_b32 m0, 55296
    s_nop 0
    global_load_lds_dwordx4 v14, s[14:15]
    s_mov_b32 m0, 56320
    s_nop 0
    global_load_lds_dwordx4 v15, s[14:15]
    s_add_u32 s14, s60, 1048576
    s_addc_u32 s15, s61, 0
    s_mov_b32 m0, 69632
    s_nop 0
    global_load_lds_dwordx4 v12, s[14:15]
    s_mov_b32 m0, 70656
    s_nop 0
    global_load_lds_dwordx4 v13, s[14:15]
    s_mov_b32 m0, 71680
    s_nop 0
    global_load_lds_dwordx4 v14, s[14:15]
    s_mov_b32 m0, 72704
    s_nop 0
    global_load_lds_dwordx4 v15, s[14:15]
    s_add_u32 s14, s60, 1572864
    s_addc_u32 s15, s61, 0
    s_mov_b32 m0, 86016
    s_nop 0
    global_load_lds_dwordx4 v12, s[14:15]
    s_mov_b32 m0, 87040
    s_nop 0
    global_load_lds_dwordx4 v13, s[14:15]
    s_mov_b32 m0, 88064
    s_nop 0
    global_load_lds_dwordx4 v14, s[14:15]
    s_mov_b32 m0, 89088
    s_nop 0
    global_load_lds_dwordx4 v15, s[14:15]
    s_add_u32 s14, s60, 2097152
    s_addc_u32 s15, s61, 0
    s_mov_b32 m0, 102400
    s_nop 0
    global_load_lds_dwordx4 v12, s[14:15]
    s_mov_b32 m0, 103424
    s_nop 0
    global_load_lds_dwordx4 v13, s[14:15]
    s_mov_b32 m0, 104448
    s_nop 0
    global_load_lds_dwordx4 v14, s[14:15]
    s_mov_b32 m0, 105472
    s_nop 0
    global_load_lds_dwordx4 v15, s[14:15]
    s_add_u32 s14, s60, 2621440
    s_addc_u32 s15, s61, 0
    s_mov_b32 m0, 118784
    s_nop 0
    global_load_lds_dwordx4 v12, s[14:15]
    s_mov_b32 m0, 119808
    s_nop 0
    global_load_lds_dwordx4 v13, s[14:15]
    s_mov_b32 m0, 120832
    s_nop 0
    global_load_lds_dwordx4 v14, s[14:15]
    s_mov_b32 m0, 121856
    s_nop 0
    global_load_lds_dwordx4 v15, s[14:15]
    s_add_u32 s14, s60, 3145728
    s_addc_u32 s15, s61, 0
    s_mov_b32 m0, 135168
    s_nop 0
    global_load_lds_dwordx4 v12, s[14:15]
    s_mov_b32 m0, 136192
    s_nop 0
    global_load_lds_dwordx4 v13, s[14:15]
    s_mov_b32 m0, 137216
    s_nop 0
    global_load_lds_dwordx4 v14, s[14:15]
    s_mov_b32 m0, 138240
    s_nop 0
    global_load_lds_dwordx4 v15, s[14:15]
    s_add_u32 s14, s60, 3670016
    s_addc_u32 s15, s61, 0
    s_mov_b32 m0, 151552
    s_nop 0
    global_load_lds_dwordx4 v12, s[14:15]
    s_mov_b32 m0, 152576
    s_nop 0
    global_load_lds_dwordx4 v13, s[14:15]
    s_mov_b32 m0, 153600
    s_nop 0
    global_load_lds_dwordx4 v14, s[14:15]
    s_mov_b32 m0, 154624
    s_nop 0
    global_load_lds_dwordx4 v15, s[14:15]
    s_waitcnt vmcnt(28)
    s_barrier
    v_add_u32 v16, 32768, v11
    ds_read_b64_tr_b16 a[0:1], v16 offset:0
    ds_read_b64_tr_b16 a[2:3], v16 offset:1024
    ds_read_b64_tr_b16 a[4:5], v16 offset:4096
    ds_read_b64_tr_b16 a[6:7], v16 offset:5120
    ds_read_b64_tr_b16 a[8:9], v16 offset:8192
    ds_read_b64_tr_b16 a[10:11], v16 offset:9216
    ds_read_b64_tr_b16 a[12:13], v16 offset:12288
    ds_read_b64_tr_b16 a[14:15], v16 offset:13312
    s_waitcnt lgkmcnt(0)
    s_barrier
    s_add_u32 s14, s62, 4096
    s_addc_u32 s15, s63, 0
    v_xor_b32 v20, 0, v1
    s_mov_b32 m0, 36864
    s_nop 0
    global_load_lds_dwordx4 v20, s[14:15]
    s_add_u32 s14, s62, 5120
    s_addc_u32 s15, s63, 0
    v_xor_b32 v20, 64, v1
    s_mov_b32 m0, 37888
    s_nop 0
    global_load_lds_dwordx4 v20, s[14:15]
    s_add_u32 s14, s62, 6144
    s_addc_u32 s15, s63, 0
    v_xor_b32 v20, 128, v1
    s_mov_b32 m0, 38912
    s_nop 0
    global_load_lds_dwordx4 v20, s[14:15]
    s_add_u32 s14, s62, 7168
    s_addc_u32 s15, s63, 0
    v_xor_b32 v20, 192, v1
    s_mov_b32 m0, 39936
    s_nop 0
    global_load_lds_dwordx4 v20, s[14:15]
    s_waitcnt vmcnt(28)
    s_barrier
    v_add_u32 v16, 49152, v11
    ds_read_b64_tr_b16 a[16:17], v16 offset:0
    ds_read_b64_tr_b16 a[18:19], v16 offset:1024
    ds_read_b64_tr_b16 a[20:21], v16 offset:4096
    ds_read_b64_tr_b16 a[22:23], v16 offset:5120
    ds_read_b64_tr_b16 a[24:25], v16 offset:8192
    ds_read_b64_tr_b16 a[26:27], v16 offset:9216
    ds_read_b64_tr_b16 a[28:29], v16 offset:12288
    ds_read_b64_tr_b16 a[30:31], v16 offset:13312
    s_waitcnt lgkmcnt(0)
    s_barrier
    s_add_u32 s14, s62, 20480
    s_addc_u32 s15, s63, 0
    v_xor_b32 v20, 0, v1
    s_mov_b32 m0, 53248
    s_nop 0
    global_load_lds_dwordx4 v20, s[14:15]
    s_add_u32 s14, s62, 21504
    s_addc_u32 s15, s63, 0
    v_xor_b32 v20, 64, v1
    s_mov_b32 m0, 54272
    s_nop 0
    global_load_lds_dwordx4 v20, s[14:15]
    s_add_u32 s14, s62, 22528
    s_addc_u32 s15, s63, 0
    v_xor_b32 v20, 128, v1
    s_mov_b32 m0, 55296
    s_nop 0
    global_load_lds_dwordx4 v20, s[14:15]
    s_add_u32 s14, s62, 23552
    s_addc_u32 s15, s63, 0
    v_xor_b32 v20, 192, v1
    s_mov_b32 m0, 56320
    s_nop 0
    global_load_lds_dwordx4 v20, s[14:15]
    s_waitcnt vmcnt(28)
    s_barrier
    v_add_u32 v16, 65536, v11
    ds_read_b64_tr_b16 a[32:33], v16 offset:0
    ds_read_b64_tr_b16 a[34:35], v16 offset:1024
    ds_read_b64_tr_b16 a[36:37], v16 offset:4096
    ds_read_b64_tr_b16 a[38:39], v16 offset:5120
    ds_read_b64_tr_b16 a[40:41], v16 offset:8192
    ds_read_b64_tr_b16 a[42:43], v16 offset:9216
    ds_read_b64_tr_b16 a[44:45], v16 offset:12288
    ds_read_b64_tr_b16 a[46:47], v16 offset:13312
    s_waitcnt lgkmcnt(0)
    s_barrier
    s_add_u32 s14, s62, 36864
    s_addc_u32 s15, s63, 0
    v_xor_b32 v20, 0, v1
    s_mov_b32 m0, 69632
    s_nop 0
    global_load_lds_dwordx4 v20, s[14:15]
    s_add_u32 s14, s62, 37888
    s_addc_u32 s15, s63, 0
    v_xor_b32 v20, 64, v1
    s_mov_b32 m0, 70656
    s_nop 0
    global_load_lds_dwordx4 v20, s[14:15]
    s_add_u32 s14, s62, 38912
    s_addc_u32 s15, s63, 0
    v_xor_b32 v20, 128, v1
    s_mov_b32 m0, 71680
    s_nop 0
    global_load_lds_dwordx4 v20, s[14:15]
    s_add_u32 s14, s62, 39936
    s_addc_u32 s15, s63, 0
    v_xor_b32 v20, 192, v1
    s_mov_b32 m0, 72704
    s_nop 0
    global_load_lds_dwordx4 v20, s[14:15]
    s_waitcnt vmcnt(28)
    s_barrier
    v_add_u32 v16, 81920, v11
    ds_read_b64_tr_b16 a[48:49], v16 offset:0
    ds_read_b64_tr_b16 a[50:51], v16 offset:1024
    ds_read_b64_tr_b16 a[52:53], v16 offset:4096
    ds_read_b64_tr_b16 a[54:55], v16 offset:5120
    ds_read_b64_tr_b16 a[56:57], v16 offset:8192
    ds_read_b64_tr_b16 a[58:59], v16 offset:9216
    ds_read_b64_tr_b16 a[60:61], v16 offset:12288
    ds_read_b64_tr_b16 a[62:63], v16 offset:13312
    s_waitcnt lgkmcnt(0)
    s_barrier
    s_add_u32 s14, s62, 53248
    s_addc_u32 s15, s63, 0
    v_xor_b32 v20, 0, v1
    s_mov_b32 m0, 86016
    s_nop 0
    global_load_lds_dwordx4 v20, s[14:15]
    s_add_u32 s14, s62, 54272
    s_addc_u32 s15, s63, 0
    v_xor_b32 v20, 64, v1
    s_mov_b32 m0, 87040
    s_nop 0
    global_load_lds_dwordx4 v20, s[14:15]
    s_add_u32 s14, s62, 55296
    s_addc_u32 s15, s63, 0
    v_xor_b32 v20, 128, v1
    s_mov_b32 m0, 88064
    s_nop 0
    global_load_lds_dwordx4 v20, s[14:15]
    s_add_u32 s14, s62, 56320
    s_addc_u32 s15, s63, 0
    v_xor_b32 v20, 192, v1
    s_mov_b32 m0, 89088
    s_nop 0
    global_load_lds_dwordx4 v20, s[14:15]
    s_waitcnt vmcnt(28)
    s_barrier
    v_add_u32 v16, 98304, v11
    ds_read_b64_tr_b16 a[64:65], v16 offset:0
    ds_read_b64_tr_b16 a[66:67], v16 offset:1024
    ds_read_b64_tr_b16 a[68:69], v16 offset:4096
    ds_read_b64_tr_b16 a[70:71], v16 offset:5120
    ds_read_b64_tr_b16 a[72:73], v16 offset:8192
    ds_read_b64_tr_b16 a[74:75], v16 offset:9216
    ds_read_b64_tr_b16 a[76:77], v16 offset:12288
    ds_read_b64_tr_b16 a[78:79], v16 offset:13312
    s_waitcnt lgkmcnt(0)
    s_barrier
    s_add_u32 s14, s62, 69632
    s_addc_u32 s15, s63, 0
    v_xor_b32 v20, 0, v1
    s_mov_b32 m0, 102400
    s_nop 0
    global_load_lds_dwordx4 v20, s[14:15]
    s_add_u32 s14, s62, 70656
    s_addc_u32 s15, s63, 0
    v_xor_b32 v20, 64, v1
    s_mov_b32 m0, 103424
    s_nop 0
    global_load_lds_dwordx4 v20, s[14:15]
    s_add_u32 s14, s62, 71680
    s_addc_u32 s15, s63, 0
    v_xor_b32 v20, 128, v1
    s_mov_b32 m0, 104448
    s_nop 0
    global_load_lds_dwordx4 v20, s[14:15]
    s_add_u32 s14, s62, 72704
    s_addc_u32 s15, s63, 0
    v_xor_b32 v20, 192, v1
    s_mov_b32 m0, 105472
    s_nop 0
    global_load_lds_dwordx4 v20, s[14:15]
    s_waitcnt vmcnt(28)
    s_barrier
    v_add_u32 v16, 114688, v11
    ds_read_b64_tr_b16 a[80:81], v16 offset:0
    ds_read_b64_tr_b16 a[82:83], v16 offset:1024
    ds_read_b64_tr_b16 a[84:85], v16 offset:4096
    ds_read_b64_tr_b16 a[86:87], v16 offset:5120
    ds_read_b64_tr_b16 a[88:89], v16 offset:8192
    ds_read_b64_tr_b16 a[90:91], v16 offset:9216
    ds_read_b64_tr_b16 a[92:93], v16 offset:12288
    ds_read_b64_tr_b16 a[94:95], v16 offset:13312
    s_waitcnt lgkmcnt(0)
    s_barrier
    s_add_u32 s14, s62, 86016
    s_addc_u32 s15, s63, 0
    v_xor_b32 v20, 0, v1
    s_mov_b32 m0, 118784
    s_nop 0
    global_load_lds_dwordx4 v20, s[14:15]
    s_add_u32 s14, s62, 87040
    s_addc_u32 s15, s63, 0
    v_xor_b32 v20, 64, v1
    s_mov_b32 m0, 119808
    s_nop 0
    global_load_lds_dwordx4 v20, s[14:15]
    s_add_u32 s14, s62, 88064
    s_addc_u32 s15, s63, 0
    v_xor_b32 v20, 128, v1
    s_mov_b32 m0, 120832
    s_nop 0
    global_load_lds_dwordx4 v20, s[14:15]
    s_add_u32 s14, s62, 89088
    s_addc_u32 s15, s63, 0
    v_xor_b32 v20, 192, v1
    s_mov_b32 m0, 121856
    s_nop 0
    global_load_lds_dwordx4 v20, s[14:15]
    s_waitcnt vmcnt(28)
    s_barrier
    v_add_u32 v16, 131072, v11
    ds_read_b64_tr_b16 a[96:97], v16 offset:0
    ds_read_b64_tr_b16 a[98:99], v16 offset:1024
    ds_read_b64_tr_b16 a[100:101], v16 offset:4096
    ds_read_b64_tr_b16 a[102:103], v16 offset:5120
    ds_read_b64_tr_b16 a[104:105], v16 offset:8192
    ds_read_b64_tr_b16 a[106:107], v16 offset:9216
    ds_read_b64_tr_b16 a[108:109], v16 offset:12288
    ds_read_b64_tr_b16 a[110:111], v16 offset:13312
    s_waitcnt lgkmcnt(0)
    s_barrier
    s_add_u32 s14, s62, 102400
    s_addc_u32 s15, s63, 0
    v_xor_b32 v20, 0, v1
    s_mov_b32 m0, 135168
    s_nop 0
    global_load_lds_dwordx4 v20, s[14:15]
    s_add_u32 s14, s62, 103424
    s_addc_u32 s15, s63, 0
    v_xor_b32 v20, 64, v1
    s_mov_b32 m0, 136192
    s_nop 0
    global_load_lds_dwordx4 v20, s[14:15]
    s_add_u32 s14, s62, 104448
    s_addc_u32 s15, s63, 0
    v_xor_b32 v20, 128, v1
    s_mov_b32 m0, 137216
    s_nop 0
    global_load_lds_dwordx4 v20, s[14:15]
    s_add_u32 s14, s62, 105472
    s_addc_u32 s15, s63, 0
    v_xor_b32 v20, 192, v1
    s_mov_b32 m0, 138240
    s_nop 0
    global_load_lds_dwordx4 v20, s[14:15]
    s_waitcnt vmcnt(28)
    s_barrier
    v_add_u32 v16, 147456, v11
    ds_read_b64_tr_b16 a[112:113], v16 offset:0
    ds_read_b64_tr_b16 a[114:115], v16 offset:1024
    ds_read_b64_tr_b16 a[116:117], v16 offset:4096
    ds_read_b64_tr_b16 a[118:119], v16 offset:5120
    ds_read_b64_tr_b16 a[120:121], v16 offset:8192
    ds_read_b64_tr_b16 a[122:123], v16 offset:9216
    ds_read_b64_tr_b16 a[124:125], v16 offset:12288
    ds_read_b64_tr_b16 a[126:127], v16 offset:13312
    s_waitcnt lgkmcnt(0)
    s_barrier
    s_add_u32 s14, s62, 118784
    s_addc_u32 s15, s63, 0
    v_xor_b32 v20, 0, v1
    s_mov_b32 m0, 151552
    s_nop 0
    global_load_lds_dwordx4 v20, s[14:15]
    s_add_u32 s14, s62, 119808
    s_addc_u32 s15, s63, 0
    v_xor_b32 v20, 64, v1
    s_mov_b32 m0, 152576
    s_nop 0
    global_load_lds_dwordx4 v20, s[14:15]
    s_add_u32 s14, s62, 120832
    s_addc_u32 s15, s63, 0
    v_xor_b32 v20, 128, v1
    s_mov_b32 m0, 153600
    s_nop 0
    global_load_lds_dwordx4 v20, s[14:15]
    s_add_u32 s14, s62, 121856
    s_addc_u32 s15, s63, 0
    v_xor_b32 v20, 192, v1
    s_mov_b32 m0, 154624
    s_nop 0
    global_load_lds_dwordx4 v20, s[14:15]
    s_waitcnt vmcnt(24)
    s_barrier
    v_xor_b32 v16, 0, v19
    v_add_u32 v16, 0, v16
    ds_read_b64_tr_b16 a[128:129], v16 offset:0
    ds_read_b64_tr_b16 a[130:131], v16 offset:16384
    ds_read_b64_tr_b16 a[132:133], v16 offset:8192
    ds_read_b64_tr_b16 a[134:135], v16 offset:24576
    v_xor_b32 v16, 64, v19
    v_add_u32 v16, 0, v16
    ds_read_b64_tr_b16 a[160:161], v16 offset:0
    ds_read_b64_tr_b16 a[162:163], v16 offset:16384
    ds_read_b64_tr_b16 a[164:165], v16 offset:8192
    ds_read_b64_tr_b16 a[166:167], v16 offset:24576
    v_xor_b32 v16, 128, v19
    v_add_u32 v16, 0, v16
    ds_read_b64_tr_b16 a[192:193], v16 offset:0
    ds_read_b64_tr_b16 a[194:195], v16 offset:16384
    ds_read_b64_tr_b16 a[196:197], v16 offset:8192
    ds_read_b64_tr_b16 a[198:199], v16 offset:24576
    v_xor_b32 v16, 192, v19
    v_add_u32 v16, 0, v16
    ds_read_b64_tr_b16 a[224:225], v16 offset:0
    ds_read_b64_tr_b16 a[226:227], v16 offset:16384
    ds_read_b64_tr_b16 a[228:229], v16 offset:8192
    ds_read_b64_tr_b16 a[230:231], v16 offset:24576
    s_waitcnt lgkmcnt(0)
    s_waitcnt vmcnt(16)
    s_barrier
    v_xor_b32 v16, 0, v19
    v_add_u32 v16, 32768, v16
    ds_read_b64_tr_b16 a[136:137], v16 offset:0
    ds_read_b64_tr_b16 a[138:139], v16 offset:16384
    ds_read_b64_tr_b16 a[140:141], v16 offset:8192
    ds_read_b64_tr_b16 a[142:143], v16 offset:24576
    v_xor_b32 v16, 64, v19
    v_add_u32 v16, 32768, v16
    ds_read_b64_tr_b16 a[168:169], v16 offset:0
    ds_read_b64_tr_b16 a[170:171], v16 offset:16384
    ds_read_b64_tr_b16 a[172:173], v16 offset:8192
    ds_read_b64_tr_b16 a[174:175], v16 offset:24576
    v_xor_b32 v16, 128, v19
    v_add_u32 v16, 32768, v16
    ds_read_b64_tr_b16 a[200:201], v16 offset:0
    ds_read_b64_tr_b16 a[202:203], v16 offset:16384
    ds_read_b64_tr_b16 a[204:205], v16 offset:8192
    ds_read_b64_tr_b16 a[206:207], v16 offset:24576
    v_xor_b32 v16, 192, v19
    v_add_u32 v16, 32768, v16
    ds_read_b64_tr_b16 a[232:233], v16 offset:0
    ds_read_b64_tr_b16 a[234:235], v16 offset:16384
    ds_read_b64_tr_b16 a[236:237], v16 offset:8192
    ds_read_b64_tr_b16 a[238:239], v16 offset:24576
    s_waitcnt lgkmcnt(0)
    s_waitcnt vmcnt(8)
    s_barrier
    v_xor_b32 v16, 0, v19
    v_add_u32 v16, 65536, v16
    ds_read_b64_tr_b16 a[144:145], v16 offset:0
    ds_read_b64_tr_b16 a[146:147], v16 offset:16384
    ds_read_b64_tr_b16 a[148:149], v16 offset:8192
    ds_read_b64_tr_b16 a[150:151], v16 offset:24576
    v_xor_b32 v16, 64, v19
    v_add_u32 v16, 65536, v16
    ds_read_b64_tr_b16 a[176:177], v16 offset:0
    ds_read_b64_tr_b16 a[178:179], v16 offset:16384
    ds_read_b64_tr_b16 a[180:181], v16 offset:8192
    ds_read_b64_tr_b16 a[182:183], v16 offset:24576
    v_xor_b32 v16, 128, v19
    v_add_u32 v16, 65536, v16
    ds_read_b64_tr_b16 a[208:209], v16 offset:0
    ds_read_b64_tr_b16 a[210:211], v16 offset:16384
    ds_read_b64_tr_b16 a[212:213], v16 offset:8192
    ds_read_b64_tr_b16 a[214:215], v16 offset:24576
    v_xor_b32 v16, 192, v19
    v_add_u32 v16, 65536, v16
    ds_read_b64_tr_b16 a[240:241], v16 offset:0
    ds_read_b64_tr_b16 a[242:243], v16 offset:16384
    ds_read_b64_tr_b16 a[244:245], v16 offset:8192
    ds_read_b64_tr_b16 a[246:247], v16 offset:24576
    s_waitcnt lgkmcnt(0)
    s_waitcnt vmcnt(0)
    s_barrier
    v_xor_b32 v16, 0, v19
    v_add_u32 v16, 98304, v16
    ds_read_b64_tr_b16 a[152:153], v16 offset:0
    ds_read_b64_tr_b16 a[154:155], v16 offset:16384
    ds_read_b64_tr_b16 a[156:157], v16 offset:8192
    ds_read_b64_tr_b16 a[158:159], v16 offset:24576
    v_xor_b32 v16, 64, v19
    v_add_u32 v16, 98304, v16
    ds_read_b64_tr_b16 a[184:185], v16 offset:0
    ds_read_b64_tr_b16 a[186:187], v16 offset:16384
    ds_read_b64_tr_b16 a[188:189], v16 offset:8192
    ds_read_b64_tr_b16 a[190:191], v16 offset:24576
    v_xor_b32 v16, 128, v19
    v_add_u32 v16, 98304, v16
    ds_read_b64_tr_b16 a[216:217], v16 offset:0
    ds_read_b64_tr_b16 a[218:219], v16 offset:16384
    ds_read_b64_tr_b16 a[220:221], v16 offset:8192
    ds_read_b64_tr_b16 a[222:223], v16 offset:24576
    v_xor_b32 v16, 192, v19
    v_add_u32 v16, 98304, v16
    ds_read_b64_tr_b16 a[248:249], v16 offset:0
    ds_read_b64_tr_b16 a[250:251], v16 offset:16384
    ds_read_b64_tr_b16 a[252:253], v16 offset:8192
    ds_read_b64_tr_b16 a[254:255], v16 offset:24576
    s_waitcnt lgkmcnt(0)
    s_barrier
    s_branch L_fw_42
L_fw2_45:
    v_lshrrev_b32 v8, 4, v0
    v_lshlrev_b32 v9, 2, v8
    v_and_b32 v10, 15, v0
    v_xor_b32 v10, v10, v9
    v_lshlrev_b32 v10, 4, v10
    v_add_u32 v8, 32, v8
    v_lshl_add_u32 v12, v8, 13, v10
    v_add_u32 v13, 32768, v12
    v_add_u32 v14, 65536, v12
    v_add_u32 v15, 98304, v12
    v_bfe_u32 v8, v0, 2, 2
    v_xor_b32 v9, 2, v8
    v_lshlrev_b32 v9, 6, v9
    v_lshrrev_b32 v10, 5, v0
    v_lshl_add_u32 v17, v10, 3, v8
    v_lshl_add_u32 v9, v17, 8, v9
    v_bfe_u32 v17, v0, 4, 1
    v_lshl_add_u32 v9, v17, 5, v9
    v_and_b32 v18, 3, v0
    v_lshl_add_u32 v11, v18, 3, v9
    v_lshl_add_u32 v19, v10, 2, v8
    v_lshlrev_b32 v19, 10, v19
    v_lshl_add_u32 v19, v8, 6, v19
    v_lshl_add_u32 v19, v17, 5, v19
    v_lshl_add_u32 v19, v18, 3, v19
    v_add_u32 v19, 33280, v19
    s_add_u32 s14, s60, 0
    s_addc_u32 s15, s61, 0
    s_mov_b32 m0, 40960
    s_nop 0
    global_load_lds_dwordx4 v12, s[14:15]
    s_mov_b32 m0, 41984
    s_nop 0
    global_load_lds_dwordx4 v13, s[14:15]
    s_mov_b32 m0, 43008
    s_nop 0
    global_load_lds_dwordx4 v14, s[14:15]
    s_mov_b32 m0, 44032
    s_nop 0
    global_load_lds_dwordx4 v15, s[14:15]
    s_add_u32 s14, s60, 524288
    s_addc_u32 s15, s61, 0
    s_mov_b32 m0, 57344
    s_nop 0
    global_load_lds_dwordx4 v12, s[14:15]
    s_mov_b32 m0, 58368
    s_nop 0
    global_load_lds_dwordx4 v13, s[14:15]
    s_mov_b32 m0, 59392
    s_nop 0
    global_load_lds_dwordx4 v14, s[14:15]
    s_mov_b32 m0, 60416
    s_nop 0
    global_load_lds_dwordx4 v15, s[14:15]
    s_add_u32 s14, s60, 1048576
    s_addc_u32 s15, s61, 0
    s_mov_b32 m0, 73728
    s_nop 0
    global_load_lds_dwordx4 v12, s[14:15]
    s_mov_b32 m0, 74752
    s_nop 0
    global_load_lds_dwordx4 v13, s[14:15]
    s_mov_b32 m0, 75776
    s_nop 0
    global_load_lds_dwordx4 v14, s[14:15]
    s_mov_b32 m0, 76800
    s_nop 0
    global_load_lds_dwordx4 v15, s[14:15]
    s_add_u32 s14, s60, 1572864
    s_addc_u32 s15, s61, 0
    s_mov_b32 m0, 90112
    s_nop 0
    global_load_lds_dwordx4 v12, s[14:15]
    s_mov_b32 m0, 91136
    s_nop 0
    global_load_lds_dwordx4 v13, s[14:15]
    s_mov_b32 m0, 92160
    s_nop 0
    global_load_lds_dwordx4 v14, s[14:15]
    s_mov_b32 m0, 93184
    s_nop 0
    global_load_lds_dwordx4 v15, s[14:15]
    s_add_u32 s14, s60, 2097152
    s_addc_u32 s15, s61, 0
    s_mov_b32 m0, 106496
    s_nop 0
    global_load_lds_dwordx4 v12, s[14:15]
    s_mov_b32 m0, 107520
    s_nop 0
    global_load_lds_dwordx4 v13, s[14:15]
    s_mov_b32 m0, 108544
    s_nop 0
    global_load_lds_dwordx4 v14, s[14:15]
    s_mov_b32 m0, 109568
    s_nop 0
    global_load_lds_dwordx4 v15, s[14:15]
    s_add_u32 s14, s60, 2621440
    s_addc_u32 s15, s61, 0
    s_mov_b32 m0, 122880
    s_nop 0
    global_load_lds_dwordx4 v12, s[14:15]
    s_mov_b32 m0, 123904
    s_nop 0
    global_load_lds_dwordx4 v13, s[14:15]
    s_mov_b32 m0, 124928
    s_nop 0
    global_load_lds_dwordx4 v14, s[14:15]
    s_mov_b32 m0, 125952
    s_nop 0
    global_load_lds_dwordx4 v15, s[14:15]
    s_add_u32 s14, s60, 3145728
    s_addc_u32 s15, s61, 0
    s_mov_b32 m0, 139264
    s_nop 0
    global_load_lds_dwordx4 v12, s[14:15]
    s_mov_b32 m0, 140288
    s_nop 0
    global_load_lds_dwordx4 v13, s[14:15]
    s_mov_b32 m0, 141312
    s_nop 0
    global_load_lds_dwordx4 v14, s[14:15]
    s_mov_b32 m0, 142336
    s_nop 0
    global_load_lds_dwordx4 v15, s[14:15]
    s_add_u32 s14, s60, 3670016
    s_addc_u32 s15, s61, 0
    s_mov_b32 m0, 155648
    s_nop 0
    global_load_lds_dwordx4 v12, s[14:15]
    s_mov_b32 m0, 156672
    s_nop 0
    global_load_lds_dwordx4 v13, s[14:15]
    s_mov_b32 m0, 157696
    s_nop 0
    global_load_lds_dwordx4 v14, s[14:15]
    s_mov_b32 m0, 158720
    s_nop 0
    global_load_lds_dwordx4 v15, s[14:15]
    s_waitcnt vmcnt(28)
    s_barrier
    v_add_u32 v16, 32768, v11
    ds_read_b64_tr_b16 a[0:1], v16 offset:0
    ds_read_b64_tr_b16 a[2:3], v16 offset:1024
    ds_read_b64_tr_b16 a[4:5], v16 offset:4096
    ds_read_b64_tr_b16 a[6:7], v16 offset:5120
    ds_read_b64_tr_b16 a[8:9], v16 offset:8192
    ds_read_b64_tr_b16 a[10:11], v16 offset:9216
    ds_read_b64_tr_b16 a[12:13], v16 offset:12288
    ds_read_b64_tr_b16 a[14:15], v16 offset:13312
    s_waitcnt lgkmcnt(0)
    s_barrier
    s_add_u32 s14, s62, 8192
    s_addc_u32 s15, s63, 0
    v_xor_b32 v20, 0, v1
    s_mov_b32 m0, 40960
    s_nop 0
    global_load_lds_dwordx4 v20, s[14:15]
    s_add_u32 s14, s62, 9216
    s_addc_u32 s15, s63, 0
    v_xor_b32 v20, 64, v1
    s_mov_b32 m0, 41984
    s_nop 0
    global_load_lds_dwordx4 v20, s[14:15]
    s_add_u32 s14, s62, 10240
    s_addc_u32 s15, s63, 0
    v_xor_b32 v20, 128, v1
    s_mov_b32 m0, 43008
    s_nop 0
    global_load_lds_dwordx4 v20, s[14:15]
    s_add_u32 s14, s62, 11264
    s_addc_u32 s15, s63, 0
    v_xor_b32 v20, 192, v1
    s_mov_b32 m0, 44032
    s_nop 0
    global_load_lds_dwordx4 v20, s[14:15]
    s_waitcnt vmcnt(28)
    s_barrier
    v_add_u32 v16, 49152, v11
    ds_read_b64_tr_b16 a[16:17], v16 offset:0
    ds_read_b64_tr_b16 a[18:19], v16 offset:1024
    ds_read_b64_tr_b16 a[20:21], v16 offset:4096
    ds_read_b64_tr_b16 a[22:23], v16 offset:5120
    ds_read_b64_tr_b16 a[24:25], v16 offset:8192
    ds_read_b64_tr_b16 a[26:27], v16 offset:9216
    ds_read_b64_tr_b16 a[28:29], v16 offset:12288
    ds_read_b64_tr_b16 a[30:31], v16 offset:13312
    s_waitcnt lgkmcnt(0)
    s_barrier
    s_add_u32 s14, s62, 24576
    s_addc_u32 s15, s63, 0
    v_xor_b32 v20, 0, v1
    s_mov_b32 m0, 57344
    s_nop 0
    global_load_lds_dwordx4 v20, s[14:15]
    s_add_u32 s14, s62, 25600
    s_addc_u32 s15, s63, 0
    v_xor_b32 v20, 64, v1
    s_mov_b32 m0, 58368
    s_nop 0
    global_load_lds_dwordx4 v20, s[14:15]
    s_add_u32 s14, s62, 26624
    s_addc_u32 s15, s63, 0
    v_xor_b32 v20, 128, v1
    s_mov_b32 m0, 59392
    s_nop 0
    global_load_lds_dwordx4 v20, s[14:15]
    s_add_u32 s14, s62, 27648
    s_addc_u32 s15, s63, 0
    v_xor_b32 v20, 192, v1
    s_mov_b32 m0, 60416
    s_nop 0
    global_load_lds_dwordx4 v20, s[14:15]
    s_waitcnt vmcnt(28)
    s_barrier
    v_add_u32 v16, 65536, v11
    ds_read_b64_tr_b16 a[32:33], v16 offset:0
    ds_read_b64_tr_b16 a[34:35], v16 offset:1024
    ds_read_b64_tr_b16 a[36:37], v16 offset:4096
    ds_read_b64_tr_b16 a[38:39], v16 offset:5120
    ds_read_b64_tr_b16 a[40:41], v16 offset:8192
    ds_read_b64_tr_b16 a[42:43], v16 offset:9216
    ds_read_b64_tr_b16 a[44:45], v16 offset:12288
    ds_read_b64_tr_b16 a[46:47], v16 offset:13312
    s_waitcnt lgkmcnt(0)
    s_barrier
    s_add_u32 s14, s62, 40960
    s_addc_u32 s15, s63, 0
    v_xor_b32 v20, 0, v1
    s_mov_b32 m0, 73728
    s_nop 0
    global_load_lds_dwordx4 v20, s[14:15]
    s_add_u32 s14, s62, 41984
    s_addc_u32 s15, s63, 0
    v_xor_b32 v20, 64, v1
    s_mov_b32 m0, 74752
    s_nop 0
    global_load_lds_dwordx4 v20, s[14:15]
    s_add_u32 s14, s62, 43008
    s_addc_u32 s15, s63, 0
    v_xor_b32 v20, 128, v1
    s_mov_b32 m0, 75776
    s_nop 0
    global_load_lds_dwordx4 v20, s[14:15]
    s_add_u32 s14, s62, 44032
    s_addc_u32 s15, s63, 0
    v_xor_b32 v20, 192, v1
    s_mov_b32 m0, 76800
    s_nop 0
    global_load_lds_dwordx4 v20, s[14:15]
    s_waitcnt vmcnt(28)
    s_barrier
    v_add_u32 v16, 81920, v11
    ds_read_b64_tr_b16 a[48:49], v16 offset:0
    ds_read_b64_tr_b16 a[50:51], v16 offset:1024
    ds_read_b64_tr_b16 a[52:53], v16 offset:4096
    ds_read_b64_tr_b16 a[54:55], v16 offset:5120
    ds_read_b64_tr_b16 a[56:57], v16 offset:8192
    ds_read_b64_tr_b16 a[58:59], v16 offset:9216
    ds_read_b64_tr_b16 a[60:61], v16 offset:12288
    ds_read_b64_tr_b16 a[62:63], v16 offset:13312
    s_waitcnt lgkmcnt(0)
    s_barrier
    s_add_u32 s14, s62, 57344
    s_addc_u32 s15, s63, 0
    v_xor_b32 v20, 0, v1
    s_mov_b32 m0, 90112
    s_nop 0
    global_load_lds_dwordx4 v20, s[14:15]
    s_add_u32 s14, s62, 58368
    s_addc_u32 s15, s63, 0
    v_xor_b32 v20, 64, v1
    s_mov_b32 m0, 91136
    s_nop 0
    global_load_lds_dwordx4 v20, s[14:15]
    s_add_u32 s14, s62, 59392
    s_addc_u32 s15, s63, 0
    v_xor_b32 v20, 128, v1
    s_mov_b32 m0, 92160
    s_nop 0
    global_load_lds_dwordx4 v20, s[14:15]
    s_add_u32 s14, s62, 60416
    s_addc_u32 s15, s63, 0
    v_xor_b32 v20, 192, v1
    s_mov_b32 m0, 93184
    s_nop 0
    global_load_lds_dwordx4 v20, s[14:15]
    s_waitcnt vmcnt(28)
    s_barrier
    v_add_u32 v16, 98304, v11
    ds_read_b64_tr_b16 a[64:65], v16 offset:0
    ds_read_b64_tr_b16 a[66:67], v16 offset:1024
    ds_read_b64_tr_b16 a[68:69], v16 offset:4096
    ds_read_b64_tr_b16 a[70:71], v16 offset:5120
    ds_read_b64_tr_b16 a[72:73], v16 offset:8192
    ds_read_b64_tr_b16 a[74:75], v16 offset:9216
    ds_read_b64_tr_b16 a[76:77], v16 offset:12288
    ds_read_b64_tr_b16 a[78:79], v16 offset:13312
    s_waitcnt lgkmcnt(0)
    s_barrier
    s_add_u32 s14, s62, 73728
    s_addc_u32 s15, s63, 0
    v_xor_b32 v20, 0, v1
    s_mov_b32 m0, 106496
    s_nop 0
    global_load_lds_dwordx4 v20, s[14:15]
    s_add_u32 s14, s62, 74752
    s_addc_u32 s15, s63, 0
    v_xor_b32 v20, 64, v1
    s_mov_b32 m0, 107520
    s_nop 0
    global_load_lds_dwordx4 v20, s[14:15]
    s_add_u32 s14, s62, 75776
    s_addc_u32 s15, s63, 0
    v_xor_b32 v20, 128, v1
    s_mov_b32 m0, 108544
    s_nop 0
    global_load_lds_dwordx4 v20, s[14:15]
    s_add_u32 s14, s62, 76800
    s_addc_u32 s15, s63, 0
    v_xor_b32 v20, 192, v1
    s_mov_b32 m0, 109568
    s_nop 0
    global_load_lds_dwordx4 v20, s[14:15]
    s_waitcnt vmcnt(28)
    s_barrier
    v_add_u32 v16, 114688, v11
    ds_read_b64_tr_b16 a[80:81], v16 offset:0
    ds_read_b64_tr_b16 a[82:83], v16 offset:1024
    ds_read_b64_tr_b16 a[84:85], v16 offset:4096
    ds_read_b64_tr_b16 a[86:87], v16 offset:5120
    ds_read_b64_tr_b16 a[88:89], v16 offset:8192
    ds_read_b64_tr_b16 a[90:91], v16 offset:9216
    ds_read_b64_tr_b16 a[92:93], v16 offset:12288
    ds_read_b64_tr_b16 a[94:95], v16 offset:13312
    s_waitcnt lgkmcnt(0)
    s_barrier
    s_add_u32 s14, s62, 90112
    s_addc_u32 s15, s63, 0
    v_xor_b32 v20, 0, v1
    s_mov_b32 m0, 122880
    s_nop 0
    global_load_lds_dwordx4 v20, s[14:15]
    s_add_u32 s14, s62, 91136
    s_addc_u32 s15, s63, 0
    v_xor_b32 v20, 64, v1
    s_mov_b32 m0, 123904
    s_nop 0
    global_load_lds_dwordx4 v20, s[14:15]
    s_add_u32 s14, s62, 92160
    s_addc_u32 s15, s63, 0
    v_xor_b32 v20, 128, v1
    s_mov_b32 m0, 124928
    s_nop 0
    global_load_lds_dwordx4 v20, s[14:15]
    s_add_u32 s14, s62, 93184
    s_addc_u32 s15, s63, 0
    v_xor_b32 v20, 192, v1
    s_mov_b32 m0, 125952
    s_nop 0
    global_load_lds_dwordx4 v20, s[14:15]
    s_waitcnt vmcnt(28)
    s_barrier
    v_add_u32 v16, 131072, v11
    ds_read_b64_tr_b16 a[96:97], v16 offset:0
    ds_read_b64_tr_b16 a[98:99], v16 offset:1024
    ds_read_b64_tr_b16 a[100:101], v16 offset:4096
    ds_read_b64_tr_b16 a[102:103], v16 offset:5120
    ds_read_b64_tr_b16 a[104:105], v16 offset:8192
    ds_read_b64_tr_b16 a[106:107], v16 offset:9216
    ds_read_b64_tr_b16 a[108:109], v16 offset:12288
    ds_read_b64_tr_b16 a[110:111], v16 offset:13312
    s_waitcnt lgkmcnt(0)
    s_barrier
    s_add_u32 s14, s62, 106496
    s_addc_u32 s15, s63, 0
    v_xor_b32 v20, 0, v1
    s_mov_b32 m0, 139264
    s_nop 0
    global_load_lds_dwordx4 v20, s[14:15]
    s_add_u32 s14, s62, 107520
    s_addc_u32 s15, s63, 0
    v_xor_b32 v20, 64, v1
    s_mov_b32 m0, 140288
    s_nop 0
    global_load_lds_dwordx4 v20, s[14:15]
    s_add_u32 s14, s62, 108544
    s_addc_u32 s15, s63, 0
    v_xor_b32 v20, 128, v1
    s_mov_b32 m0, 141312
    s_nop 0
    global_load_lds_dwordx4 v20, s[14:15]
    s_add_u32 s14, s62, 109568
    s_addc_u32 s15, s63, 0
    v_xor_b32 v20, 192, v1
    s_mov_b32 m0, 142336
    s_nop 0
    global_load_lds_dwordx4 v20, s[14:15]
    s_waitcnt vmcnt(28)
    s_barrier
    v_add_u32 v16, 147456, v11
    ds_read_b64_tr_b16 a[112:113], v16 offset:0
    ds_read_b64_tr_b16 a[114:115], v16 offset:1024
    ds_read_b64_tr_b16 a[116:117], v16 offset:4096
    ds_read_b64_tr_b16 a[118:119], v16 offset:5120
    ds_read_b64_tr_b16 a[120:121], v16 offset:8192
    ds_read_b64_tr_b16 a[122:123], v16 offset:9216
    ds_read_b64_tr_b16 a[124:125], v16 offset:12288
    ds_read_b64_tr_b16 a[126:127], v16 offset:13312
    s_waitcnt lgkmcnt(0)
    s_barrier
    s_add_u32 s14, s62, 122880
    s_addc_u32 s15, s63, 0
    v_xor_b32 v20, 0, v1
    s_mov_b32 m0, 155648
    s_nop 0
    global_load_lds_dwordx4 v20, s[14:15]
    s_add_u32 s14, s62, 123904
    s_addc_u32 s15, s63, 0
    v_xor_b32 v20, 64, v1
    s_mov_b32 m0, 156672
    s_nop 0
    global_load_lds_dwordx4 v20, s[14:15]
    s_add_u32 s14, s62, 124928
    s_addc_u32 s15, s63, 0
    v_xor_b32 v20, 128, v1
    s_mov_b32 m0, 157696
    s_nop 0
    global_load_lds_dwordx4 v20, s[14:15]
    s_add_u32 s14, s62, 125952
    s_addc_u32 s15, s63, 0
    v_xor_b32 v20, 192, v1
    s_mov_b32 m0, 158720
    s_nop 0
    global_load_lds_dwordx4 v20, s[14:15]
    s_waitcnt vmcnt(24)
    s_barrier
    v_xor_b32 v16, 0, v19
    v_add_u32 v16, 0, v16
    ds_read_b64_tr_b16 a[128:129], v16 offset:0
    ds_read_b64_tr_b16 a[130:131], v16 offset:16384
    ds_read_b64_tr_b16 a[132:133], v16 offset:8192
    ds_read_b64_tr_b16 a[134:135], v16 offset:24576
    v_xor_b32 v16, 64, v19
    v_add_u32 v16, 0, v16
    ds_read_b64_tr_b16 a[160:161], v16 offset:0
    ds_read_b64_tr_b16 a[162:163], v16 offset:16384
    ds_read_b64_tr_b16 a[164:165], v16 offset:8192
    ds_read_b64_tr_b16 a[166:167], v16 offset:24576
    v_xor_b32 v16, 128, v19
    v_add_u32 v16, 0, v16
    ds_read_b64_tr_b16 a[192:193], v16 offset:0
    ds_read_b64_tr_b16 a[194:195], v16 offset:16384
    ds_read_b64_tr_b16 a[196:197], v16 offset:8192
    ds_read_b64_tr_b16 a[198:199], v16 offset:24576
    v_xor_b32 v16, 192, v19
    v_add_u32 v16, 0, v16
    ds_read_b64_tr_b16 a[224:225], v16 offset:0
    ds_read_b64_tr_b16 a[226:227], v16 offset:16384
    ds_read_b64_tr_b16 a[228:229], v16 offset:8192
    ds_read_b64_tr_b16 a[230:231], v16 offset:24576
    s_waitcnt lgkmcnt(0)
    s_waitcnt vmcnt(16)
    s_barrier
    v_xor_b32 v16, 0, v19
    v_add_u32 v16, 32768, v16
    ds_read_b64_tr_b16 a[136:137], v16 offset:0
    ds_read_b64_tr_b16 a[138:139], v16 offset:16384
    ds_read_b64_tr_b16 a[140:141], v16 offset:8192
    ds_read_b64_tr_b16 a[142:143], v16 offset:24576
    v_xor_b32 v16, 64, v19
    v_add_u32 v16, 32768, v16
    ds_read_b64_tr_b16 a[168:169], v16 offset:0
    ds_read_b64_tr_b16 a[170:171], v16 offset:16384
    ds_read_b64_tr_b16 a[172:173], v16 offset:8192
    ds_read_b64_tr_b16 a[174:175], v16 offset:24576
    v_xor_b32 v16, 128, v19
    v_add_u32 v16, 32768, v16
    ds_read_b64_tr_b16 a[200:201], v16 offset:0
    ds_read_b64_tr_b16 a[202:203], v16 offset:16384
    ds_read_b64_tr_b16 a[204:205], v16 offset:8192
    ds_read_b64_tr_b16 a[206:207], v16 offset:24576
    v_xor_b32 v16, 192, v19
    v_add_u32 v16, 32768, v16
    ds_read_b64_tr_b16 a[232:233], v16 offset:0
    ds_read_b64_tr_b16 a[234:235], v16 offset:16384
    ds_read_b64_tr_b16 a[236:237], v16 offset:8192
    ds_read_b64_tr_b16 a[238:239], v16 offset:24576
    s_waitcnt lgkmcnt(0)
    s_waitcnt vmcnt(8)
    s_barrier
    v_xor_b32 v16, 0, v19
    v_add_u32 v16, 65536, v16
    ds_read_b64_tr_b16 a[144:145], v16 offset:0
    ds_read_b64_tr_b16 a[146:147], v16 offset:16384
    ds_read_b64_tr_b16 a[148:149], v16 offset:8192
    ds_read_b64_tr_b16 a[150:151], v16 offset:24576
    v_xor_b32 v16, 64, v19
    v_add_u32 v16, 65536, v16
    ds_read_b64_tr_b16 a[176:177], v16 offset:0
    ds_read_b64_tr_b16 a[178:179], v16 offset:16384
    ds_read_b64_tr_b16 a[180:181], v16 offset:8192
    ds_read_b64_tr_b16 a[182:183], v16 offset:24576
    v_xor_b32 v16, 128, v19
    v_add_u32 v16, 65536, v16
    ds_read_b64_tr_b16 a[208:209], v16 offset:0
    ds_read_b64_tr_b16 a[210:211], v16 offset:16384
    ds_read_b64_tr_b16 a[212:213], v16 offset:8192
    ds_read_b64_tr_b16 a[214:215], v16 offset:24576
    v_xor_b32 v16, 192, v19
    v_add_u32 v16, 65536, v16
    ds_read_b64_tr_b16 a[240:241], v16 offset:0
    ds_read_b64_tr_b16 a[242:243], v16 offset:16384
    ds_read_b64_tr_b16 a[244:245], v16 offset:8192
    ds_read_b64_tr_b16 a[246:247], v16 offset:24576
    s_waitcnt lgkmcnt(0)
    s_waitcnt vmcnt(0)
    s_barrier
    v_xor_b32 v16, 0, v19
    v_add_u32 v16, 98304, v16
    ds_read_b64_tr_b16 a[152:153], v16 offset:0
    ds_read_b64_tr_b16 a[154:155], v16 offset:16384
    ds_read_b64_tr_b16 a[156:157], v16 offset:8192
    ds_read_b64_tr_b16 a[158:159], v16 offset:24576
    v_xor_b32 v16, 64, v19
    v_add_u32 v16, 98304, v16
    ds_read_b64_tr_b16 a[184:185], v16 offset:0
    ds_read_b64_tr_b16 a[186:187], v16 offset:16384
    ds_read_b64_tr_b16 a[188:189], v16 offset:8192
    ds_read_b64_tr_b16 a[190:191], v16 offset:24576
    v_xor_b32 v16, 128, v19
    v_add_u32 v16, 98304, v16
    ds_read_b64_tr_b16 a[216:217], v16 offset:0
    ds_read_b64_tr_b16 a[218:219], v16 offset:16384
    ds_read_b64_tr_b16 a[220:221], v16 offset:8192
    ds_read_b64_tr_b16 a[222:223], v16 offset:24576
    v_xor_b32 v16, 192, v19
    v_add_u32 v16, 98304, v16
    ds_read_b64_tr_b16 a[248:249], v16 offset:0
    ds_read_b64_tr_b16 a[250:251], v16 offset:16384
    ds_read_b64_tr_b16 a[252:253], v16 offset:8192
    ds_read_b64_tr_b16 a[254:255], v16 offset:24576
    s_waitcnt lgkmcnt(0)
    s_barrier
    s_branch L_fw_42
L_fw3_46:
    v_lshrrev_b32 v8, 4, v0
    v_lshlrev_b32 v9, 2, v8
    v_and_b32 v10, 15, v0
    v_xor_b32 v10, v10, v9
    v_lshlrev_b32 v10, 4, v10
    v_add_u32 v8, 48, v8
    v_lshl_add_u32 v12, v8, 13, v10
    v_add_u32 v13, 32768, v12
    v_add_u32 v14, 65536, v12
    v_add_u32 v15, 98304, v12
    v_bfe_u32 v8, v0, 2, 2
    v_xor_b32 v9, 3, v8
    v_lshlrev_b32 v9, 6, v9
    v_lshrrev_b32 v10, 5, v0
    v_lshl_add_u32 v17, v10, 3, v8
    v_lshl_add_u32 v9, v17, 8, v9
    v_bfe_u32 v17, v0, 4, 1
    v_lshl_add_u32 v9, v17, 5, v9
    v_and_b32 v18, 3, v0
    v_lshl_add_u32 v11, v18, 3, v9
    v_lshl_add_u32 v19, v10, 2, v8
    v_lshlrev_b32 v19, 10, v19
    v_lshl_add_u32 v19, v8, 6, v19
    v_lshl_add_u32 v19, v17, 5, v19
    v_lshl_add_u32 v19, v18, 3, v19
    v_add_u32 v19, 33536, v19
    s_add_u32 s14, s60, 0
    s_addc_u32 s15, s61, 0
    s_mov_b32 m0, 45056
    s_nop 0
    global_load_lds_dwordx4 v12, s[14:15]
    s_mov_b32 m0, 46080
    s_nop 0
    global_load_lds_dwordx4 v13, s[14:15]
    s_mov_b32 m0, 47104
    s_nop 0
    global_load_lds_dwordx4 v14, s[14:15]
    s_mov_b32 m0, 48128
    s_nop 0
    global_load_lds_dwordx4 v15, s[14:15]
    s_add_u32 s14, s60, 524288
    s_addc_u32 s15, s61, 0
    s_mov_b32 m0, 61440
    s_nop 0
    global_load_lds_dwordx4 v12, s[14:15]
    s_mov_b32 m0, 62464
    s_nop 0
    global_load_lds_dwordx4 v13, s[14:15]
    s_mov_b32 m0, 63488
    s_nop 0
    global_load_lds_dwordx4 v14, s[14:15]
    s_mov_b32 m0, 64512
    s_nop 0
    global_load_lds_dwordx4 v15, s[14:15]
    s_add_u32 s14, s60, 1048576
    s_addc_u32 s15, s61, 0
    s_mov_b32 m0, 77824
    s_nop 0
    global_load_lds_dwordx4 v12, s[14:15]
    s_mov_b32 m0, 78848
    s_nop 0
    global_load_lds_dwordx4 v13, s[14:15]
    s_mov_b32 m0, 79872
    s_nop 0
    global_load_lds_dwordx4 v14, s[14:15]
    s_mov_b32 m0, 80896
    s_nop 0
    global_load_lds_dwordx4 v15, s[14:15]
    s_add_u32 s14, s60, 1572864
    s_addc_u32 s15, s61, 0
    s_mov_b32 m0, 94208
    s_nop 0
    global_load_lds_dwordx4 v12, s[14:15]
    s_mov_b32 m0, 95232
    s_nop 0
    global_load_lds_dwordx4 v13, s[14:15]
    s_mov_b32 m0, 96256
    s_nop 0
    global_load_lds_dwordx4 v14, s[14:15]
    s_mov_b32 m0, 97280
    s_nop 0
    global_load_lds_dwordx4 v15, s[14:15]
    s_add_u32 s14, s60, 2097152
    s_addc_u32 s15, s61, 0
    s_mov_b32 m0, 110592
    s_nop 0
    global_load_lds_dwordx4 v12, s[14:15]
    s_mov_b32 m0, 111616
    s_nop 0
    global_load_lds_dwordx4 v13, s[14:15]
    s_mov_b32 m0, 112640
    s_nop 0
    global_load_lds_dwordx4 v14, s[14:15]
    s_mov_b32 m0, 113664
    s_nop 0
    global_load_lds_dwordx4 v15, s[14:15]
    s_add_u32 s14, s60, 2621440
    s_addc_u32 s15, s61, 0
    s_mov_b32 m0, 126976
    s_nop 0
    global_load_lds_dwordx4 v12, s[14:15]
    s_mov_b32 m0, 128000
    s_nop 0
    global_load_lds_dwordx4 v13, s[14:15]
    s_mov_b32 m0, 129024
    s_nop 0
    global_load_lds_dwordx4 v14, s[14:15]
    s_mov_b32 m0, 130048
    s_nop 0
    global_load_lds_dwordx4 v15, s[14:15]
    s_add_u32 s14, s60, 3145728
    s_addc_u32 s15, s61, 0
    s_mov_b32 m0, 143360
    s_nop 0
    global_load_lds_dwordx4 v12, s[14:15]
    s_mov_b32 m0, 144384
    s_nop 0
    global_load_lds_dwordx4 v13, s[14:15]
    s_mov_b32 m0, 145408
    s_nop 0
    global_load_lds_dwordx4 v14, s[14:15]
    s_mov_b32 m0, 146432
    s_nop 0
    global_load_lds_dwordx4 v15, s[14:15]
    s_add_u32 s14, s60, 3670016
    s_addc_u32 s15, s61, 0
    s_mov_b32 m0, 159744
    s_nop 0
    global_load_lds_dwordx4 v12, s[14:15]
    s_mov_b32 m0, 160768
    s_nop 0
    global_load_lds_dwordx4 v13, s[14:15]
    s_mov_b32 m0, 161792
    s_nop 0
    global_load_lds_dwordx4 v14, s[14:15]
    s_mov_b32 m0, 162816
    s_nop 0
    global_load_lds_dwordx4 v15, s[14:15]
    s_waitcnt vmcnt(28)
    s_barrier
    v_add_u32 v16, 32768, v11
    ds_read_b64_tr_b16 a[0:1], v16 offset:0
    ds_read_b64_tr_b16 a[2:3], v16 offset:1024
    ds_read_b64_tr_b16 a[4:5], v16 offset:4096
    ds_read_b64_tr_b16 a[6:7], v16 offset:5120
    ds_read_b64_tr_b16 a[8:9], v16 offset:8192
    ds_read_b64_tr_b16 a[10:11], v16 offset:9216
    ds_read_b64_tr_b16 a[12:13], v16 offset:12288
    ds_read_b64_tr_b16 a[14:15], v16 offset:13312
    s_waitcnt lgkmcnt(0)
    s_barrier
    s_add_u32 s14, s62, 12288
    s_addc_u32 s15, s63, 0
    v_xor_b32 v20, 0, v1
    s_mov_b32 m0, 45056
    s_nop 0
    global_load_lds_dwordx4 v20, s[14:15]
    s_add_u32 s14, s62, 13312
    s_addc_u32 s15, s63, 0
    v_xor_b32 v20, 64, v1
    s_mov_b32 m0, 46080
    s_nop 0
    global_load_lds_dwordx4 v20, s[14:15]
    s_add_u32 s14, s62, 14336
    s_addc_u32 s15, s63, 0
    v_xor_b32 v20, 128, v1
    s_mov_b32 m0, 47104
    s_nop 0
    global_load_lds_dwordx4 v20, s[14:15]
    s_add_u32 s14, s62, 15360
    s_addc_u32 s15, s63, 0
    v_xor_b32 v20, 192, v1
    s_mov_b32 m0, 48128
    s_nop 0
    global_load_lds_dwordx4 v20, s[14:15]
    s_waitcnt vmcnt(28)
    s_barrier
    v_add_u32 v16, 49152, v11
    ds_read_b64_tr_b16 a[16:17], v16 offset:0
    ds_read_b64_tr_b16 a[18:19], v16 offset:1024
    ds_read_b64_tr_b16 a[20:21], v16 offset:4096
    ds_read_b64_tr_b16 a[22:23], v16 offset:5120
    ds_read_b64_tr_b16 a[24:25], v16 offset:8192
    ds_read_b64_tr_b16 a[26:27], v16 offset:9216
    ds_read_b64_tr_b16 a[28:29], v16 offset:12288
    ds_read_b64_tr_b16 a[30:31], v16 offset:13312
    s_waitcnt lgkmcnt(0)
    s_barrier
    s_add_u32 s14, s62, 28672
    s_addc_u32 s15, s63, 0
    v_xor_b32 v20, 0, v1
    s_mov_b32 m0, 61440
    s_nop 0
    global_load_lds_dwordx4 v20, s[14:15]
    s_add_u32 s14, s62, 29696
    s_addc_u32 s15, s63, 0
    v_xor_b32 v20, 64, v1
    s_mov_b32 m0, 62464
    s_nop 0
    global_load_lds_dwordx4 v20, s[14:15]
    s_add_u32 s14, s62, 30720
    s_addc_u32 s15, s63, 0
    v_xor_b32 v20, 128, v1
    s_mov_b32 m0, 63488
    s_nop 0
    global_load_lds_dwordx4 v20, s[14:15]
    s_add_u32 s14, s62, 31744
    s_addc_u32 s15, s63, 0
    v_xor_b32 v20, 192, v1
    s_mov_b32 m0, 64512
    s_nop 0
    global_load_lds_dwordx4 v20, s[14:15]
    s_waitcnt vmcnt(28)
    s_barrier
    v_add_u32 v16, 65536, v11
    ds_read_b64_tr_b16 a[32:33], v16 offset:0
    ds_read_b64_tr_b16 a[34:35], v16 offset:1024
    ds_read_b64_tr_b16 a[36:37], v16 offset:4096
    ds_read_b64_tr_b16 a[38:39], v16 offset:5120
    ds_read_b64_tr_b16 a[40:41], v16 offset:8192
    ds_read_b64_tr_b16 a[42:43], v16 offset:9216
    ds_read_b64_tr_b16 a[44:45], v16 offset:12288
    ds_read_b64_tr_b16 a[46:47], v16 offset:13312
    s_waitcnt lgkmcnt(0)
    s_barrier
    s_add_u32 s14, s62, 45056
    s_addc_u32 s15, s63, 0
    v_xor_b32 v20, 0, v1
    s_mov_b32 m0, 77824
    s_nop 0
    global_load_lds_dwordx4 v20, s[14:15]
    s_add_u32 s14, s62, 46080
    s_addc_u32 s15, s63, 0
    v_xor_b32 v20, 64, v1
    s_mov_b32 m0, 78848
    s_nop 0
    global_load_lds_dwordx4 v20, s[14:15]
    s_add_u32 s14, s62, 47104
    s_addc_u32 s15, s63, 0
    v_xor_b32 v20, 128, v1
    s_mov_b32 m0, 79872
    s_nop 0
    global_load_lds_dwordx4 v20, s[14:15]
    s_add_u32 s14, s62, 48128
    s_addc_u32 s15, s63, 0
    v_xor_b32 v20, 192, v1
    s_mov_b32 m0, 80896
    s_nop 0
    global_load_lds_dwordx4 v20, s[14:15]
    s_waitcnt vmcnt(28)
    s_barrier
    v_add_u32 v16, 81920, v11
    ds_read_b64_tr_b16 a[48:49], v16 offset:0
    ds_read_b64_tr_b16 a[50:51], v16 offset:1024
    ds_read_b64_tr_b16 a[52:53], v16 offset:4096
    ds_read_b64_tr_b16 a[54:55], v16 offset:5120
    ds_read_b64_tr_b16 a[56:57], v16 offset:8192
    ds_read_b64_tr_b16 a[58:59], v16 offset:9216
    ds_read_b64_tr_b16 a[60:61], v16 offset:12288
    ds_read_b64_tr_b16 a[62:63], v16 offset:13312
    s_waitcnt lgkmcnt(0)
    s_barrier
    s_add_u32 s14, s62, 61440
    s_addc_u32 s15, s63, 0
    v_xor_b32 v20, 0, v1
    s_mov_b32 m0, 94208
    s_nop 0
    global_load_lds_dwordx4 v20, s[14:15]
    s_add_u32 s14, s62, 62464
    s_addc_u32 s15, s63, 0
    v_xor_b32 v20, 64, v1
    s_mov_b32 m0, 95232
    s_nop 0
    global_load_lds_dwordx4 v20, s[14:15]
    s_add_u32 s14, s62, 63488
    s_addc_u32 s15, s63, 0
    v_xor_b32 v20, 128, v1
    s_mov_b32 m0, 96256
    s_nop 0
    global_load_lds_dwordx4 v20, s[14:15]
    s_add_u32 s14, s62, 64512
    s_addc_u32 s15, s63, 0
    v_xor_b32 v20, 192, v1
    s_mov_b32 m0, 97280
    s_nop 0
    global_load_lds_dwordx4 v20, s[14:15]
    s_waitcnt vmcnt(28)
    s_barrier
    v_add_u32 v16, 98304, v11
    ds_read_b64_tr_b16 a[64:65], v16 offset:0
    ds_read_b64_tr_b16 a[66:67], v16 offset:1024
    ds_read_b64_tr_b16 a[68:69], v16 offset:4096
    ds_read_b64_tr_b16 a[70:71], v16 offset:5120
    ds_read_b64_tr_b16 a[72:73], v16 offset:8192
    ds_read_b64_tr_b16 a[74:75], v16 offset:9216
    ds_read_b64_tr_b16 a[76:77], v16 offset:12288
    ds_read_b64_tr_b16 a[78:79], v16 offset:13312
    s_waitcnt lgkmcnt(0)
    s_barrier
    s_add_u32 s14, s62, 77824
    s_addc_u32 s15, s63, 0
    v_xor_b32 v20, 0, v1
    s_mov_b32 m0, 110592
    s_nop 0
    global_load_lds_dwordx4 v20, s[14:15]
    s_add_u32 s14, s62, 78848
    s_addc_u32 s15, s63, 0
    v_xor_b32 v20, 64, v1
    s_mov_b32 m0, 111616
    s_nop 0
    global_load_lds_dwordx4 v20, s[14:15]
    s_add_u32 s14, s62, 79872
    s_addc_u32 s15, s63, 0
    v_xor_b32 v20, 128, v1
    s_mov_b32 m0, 112640
    s_nop 0
    global_load_lds_dwordx4 v20, s[14:15]
    s_add_u32 s14, s62, 80896
    s_addc_u32 s15, s63, 0
    v_xor_b32 v20, 192, v1
    s_mov_b32 m0, 113664
    s_nop 0
    global_load_lds_dwordx4 v20, s[14:15]
    s_waitcnt vmcnt(28)
    s_barrier
    v_add_u32 v16, 114688, v11
    ds_read_b64_tr_b16 a[80:81], v16 offset:0
    ds_read_b64_tr_b16 a[82:83], v16 offset:1024
    ds_read_b64_tr_b16 a[84:85], v16 offset:4096
    ds_read_b64_tr_b16 a[86:87], v16 offset:5120
    ds_read_b64_tr_b16 a[88:89], v16 offset:8192
    ds_read_b64_tr_b16 a[90:91], v16 offset:9216
    ds_read_b64_tr_b16 a[92:93], v16 offset:12288
    ds_read_b64_tr_b16 a[94:95], v16 offset:13312
    s_waitcnt lgkmcnt(0)
    s_barrier
    s_add_u32 s14, s62, 94208
    s_addc_u32 s15, s63, 0
    v_xor_b32 v20, 0, v1
    s_mov_b32 m0, 126976
    s_nop 0
    global_load_lds_dwordx4 v20, s[14:15]
    s_add_u32 s14, s62, 95232
    s_addc_u32 s15, s63, 0
    v_xor_b32 v20, 64, v1
    s_mov_b32 m0, 128000
    s_nop 0
    global_load_lds_dwordx4 v20, s[14:15]
    s_add_u32 s14, s62, 96256
    s_addc_u32 s15, s63, 0
    v_xor_b32 v20, 128, v1
    s_mov_b32 m0, 129024
    s_nop 0
    global_load_lds_dwordx4 v20, s[14:15]
    s_add_u32 s14, s62, 97280
    s_addc_u32 s15, s63, 0
    v_xor_b32 v20, 192, v1
    s_mov_b32 m0, 130048
    s_nop 0
    global_load_lds_dwordx4 v20, s[14:15]
    s_waitcnt vmcnt(28)
    s_barrier
    v_add_u32 v16, 131072, v11
    ds_read_b64_tr_b16 a[96:97], v16 offset:0
    ds_read_b64_tr_b16 a[98:99], v16 offset:1024
    ds_read_b64_tr_b16 a[100:101], v16 offset:4096
    ds_read_b64_tr_b16 a[102:103], v16 offset:5120
    ds_read_b64_tr_b16 a[104:105], v16 offset:8192
    ds_read_b64_tr_b16 a[106:107], v16 offset:9216
    ds_read_b64_tr_b16 a[108:109], v16 offset:12288
    ds_read_b64_tr_b16 a[110:111], v16 offset:13312
    s_waitcnt lgkmcnt(0)
    s_barrier
    s_add_u32 s14, s62, 110592
    s_addc_u32 s15, s63, 0
    v_xor_b32 v20, 0, v1
    s_mov_b32 m0, 143360
    s_nop 0
    global_load_lds_dwordx4 v20, s[14:15]
    s_add_u32 s14, s62, 111616
    s_addc_u32 s15, s63, 0
    v_xor_b32 v20, 64, v1
    s_mov_b32 m0, 144384
    s_nop 0
    global_load_lds_dwordx4 v20, s[14:15]
    s_add_u32 s14, s62, 112640
    s_addc_u32 s15, s63, 0
    v_xor_b32 v20, 128, v1
    s_mov_b32 m0, 145408
    s_nop 0
    global_load_lds_dwordx4 v20, s[14:15]
    s_add_u32 s14, s62, 113664
    s_addc_u32 s15, s63, 0
    v_xor_b32 v20, 192, v1
    s_mov_b32 m0, 146432
    s_nop 0
    global_load_lds_dwordx4 v20, s[14:15]
    s_waitcnt vmcnt(28)
    s_barrier
    v_add_u32 v16, 147456, v11
    ds_read_b64_tr_b16 a[112:113], v16 offset:0
    ds_read_b64_tr_b16 a[114:115], v16 offset:1024
    ds_read_b64_tr_b16 a[116:117], v16 offset:4096
    ds_read_b64_tr_b16 a[118:119], v16 offset:5120
    ds_read_b64_tr_b16 a[120:121], v16 offset:8192
    ds_read_b64_tr_b16 a[122:123], v16 offset:9216
    ds_read_b64_tr_b16 a[124:125], v16 offset:12288
    ds_read_b64_tr_b16 a[126:127], v16 offset:13312
    s_waitcnt lgkmcnt(0)
    s_barrier
    s_add_u32 s14, s62, 126976
    s_addc_u32 s15, s63, 0
    v_xor_b32 v20, 0, v1
    s_mov_b32 m0, 159744
    s_nop 0
    global_load_lds_dwordx4 v20, s[14:15]
    s_add_u32 s14, s62, 128000
    s_addc_u32 s15, s63, 0
    v_xor_b32 v20, 64, v1
    s_mov_b32 m0, 160768
    s_nop 0
    global_load_lds_dwordx4 v20, s[14:15]
    s_add_u32 s14, s62, 129024
    s_addc_u32 s15, s63, 0
    v_xor_b32 v20, 128, v1
    s_mov_b32 m0, 161792
    s_nop 0
    global_load_lds_dwordx4 v20, s[14:15]
    s_add_u32 s14, s62, 130048
    s_addc_u32 s15, s63, 0
    v_xor_b32 v20, 192, v1
    s_mov_b32 m0, 162816
    s_nop 0
    global_load_lds_dwordx4 v20, s[14:15]
    s_waitcnt vmcnt(24)
    s_barrier
    v_xor_b32 v16, 0, v19
    v_add_u32 v16, 0, v16
    ds_read_b64_tr_b16 a[128:129], v16 offset:0
    ds_read_b64_tr_b16 a[130:131], v16 offset:16384
    ds_read_b64_tr_b16 a[132:133], v16 offset:8192
    ds_read_b64_tr_b16 a[134:135], v16 offset:24576
    v_xor_b32 v16, 64, v19
    v_add_u32 v16, 0, v16
    ds_read_b64_tr_b16 a[160:161], v16 offset:0
    ds_read_b64_tr_b16 a[162:163], v16 offset:16384
    ds_read_b64_tr_b16 a[164:165], v16 offset:8192
    ds_read_b64_tr_b16 a[166:167], v16 offset:24576
    v_xor_b32 v16, 128, v19
    v_add_u32 v16, 0, v16
    ds_read_b64_tr_b16 a[192:193], v16 offset:0
    ds_read_b64_tr_b16 a[194:195], v16 offset:16384
    ds_read_b64_tr_b16 a[196:197], v16 offset:8192
    ds_read_b64_tr_b16 a[198:199], v16 offset:24576
    v_xor_b32 v16, 192, v19
    v_add_u32 v16, 0, v16
    ds_read_b64_tr_b16 a[224:225], v16 offset:0
    ds_read_b64_tr_b16 a[226:227], v16 offset:16384
    ds_read_b64_tr_b16 a[228:229], v16 offset:8192
    ds_read_b64_tr_b16 a[230:231], v16 offset:24576
    s_waitcnt lgkmcnt(0)
    s_waitcnt vmcnt(16)
    s_barrier
    v_xor_b32 v16, 0, v19
    v_add_u32 v16, 32768, v16
    ds_read_b64_tr_b16 a[136:137], v16 offset:0
    ds_read_b64_tr_b16 a[138:139], v16 offset:16384
    ds_read_b64_tr_b16 a[140:141], v16 offset:8192
    ds_read_b64_tr_b16 a[142:143], v16 offset:24576
    v_xor_b32 v16, 64, v19
    v_add_u32 v16, 32768, v16
    ds_read_b64_tr_b16 a[168:169], v16 offset:0
    ds_read_b64_tr_b16 a[170:171], v16 offset:16384
    ds_read_b64_tr_b16 a[172:173], v16 offset:8192
    ds_read_b64_tr_b16 a[174:175], v16 offset:24576
    v_xor_b32 v16, 128, v19
    v_add_u32 v16, 32768, v16
    ds_read_b64_tr_b16 a[200:201], v16 offset:0
    ds_read_b64_tr_b16 a[202:203], v16 offset:16384
    ds_read_b64_tr_b16 a[204:205], v16 offset:8192
    ds_read_b64_tr_b16 a[206:207], v16 offset:24576
    v_xor_b32 v16, 192, v19
    v_add_u32 v16, 32768, v16
    ds_read_b64_tr_b16 a[232:233], v16 offset:0
    ds_read_b64_tr_b16 a[234:235], v16 offset:16384
    ds_read_b64_tr_b16 a[236:237], v16 offset:8192
    ds_read_b64_tr_b16 a[238:239], v16 offset:24576
    s_waitcnt lgkmcnt(0)
    s_waitcnt vmcnt(8)
    s_barrier
    v_xor_b32 v16, 0, v19
    v_add_u32 v16, 65536, v16
    ds_read_b64_tr_b16 a[144:145], v16 offset:0
    ds_read_b64_tr_b16 a[146:147], v16 offset:16384
    ds_read_b64_tr_b16 a[148:149], v16 offset:8192
    ds_read_b64_tr_b16 a[150:151], v16 offset:24576
    v_xor_b32 v16, 64, v19
    v_add_u32 v16, 65536, v16
    ds_read_b64_tr_b16 a[176:177], v16 offset:0
    ds_read_b64_tr_b16 a[178:179], v16 offset:16384
    ds_read_b64_tr_b16 a[180:181], v16 offset:8192
    ds_read_b64_tr_b16 a[182:183], v16 offset:24576
    v_xor_b32 v16, 128, v19
    v_add_u32 v16, 65536, v16
    ds_read_b64_tr_b16 a[208:209], v16 offset:0
    ds_read_b64_tr_b16 a[210:211], v16 offset:16384
    ds_read_b64_tr_b16 a[212:213], v16 offset:8192
    ds_read_b64_tr_b16 a[214:215], v16 offset:24576
    v_xor_b32 v16, 192, v19
    v_add_u32 v16, 65536, v16
    ds_read_b64_tr_b16 a[240:241], v16 offset:0
    ds_read_b64_tr_b16 a[242:243], v16 offset:16384
    ds_read_b64_tr_b16 a[244:245], v16 offset:8192
    ds_read_b64_tr_b16 a[246:247], v16 offset:24576
    s_waitcnt lgkmcnt(0)
    s_waitcnt vmcnt(0)
    s_barrier
    v_xor_b32 v16, 0, v19
    v_add_u32 v16, 98304, v16
    ds_read_b64_tr_b16 a[152:153], v16 offset:0
    ds_read_b64_tr_b16 a[154:155], v16 offset:16384
    ds_read_b64_tr_b16 a[156:157], v16 offset:8192
    ds_read_b64_tr_b16 a[158:159], v16 offset:24576
    v_xor_b32 v16, 64, v19
    v_add_u32 v16, 98304, v16
    ds_read_b64_tr_b16 a[184:185], v16 offset:0
    ds_read_b64_tr_b16 a[186:187], v16 offset:16384
    ds_read_b64_tr_b16 a[188:189], v16 offset:8192
    ds_read_b64_tr_b16 a[190:191], v16 offset:24576
    v_xor_b32 v16, 128, v19
    v_add_u32 v16, 98304, v16
    ds_read_b64_tr_b16 a[216:217], v16 offset:0
    ds_read_b64_tr_b16 a[218:219], v16 offset:16384
    ds_read_b64_tr_b16 a[220:221], v16 offset:8192
    ds_read_b64_tr_b16 a[222:223], v16 offset:24576
    v_xor_b32 v16, 192, v19
    v_add_u32 v16, 98304, v16
    ds_read_b64_tr_b16 a[248:249], v16 offset:0
    ds_read_b64_tr_b16 a[250:251], v16 offset:16384
    ds_read_b64_tr_b16 a[252:253], v16 offset:8192
    ds_read_b64_tr_b16 a[254:255], v16 offset:24576
    s_waitcnt lgkmcnt(0)
    s_barrier
L_fw_42:
    v_and_b32 v32, 31, v0
    v_lshrrev_b32 v33, 5, v0
    v_and_b32 v34, 15, v0
    v_lshrrev_b32 v35, 4, v0
    v_lshl_add_u32 v8, v33, 4, v34
    v_lshlrev_b32 v8, 4, v8
    v_bfe_u32 v9, v0, 4, 1
    v_lshl_add_u32 v8, v9, 10, v8
    s_lshl_b32 s54, s8, 11
    s_add_u32 s54, s54, 65536
    v_add_u32 v10, s54, v8
    s_and_b32 s54, s8, 1
    s_lshl_b32 s54, s54, 10
    s_add_u32 s54, s54, 65536
    v_add_u32 v21, s54, v1
    s_lshl_b32 s54, s8, 5
    v_add_u32 v8, s54, v34
    v_lshlrev_b32 v8, 5, v8
    v_lshl_add_u32 v8, v35, 3, v8
    v_add_u32 v11, 81920, v8
    v_bfe_u32 v8, v0, 5, 1
    v_lshlrev_b32 v8, 4, v8
    v_bfe_u32 v9, v0, 4, 1
    v_lshl_add_u32 v8, v9, 2, v8
    v_bfe_u32 v9, v0, 2, 2
    v_add_u32 v8, v8, v9
    v_and_b32 v9, 3, v0
    v_lshlrev_b32 v9, 3, v9
    v_lshl_add_u32 v8, v8, 5, v9
    v_add_u32 v20, 81920, v8
    v_lshrrev_b32 v8, 1, v35
    v_lshlrev_b32 v8, 10, v8
    v_and_b32 v9, 1, v35
    v_lshl_add_u32 v9, v9, 5, v34
    v_lshl_add_u32 v8, v9, 4, v8
    s_lshr_b32 s54, s8, 1
    s_lshl_b32 s54, s54, 12
    s_and_b32 s55, s8, 1
    s_lshl_b32 s55, s55, 8
    s_add_u32 s54, s54, s55
    s_add_u32 s54, s54, 73728
    v_add_u32 v16, s54, v8
    s_lshl_b32 s54, s8, 18
    s_lshl_b32 s55, s9, 10
    s_add_u32 s54, s54, s55
    v_add_u32 v17, s54, v1
    s_lshr_b32 s54, s8, 1
    s_lshl_b32 s54, s54, 5
    s_and_b32 s55, s8, 1
    s_lshl_b32 s55, s55, 4
    s_add_u32 s54, s54, s55
    v_add_u32 v8, s54, v34
    v_lshlrev_b32 v8, 4, v8
    v_lshl_add_u32 v8, v35, 10, v8
    s_lshl_b32 s54, s9, 15
    v_add_u32 v18, s54, v8
    s_and_b32 s54, s8, 1
    s_lshl_b32 s54, s54, 4
    v_add_u32 v8, s54, v34
    v_lshlrev_b32 v8, 10, v8
    v_lshl_add_u32 v8, v35, 4, v8
    s_lshl_b32 s54, s9, 5
    s_lshr_b32 s55, s8, 1
    s_lshl_b32 s55, s55, 3
    s_add_u32 s54, s54, s55
    v_add_u32 v19, s54, v8
    s_lshl_b32 s54, s9, 11
    s_lshl_b32 s55, s8, 9
    s_add_u32 s54, s54, s55
    v_add_u32 v22, s54, v1
    v_add_u32 v23, 65536, v1
    s_and_b32 s54, s8, 1
    s_lshl_b32 s54, s54, 4
    v_add_u32 v8, s54, v34
    v_lshlrev_b32 v9, 2, v35
    v_mov_b32 v36, 0xf149f2ca
    v_add_u32 v37, 0, v9
    v_cmp_gt_u32 vcc, v37, v8
    s_nop 1
    v_cndmask_b32 v24, 0, v36, vcc
    v_add_u32 v37, 1, v9
    v_cmp_gt_u32 vcc, v37, v8
    s_nop 1
    v_cndmask_b32 v25, 0, v36, vcc
    v_add_u32 v37, 2, v9
    v_cmp_gt_u32 vcc, v37, v8
    s_nop 1
    v_cndmask_b32 v26, 0, v36, vcc
    v_add_u32 v37, 3, v9
    v_cmp_gt_u32 vcc, v37, v8
    s_nop 1
    v_cndmask_b32 v27, 0, v36, vcc
    v_add_u32 v37, 16, v9
    v_cmp_gt_u32 vcc, v37, v8
    s_nop 1
    v_cndmask_b32 v28, 0, v36, vcc
    v_add_u32 v37, 17, v9
    v_cmp_gt_u32 vcc, v37, v8
    s_nop 1
    v_cndmask_b32 v29, 0, v36, vcc
    v_add_u32 v37, 18, v9
    v_cmp_gt_u32 vcc, v37, v8
    s_nop 1
    v_cndmask_b32 v30, 0, v36, vcc
    v_add_u32 v37, 19, v9
    v_cmp_gt_u32 vcc, v37, v8
    s_nop 1
    v_cndmask_b32 v31, 0, v36, vcc
    v_mov_b32 v172, 0x3f803f80
    v_mov_b32 v173, 0x3f803f80
    v_mov_b32 v174, 0x3f803f80
    v_mov_b32 v175, 0x3f803f80
    v_and_b32 v8, 7, v0
    v_lshrrev_b32 v9, 1, v8
    v_and_b32 v8, 1, v8
    v_lshlrev_b32 v8, 4, v8
    v_mov_b32 v36, 0x3f80
    v_lshlrev_b32 v8, v8, v36
    v_cmp_eq_u32 vcc, 0, v9
    s_nop 1
    v_cndmask_b32 v176, 0, v8, vcc
    v_cmp_eq_u32 vcc, 1, v9
    s_nop 1
    v_cndmask_b32 v177, 0, v8, vcc
    v_cmp_eq_u32 vcc, 2, v9
    s_nop 1
    v_cndmask_b32 v178, 0, v8, vcc
    v_cmp_eq_u32 vcc, 3, v9
    s_nop 1
    v_cndmask_b32 v179, 0, v8, vcc
    s_mov_b32 s48, 0x3e0293ee
    s_lshl_b32 s54, s3, 21
    s_add_u32 s54, s54, 118489088
    s_add_u32 s28, s4, s54
    s_addc_u32 s29, s5, 0
    s_lshl_b32 s54, s3, 7
    s_add_u32 s54, s54, 117452800
    s_add_u32 s30, s4, s54
    s_addc_u32 s31, s5, 0
    s_lshl_b32 s54, s10, 5
    s_add_u32 s54, s54, s9
    s_lshl_b32 s54, s54, 6
    s_add_u32 s54, s54, 117444608
    s_add_u32 s32, s4, s54
    s_addc_u32 s33, s5, 0
    s_lshl_b32 s54, s13, 5
    s_add_u32 s54, s54, s9
    s_lshl_b32 s54, s54, 6
    s_add_u32 s54, s54, 117456896
    s_add_u32 s34, s4, s54
    s_addc_u32 s35, s5, 0
    s_cmp_eq_u32 s13, 0
    s_cselect_b32 s22, 22, 21
    s_mov_b32 s21, 0
    s_mov_b32 s23, 0
    v_and_b32 v191, 31, v0
    v_lshlrev_b32 v191, 2, v191
    s_mov_b32 s46, 86016
    s_lshl_b32 s54, s10, 6
    s_add_u32 s54, s54, s20
    s_lshl_b32 s54, s54, 5
    s_add_u32 s54, s54, s9
    s_lshl_b32 s54, s54, 14
    s_lshl_b32 s55, s8, 12
    s_add_u32 s54, s54, s55
    s_add_u32 s44, s4, s54
    s_addc_u32 s45, s5, 0
    s_add_u32 s47, s55, s46
    s_mov_b32 m0, s47
    s_nop 0
    global_load_lds_dwordx4 v1, s[44:45] offset:0 sc1
    global_load_lds_dwordx4 v1, s[44:45] offset:1024 sc1
    global_load_lds_dwordx4 v1, s[44:45] offset:2048 sc1
    global_load_lds_dwordx4 v1, s[44:45] offset:3072 sc1
    s_mov_b32 s38, 0
    s_cmp_eq_u32 s10, 1
    s_cbranch_scc1 L_f_sideB
.p2align 6
L_f_loopA:
    s_waitcnt vmcnt(0)
    s_barrier
    global_load_dword v190, v191, s[30:31] sc1
    s_mov_b64 exec, 1
    global_load_dword v189, v1, s[32:33] sc1
    s_mov_b64 exec, -1
    v_add_u32 v12, s23, v4
    v_add_u32 v13, s23, v5
    v_add_u32 v14, s23, v6
    v_add_u32 v15, s23, v7
    v_add_u32 v3, s46, v1
    ds_read_b128 v[64:67], v12 offset:0
    ds_read_b128 v[68:71], v13 offset:0
    ds_read_b128 v[72:75], v14 offset:0
    s_lshl_b32 s54, s10, 6
    s_add_u32 s54, s54, s20
    s_lshl_b32 s54, s54, 5
    s_add_u32 s54, s54, s9
    s_lshl_b32 s55, s54, 13
    s_add_u32 s55, s55, 67108864
    s_add_u32 s36, s4, s55
    s_addc_u32 s37, s5, 0
    s_add_u32 s56, s20, 3
    s_min_u32 s56, s56, 63
    s_lshl_b32 s54, s56, 15
    s_add_u32 s14, s18, s54
    s_addc_u32 s15, s19, 0
    s_xor_b32 s57, s23, 32768
    s_lshl_b32 s54, s8, 13
    s_add_u32 s57, s57, s54
    s_xor_b32 s46, s46, 49152
    s_lshl_b32 s54, s10, 6
    s_add_u32 s54, s54, s56
    s_lshl_b32 s54, s54, 5
    s_add_u32 s54, s54, s9
    s_lshl_b32 s54, s54, 14
    s_lshl_b32 s55, s8, 12
    s_add_u32 s54, s54, s55
    s_add_u32 s44, s4, s54
    s_addc_u32 s45, s5, 0
    s_add_u32 s47, s55, s46
    s_sub_u32 s54, s21, 1
    s_and_b32 s54, s54, 1
    s_lshl_b32 s54, s54, 20
    s_add_u32 s64, s28, s54
    s_addc_u32 s65, s29, 0
    s_lshl_b32 s54, s38, 16
    s_add_u32 s54, s54, 136314880
    s_cmp_eq_u32 s21, 0
    s_cselect_b32 s54, 141557760, s54
    s_add_u32 s40, s4, s54
    s_addc_u32 s41, s5, 0
    s_lshl_b32 s54, s38, 15
    s_add_u32 s42, s26, s54
    s_addc_u32 s43, s27, 0
    s_cmp_lg_u32 s21, 0
    s_cbranch_scc1 L_od_47
    s_add_u32 s42, s4, 141819904
    s_addc_u32 s43, s5, 0
L_od_47:
    s_waitcnt lgkmcnt(2)
    v_mfma_f32_32x32x16_bf16 v[32:47], a[0:3], v[64:67], 0
    ds_read_b128 v[76:79], v15 offset:0
    s_waitcnt lgkmcnt(2)
    v_mfma_f32_32x32x16_bf16 v[32:47], a[4:7], v[68:71], v[32:47]
    ds_read_b128 v[64:67], v12 offset:1024
    s_add_u32 m0, s57, 0
    s_nop 0
    global_load_lds_dwordx4 v2, s[14:15] offset:0
    s_waitcnt lgkmcnt(2)
    v_mfma_f32_32x32x16_bf16 v[32:47], a[8:11], v[72:75], v[32:47]
    ds_read_b128 v[68:71], v13 offset:1024
    s_add_u32 m0, s57, 896
    s_nop 0
    global_load_lds_dwordx4 v2, s[14:15] offset:128
    s_waitcnt lgkmcnt(2)
    v_mfma_f32_32x32x16_bf16 v[32:47], a[12:15], v[76:79], v[32:47]
    ds_read_b128 v[72:75], v14 offset:1024
    s_add_u32 m0, s57, 1792
    s_nop 0
    global_load_lds_dwordx4 v2, s[14:15] offset:256
    s_waitcnt lgkmcnt(2)
    v_mfma_f32_32x32x16_bf16 v[32:47], a[16:19], v[64:67], v[32:47]
    ds_read_b128 v[76:79], v15 offset:1024
    s_add_u32 m0, s57, 2688
    s_nop 0
    global_load_lds_dwordx4 v2, s[14:15] offset:384
    s_waitcnt lgkmcnt(2)
    v_mfma_f32_32x32x16_bf16 v[32:47], a[20:23], v[68:71], v[32:47]
    ds_read_b128 v[64:67], v12 offset:2048
    s_add_u32 m0, s57, 3584
    s_nop 0
    global_load_lds_dwordx4 v2, s[14:15] offset:512
    s_waitcnt lgkmcnt(2)
    v_mfma_f32_32x32x16_bf16 v[32:47], a[24:27], v[72:75], v[32:47]
    ds_read_b128 v[68:71], v13 offset:2048
    s_add_u32 m0, s57, 4480
    s_nop 0
    global_load_lds_dwordx4 v2, s[14:15] offset:640
    s_waitcnt lgkmcnt(2)
    v_mfma_f32_32x32x16_bf16 v[32:47], a[28:31], v[76:79], v[32:47]
    ds_read_b128 v[72:75], v14 offset:2048
    s_add_u32 m0, s57, 5376
    s_nop 0
    global_load_lds_dwordx4 v2, s[14:15] offset:768
    s_waitcnt lgkmcnt(2)
    v_mfma_f32_32x32x16_bf16 v[32:47], a[32:35], v[64:67], v[32:47]
    ds_read_b128 v[76:79], v15 offset:2048
    s_add_u32 m0, s57, 6272
    s_nop 0
    global_load_lds_dwordx4 v2, s[14:15] offset:896
    s_waitcnt lgkmcnt(2)
    v_mfma_f32_32x32x16_bf16 v[32:47], a[36:39], v[68:71], v[32:47]
    ds_read_b128 v[64:67], v12 offset:3072
    s_mov_b32 m0, s47
    s_nop 0
    global_load_lds_dwordx4 v1, s[44:45] offset:0 sc1
    s_waitcnt lgkmcnt(2)
    v_mfma_f32_32x32x16_bf16 v[32:47], a[40:43], v[72:75], v[32:47]
    ds_read_b128 v[68:71], v13 offset:3072
    global_load_lds_dwordx4 v1, s[44:45] offset:1024 sc1
    s_waitcnt lgkmcnt(2)
    v_mfma_f32_32x32x16_bf16 v[32:47], a[44:47], v[76:79], v[32:47]
    ds_read_b128 v[72:75], v14 offset:3072
    global_load_lds_dwordx4 v1, s[44:45] offset:2048 sc1
    s_waitcnt lgkmcnt(2)
    v_mfma_f32_32x32x16_bf16 v[32:47], a[48:51], v[64:67], v[32:47]
    ds_read_b128 v[76:79], v15 offset:3072
    global_load_lds_dwordx4 v1, s[44:45] offset:3072 sc1
    s_waitcnt lgkmcnt(2)
    v_mfma_f32_32x32x16_bf16 v[32:47], a[52:55], v[68:71], v[32:47]
    ds_read_b128 v[64:67], v12 offset:4096
    s_waitcnt vmcnt(13)
    v_cmp_gt_u32 vcc, s21, v190
    s_cbranch_vccnz L_flrslow_48
L_flrok_49:
    s_waitcnt lgkmcnt(2)
    v_mfma_f32_32x32x16_bf16 v[32:47], a[56:59], v[72:75], v[32:47]
    ds_read_b128 v[68:71], v13 offset:4096
    global_load_dwordx4 v[192:195], v18, s[64:65] sc1
    s_add_u32 s64, s64, 4096
    s_addc_u32 s65, s65, 0
    s_waitcnt lgkmcnt(2)
    v_mfma_f32_32x32x16_bf16 v[32:47], a[60:63], v[76:79], v[32:47]
    ds_read_b128 v[72:75], v14 offset:4096
    s_waitcnt lgkmcnt(2)
    v_mfma_f32_32x32x16_bf16 v[32:47], a[64:67], v[64:67], v[32:47]
    ds_read_b128 v[76:79], v15 offset:4096
    global_load_dwordx4 v[196:199], v18, s[64:65] sc1
    s_add_u32 s64, s64, 4096
    s_addc_u32 s65, s65, 0
    s_waitcnt lgkmcnt(2)
    v_mfma_f32_32x32x16_bf16 v[32:47], a[68:71], v[68:71], v[32:47]
    ds_read_b128 v[64:67], v12 offset:5120
    s_waitcnt lgkmcnt(2)
    v_mfma_f32_32x32x16_bf16 v[32:47], a[72:75], v[72:75], v[32:47]
    ds_read_b128 v[68:71], v13 offset:5120
    global_load_dwordx4 v[200:203], v18, s[64:65] sc1
    s_add_u32 s64, s64, 4096
    s_addc_u32 s65, s65, 0
    s_waitcnt lgkmcnt(2)
    v_mfma_f32_32x32x16_bf16 v[32:47], a[76:79], v[76:79], v[32:47]
    ds_read_b128 v[72:75], v14 offset:5120
    s_waitcnt lgkmcnt(2)
    v_mfma_f32_32x32x16_bf16 v[32:47], a[80:83], v[64:67], v[32:47]
    ds_read_b128 v[76:79], v15 offset:5120
    global_load_dwordx4 v[204:207], v18, s[64:65] sc1
    s_add_u32 s64, s64, 4096
    s_addc_u32 s65, s65, 0
    s_waitcnt lgkmcnt(2)
    v_mfma_f32_32x32x16_bf16 v[32:47], a[84:87], v[68:71], v[32:47]
    ds_read_b128 v[64:67], v12 offset:6144
    s_waitcnt lgkmcnt(2)
    v_mfma_f32_32x32x16_bf16 v[32:47], a[88:91], v[72:75], v[32:47]
    ds_read_b128 v[68:71], v13 offset:6144
    global_load_dwordx4 v[208:211], v18, s[64:65] sc1
    s_add_u32 s64, s64, 4096
    s_addc_u32 s65, s65, 0
    s_waitcnt lgkmcnt(2)
    v_mfma_f32_32x32x16_bf16 v[32:47], a[92:95], v[76:79], v[32:47]
    ds_read_b128 v[72:75], v14 offset:6144
    s_waitcnt lgkmcnt(2)
    v_mfma_f32_32x32x16_bf16 v[32:47], a[96:99], v[64:67], v[32:47]
    ds_read_b128 v[76:79], v15 offset:6144
    global_load_dwordx4 v[212:215], v18, s[64:65] sc1
    s_add_u32 s64, s64, 4096
    s_addc_u32 s65, s65, 0
    s_waitcnt lgkmcnt(2)
    v_mfma_f32_32x32x16_bf16 v[32:47], a[100:103], v[68:71], v[32:47]
    ds_read_b128 v[64:67], v12 offset:7168
    s_waitcnt lgkmcnt(2)
    v_mfma_f32_32x32x16_bf16 v[32:47], a[104:107], v[72:75], v[32:47]
    ds_read_b128 v[68:71], v13 offset:7168
    global_load_dwordx4 v[216:219], v18, s[64:65] sc1
    s_add_u32 s64, s64, 4096
    s_addc_u32 s65, s65, 0
    s_waitcnt lgkmcnt(2)
    v_mfma_f32_32x32x16_bf16 v[32:47], a[108:111], v[76:79], v[32:47]
    ds_read_b128 v[72:75], v14 offset:7168
    s_waitcnt lgkmcnt(2)
    v_mfma_f32_32x32x16_bf16 v[32:47], a[112:115], v[64:67], v[32:47]
    ds_read_b128 v[76:79], v15 offset:7168
    global_load_dwordx4 v[220:223], v18, s[64:65] sc1
    s_waitcnt lgkmcnt(2)
    v_mfma_f32_32x32x16_bf16 v[32:47], a[116:119], v[68:71], v[32:47]
    s_waitcnt lgkmcnt(1)
    v_mfma_f32_32x32x16_bf16 v[32:47], a[120:123], v[72:75], v[32:47]
    s_waitcnt lgkmcnt(0)
    v_mfma_f32_32x32x16_bf16 v[32:47], a[124:127], v[76:79], v[32:47]
    s_add_u32 s58, s20, 1
    s_waitcnt vmcnt(20)
    v_readfirstlane_b32 s59, v189
    s_nop 0
    s_cmp_lt_u32 s59, s58
    s_cbranch_scc1 L_flmslow_50
L_flmok_51:
    s_lshl_b32 s54, s8, 10
    s_add_u32 s14, s36, s54
    s_addc_u32 s15, s37, 0
    global_load_dwordx2 v[128:129], v1, s[14:15] sc1
    s_lshr_b32 s54, s8, 1
    s_lshl_b32 s54, s54, 11
    s_add_u32 s14, s36, s54
    s_addc_u32 s15, s37, 0
    global_load_dwordx2 v[130:131], v1, s[14:15] offset:8 sc1
    global_load_dwordx2 v[132:133], v1, s[14:15] offset:1032 sc1
    v_cvt_pk_bf16_f32 v48, v32, v33
    v_cvt_pk_bf16_f32 v49, v34, v35
    v_cvt_pk_bf16_f32 v50, v36, v37
    v_cvt_pk_bf16_f32 v51, v38, v39
    v_cvt_pk_bf16_f32 v52, v40, v41
    v_cvt_pk_bf16_f32 v53, v42, v43
    v_cvt_pk_bf16_f32 v54, v44, v45
    v_cvt_pk_bf16_f32 v55, v46, v47
    ds_write_b128 v10, v[48:51]
    ds_write_b128 v10, v[52:55] offset:512
    s_waitcnt vmcnt(10)
    v_mfma_f32_16x16x32_bf16 v[180:183], v[176:179], v[192:195], 0
    s_waitcnt vmcnt(9)
    v_mfma_f32_16x16x32_bf16 v[180:183], v[176:179], v[196:199], v[180:183]
    s_waitcnt vmcnt(8)
    v_mfma_f32_16x16x32_bf16 v[180:183], v[176:179], v[200:203], v[180:183]
    s_waitcnt vmcnt(7)
    v_mfma_f32_16x16x32_bf16 v[180:183], v[176:179], v[204:207], v[180:183]
    s_waitcnt vmcnt(6)
    v_mfma_f32_16x16x32_bf16 v[180:183], v[176:179], v[208:211], v[180:183]
    s_waitcnt vmcnt(5)
    v_mfma_f32_16x16x32_bf16 v[180:183], v[176:179], v[212:215], v[180:183]
    s_waitcnt vmcnt(4)
    v_mfma_f32_16x16x32_bf16 v[180:183], v[176:179], v[216:219], v[180:183]
    s_waitcnt vmcnt(3)
    v_mfma_f32_16x16x32_bf16 v[180:183], v[176:179], v[220:223], v[180:183]
    ds_read_b128 v[80:83], v3 offset:0
    ds_read_b128 v[84:87], v3 offset:1024
    ds_read_b128 v[88:91], v3 offset:2048
    ds_read_b128 v[92:95], v3 offset:3072
    ds_read_b128 v[96:99], v3 offset:4096
    ds_read_b128 v[100:103], v3 offset:5120
    ds_read_b128 v[104:107], v3 offset:6144
    ds_read_b128 v[108:111], v3 offset:7168
    s_lshr_b32 s54, s8, 1
    s_lshl_b32 s54, s54, 12
    s_add_u32 s54, s54, 8192
    v_add_u32 v8, s54, v3
    ds_read_b128 v[112:115], v8 offset:0
    ds_read_b128 v[116:119], v8 offset:1024
    ds_read_b128 v[120:123], v8 offset:2048
    ds_read_b128 v[124:127], v8 offset:3072
    v_min_u32 v180, -2, v180
    s_mov_b32 exec_hi, 0
    global_store_dwordx4 v22, v[180:183], s[40:41] sc1
    s_mov_b64 exec, -1
    s_waitcnt vmcnt(3)
    ds_write_b32 v11, v128
    ds_write_b32 v11, v129 offset:512
    s_waitcnt lgkmcnt(0)
    s_barrier
    ds_read_b128 v[64:67], v21 offset:0
    ds_read_b128 v[68:71], v21 offset:2048
    ds_read_b128 v[72:75], v21 offset:4096
    ds_read_b128 v[76:79], v21 offset:6144
    ds_read_b64_tr_b16 v[136:137], v20 offset:0
    ds_read_b64_tr_b16 v[138:139], v20 offset:256
    ds_read_b64_tr_b16 v[140:141], v20 offset:1024
    ds_read_b64_tr_b16 v[142:143], v20 offset:1280
    ds_read_b64_tr_b16 v[144:145], v20 offset:2048
    ds_read_b64_tr_b16 v[146:147], v20 offset:2304
    ds_read_b64_tr_b16 v[148:149], v20 offset:3072
    ds_read_b64_tr_b16 v[150:151], v20 offset:3328
    s_waitcnt vmcnt(1)
    s_waitcnt lgkmcnt(8)
    v_mfma_f32_16x16x32_bf16 v[32:35], v[80:83], v[64:67], v[24:27]
    v_mfma_f32_16x16x32_bf16 v[36:39], v[96:99], v[64:67], v[28:31]
    v_mfma_f32_16x16x32_bf16 v[32:35], v[84:87], v[68:71], v[32:35]
    v_mfma_f32_16x16x32_bf16 v[36:39], v[100:103], v[68:71], v[36:39]
    v_mfma_f32_16x16x32_bf16 v[32:35], v[88:91], v[72:75], v[32:35]
    v_mfma_f32_16x16x32_bf16 v[36:39], v[104:107], v[72:75], v[36:39]
    v_mfma_f32_16x16x32_bf16 v[32:35], v[92:95], v[76:79], v[32:35]
    v_mfma_f32_16x16x32_bf16 v[36:39], v[108:111], v[76:79], v[36:39]
    s_waitcnt lgkmcnt(0)
    v_mfma_f32_16x16x32_bf16 v[40:43], v[136:139], v[64:67], 0
    v_mfma_f32_16x16x32_bf16 v[40:43], v[140:143], v[68:71], v[40:43]
    v_mfma_f32_16x16x32_bf16 v[40:43], v[144:147], v[72:75], v[40:43]
    v_mfma_f32_16x16x32_bf16 v[40:43], v[148:151], v[76:79], v[40:43]
    s_nop 7
    v_max3_f32 v8, v32, v33, v34
    v_max3_f32 v9, v35, v36, v37
    v_max3_f32 v8, v8, v38, v39
    v_max3_f32 v8, v8, v40, v41
    v_max_f32 v8, v8, v9
    v_mov_b32 v9, v8
    s_nop 1
    v_permlane16_swap_b32 v8, v9
    v_max_f32 v8, v8, v9
    v_mov_b32 v9, v8
    s_nop 1
    v_permlane32_swap_b32 v8, v9
    v_max_f32 v8, v8, v9
    v_mul_f32 v8, s48, v8
    v_fma_f32 v32, v32, s48, -v8
    v_fma_f32 v33, v33, s48, -v8
    v_fma_f32 v34, v34, s48, -v8
    v_fma_f32 v35, v35, s48, -v8
    v_fma_f32 v36, v36, s48, -v8
    v_fma_f32 v37, v37, s48, -v8
    v_fma_f32 v38, v38, s48, -v8
    v_fma_f32 v39, v39, s48, -v8
    v_fma_f32 v40, v40, s48, -v8
    v_fma_f32 v41, v41, s48, -v8
    v_exp_f32 v32, v32
    v_exp_f32 v33, v33
    v_exp_f32 v34, v34
    v_exp_f32 v35, v35
    v_exp_f32 v36, v36
    v_exp_f32 v37, v37
    v_exp_f32 v38, v38
    v_exp_f32 v39, v39
    v_exp_f32 v40, v40
    v_exp_f32 v41, v41
    v_mov_b32 v49, 0
    v_mov_b32 v50, 0
    v_cvt_pk_bf16_f32 v44, v32, v33
    v_cvt_pk_bf16_f32 v45, v34, v35
    v_cvt_pk_bf16_f32 v46, v36, v37
    v_cvt_pk_bf16_f32 v47, v38, v39
    v_cvt_pk_bf16_f32 v48, v40, v41
    v_cvt_pk_bf16_f32 v51, v40, v41
    s_nop 1
    v_mfma_f32_16x16x32_bf16 v[168:171], v[172:175], v[44:47], 0
    v_mfma_f32_16x16x32_bf16 v[152:155], v[112:115], v[44:47], 0
    v_mfma_f32_16x16x32_bf16 v[156:159], v[116:119], v[44:47], 0
    v_mfma_f32_16x16x32_bf16 v[160:163], v[120:123], v[44:47], 0
    v_mfma_f32_16x16x32_bf16 v[164:167], v[124:127], v[44:47], 0
    v_mfma_f32_16x16x16_bf16 v[168:171], v[172:173], v[48:49], v[168:171]
    v_mfma_f32_16x16x16_bf16 v[152:155], v[130:131], v[48:49], v[152:155]
    v_mfma_f32_16x16x16_bf16 v[156:159], v[130:131], v[50:51], v[156:159]
    v_mfma_f32_16x16x16_bf16 v[160:163], v[132:133], v[48:49], v[160:163]
    v_mfma_f32_16x16x16_bf16 v[164:167], v[132:133], v[50:51], v[164:167]
    s_nop 7
    s_nop 1
    v_rcp_f32 v8, v168
    s_nop 0
    v_mul_f32 v152, v152, v8
    v_mul_f32 v153, v153, v8
    v_mul_f32 v154, v154, v8
    v_mul_f32 v155, v155, v8
    v_mul_f32 v156, v156, v8
    v_mul_f32 v157, v157, v8
    v_mul_f32 v158, v158, v8
    v_mul_f32 v159, v159, v8
    v_mul_f32 v160, v160, v8
    v_mul_f32 v161, v161, v8
    v_mul_f32 v162, v162, v8
    v_mul_f32 v163, v163, v8
    v_mul_f32 v164, v164, v8
    v_mul_f32 v165, v165, v8
    v_mul_f32 v166, v166, v8
    v_mul_f32 v167, v167, v8
    v_cvt_pk_bf16_f32 v152, v152, v153
    v_cvt_pk_bf16_f32 v153, v154, v155
    v_cvt_pk_bf16_f32 v154, v156, v157
    v_cvt_pk_bf16_f32 v155, v158, v159
    v_cvt_pk_bf16_f32 v156, v160, v161
    v_cvt_pk_bf16_f32 v157, v162, v163
    v_cvt_pk_bf16_f32 v158, v164, v165
    v_cvt_pk_bf16_f32 v159, v166, v167
    ds_write_b128 v16, v[152:155]
    ds_write_b128 v16, v[156:159] offset:2048
    s_and_b32 s54, s21, 1
    s_lshl_b32 s54, s54, 20
    s_add_u32 s14, s28, s54
    s_addc_u32 s15, s29, 0
    s_waitcnt lgkmcnt(0)
    s_barrier
    ds_read_b128 v[64:67], v23 offset:8192
    ds_read_b128 v[68:71], v23 offset:9216
    ds_read_b128 v[72:75], v23 offset:10240
    ds_read_b128 v[76:79], v23 offset:11264
    ds_read_b128 v[80:83], v23 offset:12288
    ds_read_b128 v[84:87], v23 offset:13312
    ds_read_b128 v[88:91], v23 offset:14336
    ds_read_b128 v[92:95], v23 offset:15360
    s_waitcnt lgkmcnt(7)
    v_mfma_f32_32x32x16_bf16 v[192:207], a[128:131], v[64:67], 0
    s_waitcnt lgkmcnt(6)
    v_mfma_f32_32x32x16_bf16 v[192:207], a[132:135], v[68:71], v[192:207]
    s_waitcnt lgkmcnt(5)
    v_mfma_f32_32x32x16_bf16 v[192:207], a[136:139], v[72:75], v[192:207]
    s_waitcnt lgkmcnt(4)
    v_mfma_f32_32x32x16_bf16 v[192:207], a[140:143], v[76:79], v[192:207]
    s_waitcnt lgkmcnt(3)
    v_mfma_f32_32x32x16_bf16 v[192:207], a[144:147], v[80:83], v[192:207]
    s_waitcnt lgkmcnt(2)
    v_mfma_f32_32x32x16_bf16 v[192:207], a[148:151], v[84:87], v[192:207]
    s_waitcnt lgkmcnt(1)
    v_mfma_f32_32x32x16_bf16 v[192:207], a[152:155], v[88:91], v[192:207]
    s_waitcnt lgkmcnt(0)
    v_mfma_f32_32x32x16_bf16 v[192:207], a[156:159], v[92:95], v[192:207]
    v_mfma_f32_32x32x16_bf16 v[208:223], a[160:163], v[64:67], 0
    v_mfma_f32_32x32x16_bf16 v[208:223], a[164:167], v[68:71], v[208:223]
    v_mfma_f32_32x32x16_bf16 v[208:223], a[168:171], v[72:75], v[208:223]
    v_cvt_pk_bf16_f32 v32, v192, v193
    v_cvt_pk_bf16_f32 v33, v194, v195
    v_cvt_pk_bf16_f32 v34, v196, v197
    v_mfma_f32_32x32x16_bf16 v[208:223], a[172:175], v[76:79], v[208:223]
    v_cvt_pk_bf16_f32 v35, v198, v199
    global_store_dwordx4 v17, v[32:35], s[14:15]
    s_add_u32 s14, s14, 32768
    v_mfma_f32_32x32x16_bf16 v[208:223], a[176:179], v[80:83], v[208:223]
    s_addc_u32 s15, s15, 0
    v_cvt_pk_bf16_f32 v36, v200, v201
    v_cvt_pk_bf16_f32 v37, v202, v203
    v_mfma_f32_32x32x16_bf16 v[208:223], a[180:183], v[84:87], v[208:223]
    v_cvt_pk_bf16_f32 v38, v204, v205
    v_cvt_pk_bf16_f32 v39, v206, v207
    global_store_dwordx4 v17, v[36:39], s[14:15]
    v_mfma_f32_32x32x16_bf16 v[208:223], a[184:187], v[88:91], v[208:223]
    s_add_u32 s14, s14, 32768
    s_addc_u32 s15, s15, 0
    v_mfma_f32_32x32x16_bf16 v[208:223], a[188:191], v[92:95], v[208:223]
    v_mfma_f32_32x32x16_bf16 v[224:239], a[192:195], v[64:67], 0
    v_mfma_f32_32x32x16_bf16 v[224:239], a[196:199], v[68:71], v[224:239]
    v_mfma_f32_32x32x16_bf16 v[224:239], a[200:203], v[72:75], v[224:239]
    v_cvt_pk_bf16_f32 v40, v208, v209
    v_cvt_pk_bf16_f32 v41, v210, v211
    v_cvt_pk_bf16_f32 v42, v212, v213
    v_mfma_f32_32x32x16_bf16 v[224:239], a[204:207], v[76:79], v[224:239]
    v_cvt_pk_bf16_f32 v43, v214, v215
    global_store_dwordx4 v17, v[40:43], s[14:15]
    s_add_u32 s14, s14, 32768
    v_mfma_f32_32x32x16_bf16 v[224:239], a[208:211], v[80:83], v[224:239]
    s_addc_u32 s15, s15, 0
    v_cvt_pk_bf16_f32 v44, v216, v217
    v_cvt_pk_bf16_f32 v45, v218, v219
    v_mfma_f32_32x32x16_bf16 v[224:239], a[212:215], v[84:87], v[224:239]
    v_cvt_pk_bf16_f32 v46, v220, v221
    v_cvt_pk_bf16_f32 v47, v222, v223
    global_store_dwordx4 v17, v[44:47], s[14:15]
    v_mfma_f32_32x32x16_bf16 v[224:239], a[216:219], v[88:91], v[224:239]
    s_add_u32 s14, s14, 32768
    s_addc_u32 s15, s15, 0
    v_mfma_f32_32x32x16_bf16 v[224:239], a[220:223], v[92:95], v[224:239]
    v_mfma_f32_32x32x16_bf16 v[240:255], a[224:227], v[64:67], 0
    v_mfma_f32_32x32x16_bf16 v[240:255], a[228:231], v[68:71], v[240:255]
    v_mfma_f32_32x32x16_bf16 v[240:255], a[232:235], v[72:75], v[240:255]
    v_cvt_pk_bf16_f32 v32, v224, v225
    v_cvt_pk_bf16_f32 v33, v226, v227
    v_cvt_pk_bf16_f32 v34, v228, v229
    v_mfma_f32_32x32x16_bf16 v[240:255], a[236:239], v[76:79], v[240:255]
    v_cvt_pk_bf16_f32 v35, v230, v231
    global_store_dwordx4 v17, v[32:35], s[14:15]
    s_add_u32 s14, s14, 32768
    v_mfma_f32_32x32x16_bf16 v[240:255], a[240:243], v[80:83], v[240:255]
    s_addc_u32 s15, s15, 0
    v_cvt_pk_bf16_f32 v36, v232, v233
    v_cvt_pk_bf16_f32 v37, v234, v235
    v_mfma_f32_32x32x16_bf16 v[240:255], a[244:247], v[84:87], v[240:255]
    v_cvt_pk_bf16_f32 v38, v236, v237
    v_cvt_pk_bf16_f32 v39, v238, v239
    global_store_dwordx4 v17, v[36:39], s[14:15]
    v_mfma_f32_32x32x16_bf16 v[240:255], a[248:251], v[88:91], v[240:255]
    s_add_u32 s14, s14, 32768
    s_addc_u32 s15, s15, 0
    v_mfma_f32_32x32x16_bf16 v[240:255], a[252:255], v[92:95], v[240:255]
    s_nop 15
    s_nop 3
    v_cvt_pk_bf16_f32 v40, v240, v241
    v_cvt_pk_bf16_f32 v41, v242, v243
    v_cvt_pk_bf16_f32 v42, v244, v245
    v_cvt_pk_bf16_f32 v43, v246, v247
    global_store_dwordx4 v17, v[40:43], s[14:15]
    s_add_u32 s14, s14, 32768
    s_addc_u32 s15, s15, 0
    v_cvt_pk_bf16_f32 v44, v248, v249
    v_cvt_pk_bf16_f32 v45, v250, v251
    v_cvt_pk_bf16_f32 v46, v252, v253
    v_cvt_pk_bf16_f32 v47, v254, v255
    global_store_dwordx4 v17, v[44:47], s[14:15]
    s_add_u32 s14, s14, 32768
    s_addc_u32 s15, s15, 0
    s_waitcnt vmcnt(0)
    s_barrier
    s_cmp_lg_u32 s8, 0
    s_cbranch_scc1 L_noflr_52
    s_add_u32 s54, s21, 1
    v_mov_b32 v8, s54
    s_lshl_b32 s54, s9, 2
    v_mov_b32 v9, s54
    s_mov_b64 exec, 1
    global_store_dword v9, v8, s[30:31]
    s_mov_b64 exec, -1
L_noflr_52:
    s_mov_b32 s38, s20
    s_add_u32 s20, s20, 3
    s_xor_b32 s23, s23, 32768
    s_add_u32 s21, s21, 1
    s_cmp_lt_u32 s21, s22
    s_cbranch_scc1 L_f_loopA
L_lastflr_53:
    global_load_dword v190, v191, s[30:31] sc1
    s_waitcnt vmcnt(0)
    v_cmp_gt_u32 vcc, s21, v190
    s_sub_u32 s12, s12, 1
    s_cbranch_scc1 L_fail
    s_cbranch_vccnz L_lastflr_53
    s_sub_u32 s54, s21, 1
    s_and_b32 s54, s54, 1
    s_lshl_b32 s54, s54, 20
    s_add_u32 s64, s28, s54
    s_addc_u32 s65, s29, 0
    global_load_dwordx4 v[192:195], v18, s[64:65] sc1
    s_add_u32 s64, s64, 4096
    s_addc_u32 s65, s65, 0
    global_load_dwordx4 v[196:199], v18, s[64:65] sc1
    s_add_u32 s64, s64, 4096
    s_addc_u32 s65, s65, 0
    global_load_dwordx4 v[200:203], v18, s[64:65] sc1
    s_add_u32 s64, s64, 4096
    s_addc_u32 s65, s65, 0
    global_load_dwordx4 v[204:207], v18, s[64:65] sc1
    s_add_u32 s64, s64, 4096
    s_addc_u32 s65, s65, 0
    global_load_dwordx4 v[208:211], v18, s[64:65] sc1
    s_add_u32 s64, s64, 4096
    s_addc_u32 s65, s65, 0
    global_load_dwordx4 v[212:215], v18, s[64:65] sc1
    s_add_u32 s64, s64, 4096
    s_addc_u32 s65, s65, 0
    global_load_dwordx4 v[216:219], v18, s[64:65] sc1
    s_add_u32 s64, s64, 4096
    s_addc_u32 s65, s65, 0
    global_load_dwordx4 v[220:223], v18, s[64:65] sc1
    s_lshl_b32 s54, s38, 16
    s_add_u32 s54, s54, 136314880
    s_cmp_eq_u32 s21, 0
    s_cselect_b32 s54, 141557760, s54
    s_add_u32 s40, s4, s54
    s_addc_u32 s41, s5, 0
    s_lshl_b32 s54, s38, 15
    s_add_u32 s42, s26, s54
    s_addc_u32 s43, s27, 0
    s_cmp_lg_u32 s21, 0
    s_cbranch_scc1 L_od_54
    s_add_u32 s42, s4, 141819904
    s_addc_u32 s43, s5, 0
L_od_54:
    s_waitcnt vmcnt(7)
    v_mfma_f32_16x16x32_bf16 v[180:183], v[176:179], v[192:195], 0
    s_waitcnt vmcnt(6)
    v_mfma_f32_16x16x32_bf16 v[180:183], v[176:179], v[196:199], v[180:183]
    s_waitcnt vmcnt(5)
    v_mfma_f32_16x16x32_bf16 v[180:183], v[176:179], v[200:203], v[180:183]
    s_waitcnt vmcnt(4)
    v_mfma_f32_16x16x32_bf16 v[180:183], v[176:179], v[204:207], v[180:183]
    s_waitcnt vmcnt(3)
    v_mfma_f32_16x16x32_bf16 v[180:183], v[176:179], v[208:211], v[180:183]
    s_waitcnt vmcnt(2)
    v_mfma_f32_16x16x32_bf16 v[180:183], v[176:179], v[212:215], v[180:183]
    s_waitcnt vmcnt(1)
    v_mfma_f32_16x16x32_bf16 v[180:183], v[176:179], v[216:219], v[180:183]
    s_waitcnt vmcnt(0)
    v_mfma_f32_16x16x32_bf16 v[180:183], v[176:179], v[220:223], v[180:183]
    s_nop 7
    s_nop 1
    v_min_u32 v180, -2, v180
    s_mov_b32 exec_hi, 0
    global_store_dwordx4 v22, v[180:183], s[40:41] sc1
    s_mov_b64 exec, -1
    s_waitcnt vmcnt(0)
    s_endpgm
L_f_sideB:
.p2align 6
L_f_loopB:
    s_waitcnt vmcnt(0)
    s_barrier
    global_load_dword v190, v191, s[30:31] sc1
    s_mov_b64 exec, 1
    global_load_dword v189, v1, s[32:33] sc1
    s_mov_b64 exec, -1
    v_add_u32 v12, s23, v4
    v_add_u32 v13, s23, v5
    v_add_u32 v14, s23, v6
    v_add_u32 v15, s23, v7
    v_add_u32 v3, s46, v1
    ds_read_b128 v[64:67], v12 offset:0
    ds_read_b128 v[68:71], v13 offset:0
    ds_read_b128 v[72:75], v14 offset:0
    s_lshl_b32 s54, s10, 6
    s_add_u32 s54, s54, s20
    s_lshl_b32 s54, s54, 5
    s_add_u32 s54, s54, s9
    s_lshl_b32 s55, s54, 13
    s_add_u32 s55, s55, 67108864
    s_add_u32 s36, s4, s55
    s_addc_u32 s37, s5, 0
    s_add_u32 s56, s20, 3
    s_min_u32 s56, s56, 63
    s_lshl_b32 s54, s56, 15
    s_add_u32 s14, s18, s54
    s_addc_u32 s15, s19, 0
    s_xor_b32 s57, s23, 32768
    s_lshl_b32 s54, s8, 13
    s_add_u32 s57, s57, s54
    s_xor_b32 s46, s46, 49152
    s_lshl_b32 s54, s10, 6
    s_add_u32 s54, s54, s56
    s_lshl_b32 s54, s54, 5
    s_add_u32 s54, s54, s9
    s_lshl_b32 s54, s54, 14
    s_lshl_b32 s55, s8, 12
    s_add_u32 s54, s54, s55
    s_add_u32 s44, s4, s54
    s_addc_u32 s45, s5, 0
    s_add_u32 s47, s55, s46
    s_sub_u32 s54, s21, 1
    s_and_b32 s54, s54, 1
    s_lshl_b32 s54, s54, 20
    s_add_u32 s64, s28, s54
    s_addc_u32 s65, s29, 0
    s_lshl_b32 s54, s38, 16
    s_add_u32 s54, s54, 136314880
    s_cmp_eq_u32 s21, 0
    s_cselect_b32 s54, 141557760, s54
    s_add_u32 s40, s4, s54
    s_addc_u32 s41, s5, 0
    s_lshl_b32 s54, s38, 15
    s_add_u32 s42, s26, s54
    s_addc_u32 s43, s27, 0
    s_cmp_lg_u32 s21, 0
    s_cbranch_scc1 L_od_55
    s_add_u32 s42, s4, 141819904
    s_addc_u32 s43, s5, 0
L_od_55:
    s_waitcnt lgkmcnt(2)
    v_mfma_f32_32x32x16_bf16 v[32:47], a[0:3], v[64:67], 0
    ds_read_b128 v[76:79], v15 offset:0
    s_waitcnt lgkmcnt(2)
    v_mfma_f32_32x32x16_bf16 v[32:47], a[4:7], v[68:71], v[32:47]
    ds_read_b128 v[64:67], v12 offset:1024
    s_add_u32 m0, s57, 0
    s_nop 0
    global_load_lds_dwordx4 v2, s[14:15] offset:0
    s_waitcnt lgkmcnt(2)
    v_mfma_f32_32x32x16_bf16 v[32:47], a[8:11], v[72:75], v[32:47]
    ds_read_b128 v[68:71], v13 offset:1024
    s_add_u32 m0, s57, 896
    s_nop 0
    global_load_lds_dwordx4 v2, s[14:15] offset:128
    s_waitcnt lgkmcnt(2)
    v_mfma_f32_32x32x16_bf16 v[32:47], a[12:15], v[76:79], v[32:47]
    ds_read_b128 v[72:75], v14 offset:1024
    s_add_u32 m0, s57, 1792
    s_nop 0
    global_load_lds_dwordx4 v2, s[14:15] offset:256
    s_waitcnt lgkmcnt(2)
    v_mfma_f32_32x32x16_bf16 v[32:47], a[16:19], v[64:67], v[32:47]
    ds_read_b128 v[76:79], v15 offset:1024
    s_add_u32 m0, s57, 2688
    s_nop 0
    global_load_lds_dwordx4 v2, s[14:15] offset:384
    s_waitcnt lgkmcnt(2)
    v_mfma_f32_32x32x16_bf16 v[32:47], a[20:23], v[68:71], v[32:47]
    ds_read_b128 v[64:67], v12 offset:2048
    s_add_u32 m0, s57, 3584
    s_nop 0
    global_load_lds_dwordx4 v2, s[14:15] offset:512
    s_waitcnt lgkmcnt(2)
    v_mfma_f32_32x32x16_bf16 v[32:47], a[24:27], v[72:75], v[32:47]
    ds_read_b128 v[68:71], v13 offset:2048
    s_add_u32 m0, s57, 4480
    s_nop 0
    global_load_lds_dwordx4 v2, s[14:15] offset:640
    s_waitcnt lgkmcnt(2)
    v_mfma_f32_32x32x16_bf16 v[32:47], a[28:31], v[76:79], v[32:47]
    ds_read_b128 v[72:75], v14 offset:2048
    s_add_u32 m0, s57, 5376
    s_nop 0
    global_load_lds_dwordx4 v2, s[14:15] offset:768
    s_waitcnt lgkmcnt(2)
    v_mfma_f32_32x32x16_bf16 v[32:47], a[32:35], v[64:67], v[32:47]
    ds_read_b128 v[76:79], v15 offset:2048
    s_add_u32 m0, s57, 6272
    s_nop 0
    global_load_lds_dwordx4 v2, s[14:15] offset:896
    s_waitcnt lgkmcnt(2)
    v_mfma_f32_32x32x16_bf16 v[32:47], a[36:39], v[68:71], v[32:47]
    ds_read_b128 v[64:67], v12 offset:3072
    s_mov_b32 m0, s47
    s_nop 0
    global_load_lds_dwordx4 v1, s[44:45] offset:0 sc1
    s_waitcnt lgkmcnt(2)
    v_mfma_f32_32x32x16_bf16 v[32:47], a[40:43], v[72:75], v[32:47]
    ds_read_b128 v[68:71], v13 offset:3072
    global_load_lds_dwordx4 v1, s[44:45] offset:1024 sc1
    s_waitcnt lgkmcnt(2)
    v_mfma_f32_32x32x16_bf16 v[32:47], a[44:47], v[76:79], v[32:47]
    ds_read_b128 v[72:75], v14 offset:3072
    global_load_lds_dwordx4 v1, s[44:45] offset:2048 sc1
    s_waitcnt lgkmcnt(2)
    v_mfma_f32_32x32x16_bf16 v[32:47], a[48:51], v[64:67], v[32:47]
    ds_read_b128 v[76:79], v15 offset:3072
    global_load_lds_dwordx4 v1, s[44:45] offset:3072 sc1
    s_waitcnt lgkmcnt(2)
    v_mfma_f32_32x32x16_bf16 v[32:47], a[52:55], v[68:71], v[32:47]
    ds_read_b128 v[64:67], v12 offset:4096
    s_waitcnt vmcnt(13)
    v_cmp_gt_u32 vcc, s21, v190
    s_cbranch_vccnz L_flrslow_56
L_flrok_57:
    s_waitcnt lgkmcnt(2)
    v_mfma_f32_32x32x16_bf16 v[32:47], a[56:59], v[72:75], v[32:47]
    ds_read_b128 v[68:71], v13 offset:4096
    global_load_dwordx4 v[192:195], v18, s[64:65] sc1
    s_add_u32 s64, s64, 4096
    s_addc_u32 s65, s65, 0
    s_waitcnt lgkmcnt(2)
    v_mfma_f32_32x32x16_bf16 v[32:47], a[60:63], v[76:79], v[32:47]
    ds_read_b128 v[72:75], v14 offset:4096
    s_waitcnt lgkmcnt(2)
    v_mfma_f32_32x32x16_bf16 v[32:47], a[64:67], v[64:67], v[32:47]
    ds_read_b128 v[76:79], v15 offset:4096
    global_load_dwordx4 v[196:199], v18, s[64:65] sc1
    s_add_u32 s64, s64, 4096
    s_addc_u32 s65, s65, 0
    s_waitcnt lgkmcnt(2)
    v_mfma_f32_32x32x16_bf16 v[32:47], a[68:71], v[68:71], v[32:47]
    ds_read_b128 v[64:67], v12 offset:5120
    s_waitcnt lgkmcnt(2)
    v_mfma_f32_32x32x16_bf16 v[32:47], a[72:75], v[72:75], v[32:47]
    ds_read_b128 v[68:71], v13 offset:5120
    global_load_dwordx4 v[200:203], v18, s[64:65] sc1
    s_add_u32 s64, s64, 4096
    s_addc_u32 s65, s65, 0
    s_waitcnt lgkmcnt(2)
    v_mfma_f32_32x32x16_bf16 v[32:47], a[76:79], v[76:79], v[32:47]
    ds_read_b128 v[72:75], v14 offset:5120
    s_waitcnt lgkmcnt(2)
    v_mfma_f32_32x32x16_bf16 v[32:47], a[80:83], v[64:67], v[32:47]
    ds_read_b128 v[76:79], v15 offset:5120
    global_load_dwordx4 v[204:207], v18, s[64:65] sc1
    s_add_u32 s64, s64, 4096
    s_addc_u32 s65, s65, 0
    s_waitcnt lgkmcnt(2)
    v_mfma_f32_32x32x16_bf16 v[32:47], a[84:87], v[68:71], v[32:47]
    ds_read_b128 v[64:67], v12 offset:6144
    s_waitcnt lgkmcnt(2)
    v_mfma_f32_32x32x16_bf16 v[32:47], a[88:91], v[72:75], v[32:47]
    ds_read_b128 v[68:71], v13 offset:6144
    global_load_dwordx4 v[208:211], v18, s[64:65] sc1
    s_add_u32 s64, s64, 4096
    s_addc_u32 s65, s65, 0
    s_waitcnt lgkmcnt(2)
    v_mfma_f32_32x32x16_bf16 v[32:47], a[92:95], v[76:79], v[32:47]
    ds_read_b128 v[72:75], v14 offset:6144
    s_waitcnt lgkmcnt(2)
    v_mfma_f32_32x32x16_bf16 v[32:47], a[96:99], v[64:67], v[32:47]
    ds_read_b128 v[76:79], v15 offset:6144
    global_load_dwordx4 v[212:215], v18, s[64:65] sc1
    s_add_u32 s64, s64, 4096
    s_addc_u32 s65, s65, 0
    s_waitcnt lgkmcnt(2)
    v_mfma_f32_32x32x16_bf16 v[32:47], a[100:103], v[68:71], v[32:47]
    ds_read_b128 v[64:67], v12 offset:7168
    s_waitcnt lgkmcnt(2)
    v_mfma_f32_32x32x16_bf16 v[32:47], a[104:107], v[72:75], v[32:47]
    ds_read_b128 v[68:71], v13 offset:7168
    global_load_dwordx4 v[216:219], v18, s[64:65] sc1
    s_add_u32 s64, s64, 4096
    s_addc_u32 s65, s65, 0
    s_waitcnt lgkmcnt(2)
    v_mfma_f32_32x32x16_bf16 v[32:47], a[108:111], v[76:79], v[32:47]
    ds_read_b128 v[72:75], v14 offset:7168
    s_waitcnt lgkmcnt(2)
    v_mfma_f32_32x32x16_bf16 v[32:47], a[112:115], v[64:67], v[32:47]
    ds_read_b128 v[76:79], v15 offset:7168
    global_load_dwordx4 v[220:223], v18, s[64:65] sc1
    s_waitcnt lgkmcnt(2)
    v_mfma_f32_32x32x16_bf16 v[32:47], a[116:119], v[68:71], v[32:47]
    s_waitcnt lgkmcnt(1)
    v_mfma_f32_32x32x16_bf16 v[32:47], a[120:123], v[72:75], v[32:47]
    s_waitcnt lgkmcnt(0)
    v_mfma_f32_32x32x16_bf16 v[32:47], a[124:127], v[76:79], v[32:47]
    s_add_u32 s58, s20, 1
    s_waitcnt vmcnt(20)
    v_readfirstlane_b32 s59, v189
    s_nop 0
    s_cmp_lt_u32 s59, s58
    s_cbranch_scc1 L_flmslow_58
L_flmok_59:
    s_lshl_b32 s54, s8, 10
    s_add_u32 s14, s36, s54
    s_addc_u32 s15, s37, 0
    global_load_dwordx2 v[128:129], v1, s[14:15] sc1
    s_lshr_b32 s54, s8, 1
    s_lshl_b32 s54, s54, 11
    s_add_u32 s14, s36, s54
    s_addc_u32 s15, s37, 0
    global_load_dwordx2 v[130:131], v1, s[14:15] offset:8 sc1
    global_load_dwordx2 v[132:133], v1, s[14:15] offset:1032 sc1
    v_cvt_pk_bf16_f32 v48, v32, v33
    v_cvt_pk_bf16_f32 v49, v34, v35
    v_cvt_pk_bf16_f32 v50, v36, v37
    v_cvt_pk_bf16_f32 v51, v38, v39
    v_cvt_pk_bf16_f32 v52, v40, v41
    v_cvt_pk_bf16_f32 v53, v42, v43
    v_cvt_pk_bf16_f32 v54, v44, v45
    v_cvt_pk_bf16_f32 v55, v46, v47
    ds_write_b128 v10, v[48:51]
    ds_write_b128 v10, v[52:55] offset:512
    s_waitcnt vmcnt(10)
    v_mfma_f32_16x16x32_bf16 v[180:183], v[176:179], v[192:195], 0
    s_waitcnt vmcnt(9)
    v_mfma_f32_16x16x32_bf16 v[180:183], v[176:179], v[196:199], v[180:183]
    s_waitcnt vmcnt(8)
    v_mfma_f32_16x16x32_bf16 v[180:183], v[176:179], v[200:203], v[180:183]
    s_waitcnt vmcnt(7)
    v_mfma_f32_16x16x32_bf16 v[180:183], v[176:179], v[204:207], v[180:183]
    s_waitcnt vmcnt(6)
    v_mfma_f32_16x16x32_bf16 v[180:183], v[176:179], v[208:211], v[180:183]
    s_waitcnt vmcnt(5)
    v_mfma_f32_16x16x32_bf16 v[180:183], v[176:179], v[212:215], v[180:183]
    s_waitcnt vmcnt(4)
    v_mfma_f32_16x16x32_bf16 v[180:183], v[176:179], v[216:219], v[180:183]
    s_waitcnt vmcnt(3)
    v_mfma_f32_16x16x32_bf16 v[180:183], v[176:179], v[220:223], v[180:183]
    ds_read_b128 v[80:83], v3 offset:0
    ds_read_b128 v[84:87], v3 offset:1024
    ds_read_b128 v[88:91], v3 offset:2048
    ds_read_b128 v[92:95], v3 offset:3072
    ds_read_b128 v[96:99], v3 offset:4096
    ds_read_b128 v[100:103], v3 offset:5120
    ds_read_b128 v[104:107], v3 offset:6144
    ds_read_b128 v[108:111], v3 offset:7168
    s_lshr_b32 s54, s8, 1
    s_lshl_b32 s54, s54, 12
    s_add_u32 s54, s54, 8192
    v_add_u32 v8, s54, v3
    ds_read_b128 v[112:115], v8 offset:0
    ds_read_b128 v[116:119], v8 offset:1024
    ds_read_b128 v[120:123], v8 offset:2048
    ds_read_b128 v[124:127], v8 offset:3072
    s_waitcnt vmcnt(2)
    ds_write_b32 v11, v128
    ds_write_b32 v11, v129 offset:512
    s_waitcnt lgkmcnt(0)
    s_barrier
    ds_read_b128 v[64:67], v21 offset:0
    ds_read_b128 v[68:71], v21 offset:2048
    ds_read_b128 v[72:75], v21 offset:4096
    ds_read_b128 v[76:79], v21 offset:6144
    ds_read_b64_tr_b16 v[136:137], v20 offset:0
    ds_read_b64_tr_b16 v[138:139], v20 offset:256
    ds_read_b64_tr_b16 v[140:141], v20 offset:1024
    ds_read_b64_tr_b16 v[142:143], v20 offset:1280
    ds_read_b64_tr_b16 v[144:145], v20 offset:2048
    ds_read_b64_tr_b16 v[146:147], v20 offset:2304
    ds_read_b64_tr_b16 v[148:149], v20 offset:3072
    ds_read_b64_tr_b16 v[150:151], v20 offset:3328
    s_waitcnt vmcnt(0)
    s_waitcnt lgkmcnt(8)
    v_mfma_f32_16x16x32_bf16 v[32:35], v[80:83], v[64:67], v[24:27]
    v_mfma_f32_16x16x32_bf16 v[36:39], v[96:99], v[64:67], v[28:31]
    v_mfma_f32_16x16x32_bf16 v[32:35], v[84:87], v[68:71], v[32:35]
    v_mfma_f32_16x16x32_bf16 v[36:39], v[100:103], v[68:71], v[36:39]
    v_mfma_f32_16x16x32_bf16 v[32:35], v[88:91], v[72:75], v[32:35]
    v_mfma_f32_16x16x32_bf16 v[36:39], v[104:107], v[72:75], v[36:39]
    v_mfma_f32_16x16x32_bf16 v[32:35], v[92:95], v[76:79], v[32:35]
    v_mfma_f32_16x16x32_bf16 v[36:39], v[108:111], v[76:79], v[36:39]
    s_waitcnt lgkmcnt(0)
    v_mfma_f32_16x16x32_bf16 v[40:43], v[136:139], v[64:67], 0
    v_mfma_f32_16x16x32_bf16 v[40:43], v[140:143], v[68:71], v[40:43]
    v_mfma_f32_16x16x32_bf16 v[40:43], v[144:147], v[72:75], v[40:43]
    v_mfma_f32_16x16x32_bf16 v[40:43], v[148:151], v[76:79], v[40:43]
    s_lshl_b32 s54, s38, 7
    s_and_b32 s55, s8, 1
    s_lshl_b32 s55, s55, 6
    s_add_u32 s54, s54, s55
    s_add_u32 s54, s54, 117506048
    s_add_u32 s16, s4, s54
    s_addc_u32 s17, s5, 0
    v_and_b32 v8, 15, v0
    v_lshlrev_b32 v8, 2, v8
    s_mov_b32 exec_hi, 0
    global_load_dwordx4 v[184:187], v22, s[40:41] sc1
    global_load_dword v188, v8, s[16:17] sc1
    s_mov_b64 exec, -1
    s_nop 7
    v_max3_f32 v8, v32, v33, v34
    v_max3_f32 v9, v35, v36, v37
    v_max3_f32 v8, v8, v38, v39
    v_max3_f32 v8, v8, v40, v41
    v_max_f32 v8, v8, v9
    v_mov_b32 v9, v8
    s_nop 1
    v_permlane16_swap_b32 v8, v9
    v_max_f32 v8, v8, v9
    v_mov_b32 v9, v8
    s_nop 1
    v_permlane32_swap_b32 v8, v9
    v_max_f32 v8, v8, v9
    v_mul_f32 v8, s48, v8
    v_fma_f32 v32, v32, s48, -v8
    v_fma_f32 v33, v33, s48, -v8
    v_fma_f32 v34, v34, s48, -v8
    v_fma_f32 v35, v35, s48, -v8
    v_fma_f32 v36, v36, s48, -v8
    v_fma_f32 v37, v37, s48, -v8
    v_fma_f32 v38, v38, s48, -v8
    v_fma_f32 v39, v39, s48, -v8
    v_fma_f32 v40, v40, s48, -v8
    v_fma_f32 v41, v41, s48, -v8
    v_exp_f32 v32, v32
    v_exp_f32 v33, v33
    v_exp_f32 v34, v34
    v_exp_f32 v35, v35
    v_exp_f32 v36, v36
    v_exp_f32 v37, v37
    v_exp_f32 v38, v38
    v_exp_f32 v39, v39
    v_exp_f32 v40, v40
    v_exp_f32 v41, v41
    v_mov_b32 v49, 0
    v_mov_b32 v50, 0
    v_cvt_pk_bf16_f32 v44, v32, v33
    v_cvt_pk_bf16_f32 v45, v34, v35
    v_cvt_pk_bf16_f32 v46, v36, v37
    v_cvt_pk_bf16_f32 v47, v38, v39
    v_cvt_pk_bf16_f32 v48, v40, v41
    v_cvt_pk_bf16_f32 v51, v40, v41
    s_nop 1
    v_mfma_f32_16x16x32_bf16 v[168:171], v[172:175], v[44:47], 0
    v_mfma_f32_16x16x32_bf16 v[152:155], v[112:115], v[44:47], 0
    v_mfma_f32_16x16x32_bf16 v[156:159], v[116:119], v[44:47], 0
    v_mfma_f32_16x16x32_bf16 v[160:163], v[120:123], v[44:47], 0
    v_mfma_f32_16x16x32_bf16 v[164:167], v[124:127], v[44:47], 0
    v_mfma_f32_16x16x16_bf16 v[168:171], v[172:173], v[48:49], v[168:171]
    v_mfma_f32_16x16x16_bf16 v[152:155], v[130:131], v[48:49], v[152:155]
    v_mfma_f32_16x16x16_bf16 v[156:159], v[130:131], v[50:51], v[156:159]
    v_mfma_f32_16x16x16_bf16 v[160:163], v[132:133], v[48:49], v[160:163]
    v_mfma_f32_16x16x16_bf16 v[164:167], v[132:133], v[50:51], v[164:167]
    s_nop 7
    s_nop 1
    v_rcp_f32 v8, v168
    s_nop 0
    v_mul_f32 v152, v152, v8
    v_mul_f32 v153, v153, v8
    v_mul_f32 v154, v154, v8
    v_mul_f32 v155, v155, v8
    v_mul_f32 v156, v156, v8
    v_mul_f32 v157, v157, v8
    v_mul_f32 v158, v158, v8
    v_mul_f32 v159, v159, v8
    v_mul_f32 v160, v160, v8
    v_mul_f32 v161, v161, v8
    v_mul_f32 v162, v162, v8
    v_mul_f32 v163, v163, v8
    v_mul_f32 v164, v164, v8
    v_mul_f32 v165, v165, v8
    v_mul_f32 v166, v166, v8
    v_mul_f32 v167, v167, v8
    v_cvt_pk_bf16_f32 v152, v152, v153
    v_cvt_pk_bf16_f32 v153, v154, v155
    v_cvt_pk_bf16_f32 v154, v156, v157
    v_cvt_pk_bf16_f32 v155, v158, v159
    v_cvt_pk_bf16_f32 v156, v160, v161
    v_cvt_pk_bf16_f32 v157, v162, v163
    v_cvt_pk_bf16_f32 v158, v164, v165
    v_cvt_pk_bf16_f32 v159, v166, v167
    ds_write_b128 v16, v[152:155]
    ds_write_b128 v16, v[156:159] offset:2048
    s_and_b32 s54, s21, 1
    s_lshl_b32 s54, s54, 20
    s_add_u32 s14, s28, s54
    s_addc_u32 s15, s29, 0
    s_waitcnt lgkmcnt(0)
    s_barrier
    ds_read_b128 v[64:67], v23 offset:8192
    ds_read_b128 v[68:71], v23 offset:9216
    ds_read_b128 v[72:75], v23 offset:10240
    ds_read_b128 v[76:79], v23 offset:11264
    ds_read_b128 v[80:83], v23 offset:12288
    ds_read_b128 v[84:87], v23 offset:13312
    ds_read_b128 v[88:91], v23 offset:14336
    ds_read_b128 v[92:95], v23 offset:15360
    s_waitcnt lgkmcnt(7)
    v_mfma_f32_32x32x16_bf16 v[192:207], a[128:131], v[64:67], 0
    s_waitcnt lgkmcnt(6)
    v_mfma_f32_32x32x16_bf16 v[192:207], a[132:135], v[68:71], v[192:207]
    s_waitcnt lgkmcnt(5)
    v_mfma_f32_32x32x16_bf16 v[192:207], a[136:139], v[72:75], v[192:207]
    s_waitcnt lgkmcnt(4)
    v_mfma_f32_32x32x16_bf16 v[192:207], a[140:143], v[76:79], v[192:207]
    s_waitcnt lgkmcnt(3)
    v_mfma_f32_32x32x16_bf16 v[192:207], a[144:147], v[80:83], v[192:207]
    s_waitcnt lgkmcnt(2)
    v_mfma_f32_32x32x16_bf16 v[192:207], a[148:151], v[84:87], v[192:207]
    s_waitcnt lgkmcnt(1)
    v_mfma_f32_32x32x16_bf16 v[192:207], a[152:155], v[88:91], v[192:207]
    s_waitcnt lgkmcnt(0)
    v_mfma_f32_32x32x16_bf16 v[192:207], a[156:159], v[92:95], v[192:207]
    v_mfma_f32_32x32x16_bf16 v[208:223], a[160:163], v[64:67], 0
    v_mfma_f32_32x32x16_bf16 v[208:223], a[164:167], v[68:71], v[208:223]
    v_mfma_f32_32x32x16_bf16 v[208:223], a[168:171], v[72:75], v[208:223]
    v_cvt_pk_bf16_f32 v32, v192, v193
    v_cvt_pk_bf16_f32 v33, v194, v195
    v_cvt_pk_bf16_f32 v34, v196, v197
    v_mfma_f32_32x32x16_bf16 v[208:223], a[172:175], v[76:79], v[208:223]
    v_cvt_pk_bf16_f32 v35, v198, v199
    global_store_dwordx4 v17, v[32:35], s[14:15]
    s_add_u32 s14, s14, 32768
    v_mfma_f32_32x32x16_bf16 v[208:223], a[176:179], v[80:83], v[208:223]
    s_addc_u32 s15, s15, 0
    v_cvt_pk_bf16_f32 v36, v200, v201
    v_cvt_pk_bf16_f32 v37, v202, v203
    v_mfma_f32_32x32x16_bf16 v[208:223], a[180:183], v[84:87], v[208:223]
    v_cvt_pk_bf16_f32 v38, v204, v205
    v_cvt_pk_bf16_f32 v39, v206, v207
    global_store_dwordx4 v17, v[36:39], s[14:15]
    v_mfma_f32_32x32x16_bf16 v[208:223], a[184:187], v[88:91], v[208:223]
    s_add_u32 s14, s14, 32768
    s_addc_u32 s15, s15, 0
    v_mfma_f32_32x32x16_bf16 v[208:223], a[188:191], v[92:95], v[208:223]
    v_mfma_f32_32x32x16_bf16 v[224:239], a[192:195], v[64:67], 0
    v_mfma_f32_32x32x16_bf16 v[224:239], a[196:199], v[68:71], v[224:239]
    v_mfma_f32_32x32x16_bf16 v[224:239], a[200:203], v[72:75], v[224:239]
    v_cvt_pk_bf16_f32 v40, v208, v209
    v_cvt_pk_bf16_f32 v41, v210, v211
    v_cvt_pk_bf16_f32 v42, v212, v213
    v_mfma_f32_32x32x16_bf16 v[224:239], a[204:207], v[76:79], v[224:239]
    v_cvt_pk_bf16_f32 v43, v214, v215
    global_store_dwordx4 v17, v[40:43], s[14:15]
    s_add_u32 s14, s14, 32768
    v_mfma_f32_32x32x16_bf16 v[224:239], a[208:211], v[80:83], v[224:239]
    s_addc_u32 s15, s15, 0
    v_cvt_pk_bf16_f32 v44, v216, v217
    v_cvt_pk_bf16_f32 v45, v218, v219
    v_mfma_f32_32x32x16_bf16 v[224:239], a[212:215], v[84:87], v[224:239]
    v_cvt_pk_bf16_f32 v46, v220, v221
    v_cvt_pk_bf16_f32 v47, v222, v223
    global_store_dwordx4 v17, v[44:47], s[14:15]
    v_mfma_f32_32x32x16_bf16 v[224:239], a[216:219], v[88:91], v[224:239]
    s_add_u32 s14, s14, 32768
    s_addc_u32 s15, s15, 0
    v_mfma_f32_32x32x16_bf16 v[224:239], a[220:223], v[92:95], v[224:239]
    v_mfma_f32_32x32x16_bf16 v[240:255], a[224:227], v[64:67], 0
    v_mfma_f32_32x32x16_bf16 v[240:255], a[228:231], v[68:71], v[240:255]
    v_mfma_f32_32x32x16_bf16 v[240:255], a[232:235], v[72:75], v[240:255]
    v_cvt_pk_bf16_f32 v32, v224, v225
    v_cvt_pk_bf16_f32 v33, v226, v227
    v_cvt_pk_bf16_f32 v34, v228, v229
    v_mfma_f32_32x32x16_bf16 v[240:255], a[236:239], v[76:79], v[240:255]
    v_cvt_pk_bf16_f32 v35, v230, v231
    global_store_dwordx4 v17, v[32:35], s[14:15]
    s_add_u32 s14, s14, 32768
    v_mfma_f32_32x32x16_bf16 v[240:255], a[240:243], v[80:83], v[240:255]
    s_addc_u32 s15, s15, 0
    v_cvt_pk_bf16_f32 v36, v232, v233
    v_cvt_pk_bf16_f32 v37, v234, v235
    v_mfma_f32_32x32x16_bf16 v[240:255], a[244:247], v[84:87], v[240:255]
    v_cvt_pk_bf16_f32 v38, v236, v237
    v_cvt_pk_bf16_f32 v39, v238, v239
    global_store_dwordx4 v17, v[36:39], s[14:15]
    v_mfma_f32_32x32x16_bf16 v[240:255], a[248:251], v[88:91], v[240:255]
    s_add_u32 s14, s14, 32768
    s_addc_u32 s15, s15, 0
    v_mfma_f32_32x32x16_bf16 v[240:255], a[252:255], v[92:95], v[240:255]
    s_nop 15
    s_nop 3
    v_cvt_pk_bf16_f32 v40, v240, v241
    v_cvt_pk_bf16_f32 v41, v242, v243
    v_cvt_pk_bf16_f32 v42, v244, v245
    v_cvt_pk_bf16_f32 v43, v246, v247
    global_store_dwordx4 v17, v[40:43], s[14:15]
    s_add_u32 s14, s14, 32768
    s_addc_u32 s15, s15, 0
    v_cvt_pk_bf16_f32 v44, v248, v249
    v_cvt_pk_bf16_f32 v45, v250, v251
    v_cvt_pk_bf16_f32 v46, v252, v253
    v_cvt_pk_bf16_f32 v47, v254, v255
    global_store_dwordx4 v17, v[44:47], s[14:15]
    s_add_u32 s14, s14, 32768
    s_addc_u32 s15, s15, 0
    s_waitcnt vmcnt(8)
    s_mov_b32 exec_hi, 0
    s_cmp_eq_u32 s21, 0
    s_cbranch_scc1 L_aok_61
L_await_60:
    v_cmp_eq_u32 vcc, -1, v184
    s_cbranch_vccz L_aok_61
    global_load_dwordx4 v[184:187], v22, s[40:41] sc1
    s_waitcnt vmcnt(0)
    s_sub_u32 s12, s12, 1
    s_cbranch_scc1 L_fail
    s_branch L_await_60
L_aok_61:
    v_sub_f32 v184, v184, v180
    v_fma_f32 v184, v188, v184, v180
    v_sub_f32 v185, v185, v181
    v_fma_f32 v185, v188, v185, v181
    v_sub_f32 v186, v186, v182
    v_fma_f32 v186, v188, v186, v182
    v_sub_f32 v187, v187, v183
    v_fma_f32 v187, v188, v187, v183
    v_cvt_pk_bf16_f32 v184, v184, v185
    v_cvt_pk_bf16_f32 v185, v186, v187
    global_store_dwordx2 v19, v[184:185], s[42:43]
    s_mov_b64 exec, -1
    s_waitcnt vmcnt(0)
    s_barrier
    s_cmp_lg_u32 s8, 0
    s_cbranch_scc1 L_noflr_62
    s_add_u32 s54, s21, 1
    v_mov_b32 v8, s54
    s_lshl_b32 s54, s9, 2
    v_mov_b32 v9, s54
    s_mov_b64 exec, 1
    global_store_dword v9, v8, s[30:31]
    s_mov_b64 exec, -1
L_noflr_62:
    s_mov_b32 s38, s20
    s_add_u32 s20, s20, 3
    s_xor_b32 s23, s23, 32768
    s_add_u32 s21, s21, 1
    s_cmp_lt_u32 s21, s22
    s_cbranch_scc1 L_f_loopB
L_lastflr_63:
    global_load_dword v190, v191, s[30:31] sc1
    s_waitcnt vmcnt(0)
    v_cmp_gt_u32 vcc, s21, v190
    s_sub_u32 s12, s12, 1
    s_cbranch_scc1 L_fail
    s_cbranch_vccnz L_lastflr_63
    s_sub_u32 s54, s21, 1
    s_and_b32 s54, s54, 1
    s_lshl_b32 s54, s54, 20
    s_add_u32 s64, s28, s54
    s_addc_u32 s65, s29, 0
    global_load_dwordx4 v[192:195], v18, s[64:65] sc1
    s_add_u32 s64, s64, 4096
    s_addc_u32 s65, s65, 0
    global_load_dwordx4 v[196:199], v18, s[64:65] sc1
    s_add_u32 s64, s64, 4096
    s_addc_u32 s65, s65, 0
    global_load_dwordx4 v[200:203], v18, s[64:65] sc1
    s_add_u32 s64, s64, 4096
    s_addc_u32 s65, s65, 0
    global_load_dwordx4 v[204:207], v18, s[64:65] sc1
    s_add_u32 s64, s64, 4096
    s_addc_u32 s65, s65, 0
    global_load_dwordx4 v[208:211], v18, s[64:65] sc1
    s_add_u32 s64, s64, 4096
    s_addc_u32 s65, s65, 0
    global_load_dwordx4 v[212:215], v18, s[64:65] sc1
    s_add_u32 s64, s64, 4096
    s_addc_u32 s65, s65, 0
    global_load_dwordx4 v[216:219], v18, s[64:65] sc1
    s_add_u32 s64, s64, 4096
    s_addc_u32 s65, s65, 0
    global_load_dwordx4 v[220:223], v18, s[64:65] sc1
    s_lshl_b32 s54, s38, 16
    s_add_u32 s54, s54, 136314880
    s_cmp_eq_u32 s21, 0
    s_cselect_b32 s54, 141557760, s54
    s_add_u32 s40, s4, s54
    s_addc_u32 s41, s5, 0
    s_lshl_b32 s54, s38, 15
    s_add_u32 s42, s26, s54
    s_addc_u32 s43, s27, 0
    s_cmp_lg_u32 s21, 0
    s_cbranch_scc1 L_od_64
    s_add_u32 s42, s4, 141819904
    s_addc_u32 s43, s5, 0
L_od_64:
    s_lshl_b32 s54, s38, 7
    s_and_b32 s55, s8, 1
    s_lshl_b32 s55, s55, 6
    s_add_u32 s54, s54, s55
    s_add_u32 s54, s54, 117506048
    s_add_u32 s16, s4, s54
    s_addc_u32 s17, s5, 0
    v_and_b32 v8, 15, v0
    v_lshlrev_b32 v8, 2, v8
    s_mov_b32 exec_hi, 0
    global_load_dwordx4 v[184:187], v22, s[40:41] sc1
    global_load_dword v188, v8, s[16:17] sc1
    s_mov_b64 exec, -1
    s_waitcnt vmcnt(9)
    v_mfma_f32_16x16x32_bf16 v[180:183], v[176:179], v[192:195], 0
    s_waitcnt vmcnt(8)
    v_mfma_f32_16x16x32_bf16 v[180:183], v[176:179], v[196:199], v[180:183]
    s_waitcnt vmcnt(7)
    v_mfma_f32_16x16x32_bf16 v[180:183], v[176:179], v[200:203], v[180:183]
    s_waitcnt vmcnt(6)
    v_mfma_f32_16x16x32_bf16 v[180:183], v[176:179], v[204:207], v[180:183]
    s_waitcnt vmcnt(5)
    v_mfma_f32_16x16x32_bf16 v[180:183], v[176:179], v[208:211], v[180:183]
    s_waitcnt vmcnt(4)
    v_mfma_f32_16x16x32_bf16 v[180:183], v[176:179], v[212:215], v[180:183]
    s_waitcnt vmcnt(3)
    v_mfma_f32_16x16x32_bf16 v[180:183], v[176:179], v[216:219], v[180:183]
    s_waitcnt vmcnt(2)
    v_mfma_f32_16x16x32_bf16 v[180:183], v[176:179], v[220:223], v[180:183]
    s_nop 7
    s_nop 1
    s_waitcnt vmcnt(0)
    s_mov_b32 exec_hi, 0
L_await_65:
    v_cmp_eq_u32 vcc, -1, v184
    s_cbranch_vccz L_aok_66
    global_load_dwordx4 v[184:187], v22, s[40:41] sc1
    s_waitcnt vmcnt(0)
    s_sub_u32 s12, s12, 1
    s_cbranch_scc1 L_fail
    s_branch L_await_65
L_aok_66:
    v_sub_f32 v184, v184, v180
    v_fma_f32 v184, v188, v184, v180
    v_sub_f32 v185, v185, v181
    v_fma_f32 v185, v188, v185, v181
    v_sub_f32 v186, v186, v182
    v_fma_f32 v186, v188, v186, v182
    v_sub_f32 v187, v187, v183
    v_fma_f32 v187, v188, v187, v183
    v_cvt_pk_bf16_f32 v184, v184, v185
    v_cvt_pk_bf16_f32 v185, v186, v187
    global_store_dwordx2 v19, v[184:185], s[42:43]
    s_mov_b64 exec, -1
    s_waitcnt vmcnt(0)
    s_endpgm
L_flrslow_48:
    global_load_dword v190, v191, s[30:31] sc1
    s_waitcnt vmcnt(0)
    v_cmp_gt_u32 vcc, s21, v190
    s_sub_u32 s12, s12, 1
    s_cbranch_scc1 L_fail
    s_cbranch_vccnz L_flrslow_48
    s_branch L_flrok_49
L_flmslow_50:
    s_mov_b64 exec, 1
    global_load_dword v189, v1, s[32:33] sc1
    s_mov_b64 exec, -1
    s_waitcnt vmcnt(0)
    v_readfirstlane_b32 s59, v189
    s_sub_u32 s12, s12, 1
    s_cbranch_scc1 L_fail
    s_cmp_lt_u32 s59, s58
    s_cbranch_scc1 L_flmslow_50
    s_branch L_flmok_51
L_flrslow_56:
    global_load_dword v190, v191, s[30:31] sc1
    s_waitcnt vmcnt(0)
    v_cmp_gt_u32 vcc, s21, v190
    s_sub_u32 s12, s12, 1
    s_cbranch_scc1 L_fail
    s_cbranch_vccnz L_flrslow_56
    s_branch L_flrok_57
L_flmslow_58:
    s_mov_b64 exec, 1
    global_load_dword v189, v1, s[32:33] sc1
    s_mov_b64 exec, -1
    s_waitcnt vmcnt(0)
    v_readfirstlane_b32 s59, v189
    s_sub_u32 s12, s12, 1
    s_cbranch_scc1 L_fail
    s_cmp_lt_u32 s59, s58
    s_cbranch_scc1 L_flmslow_58
    s_branch L_flmok_59
L_fail:
    v_mov_b32 v2, 252
    v_mov_b32 v3, 0xdead
    s_mov_b64 exec, 1
    global_store_dword v2, v3, s[6:7] sc1
    s_waitcnt vmcnt(0)
L_exit:
    s_endpgm
L_code_end:
.section .rodata,"a"
.p2align 6
.amdhsa_kernel gated_mix__memory_aug_recurrent_mem_tr__memory_aug_recurrent_mem_tr__prompt_kernel
.amdhsa_next_free_vgpr 512
.amdhsa_next_free_sgpr 102
.amdhsa_accum_offset 256
.amdhsa_group_segment_fixed_size 0
.amdhsa_kernarg_size 144
.amdhsa_user_sgpr_count 2
.amdhsa_user_sgpr_kernarg_segment_ptr 1
.amdhsa_system_sgpr_workgroup_id_x 1
.amdhsa_float_denorm_mode_32 3
.end_amdhsa_kernel
```
